```python
import torch

def _softmax(x, axis=-1):
    return torch.softmax(x, dim=axis)
def _gelu(x):
    return torch.nn.functional.gelu(x, approximate="tanh")
def _silu(x):
    return torch.nn.functional.silu(x)
def _sigmoid(x):
    return torch.sigmoid(x)
def _layernorm(x, axis=-1, eps=1e-5):
    m = x.mean(dim=axis, keepdim=True)
    v = x.var(dim=axis, keepdim=True, unbiased=False)
    return (x - m) / torch.sqrt(v + eps)
def _scatter_add(tgt, idx, src, axis=0):
    return tgt.clone().index_add_(axis, idx, src)
def _segment_sum(src, seg, n):
    out = torch.zeros((n,) + src.shape[1:], dtype=src.dtype)
    return out.index_add_(0, seg, src)
def _pad(x, pw):
    flat = tuple(v for pair in reversed(pw) for v in pair)
    return torch.nn.functional.pad(x, flat)

kernel_name = 'standalone__mha_softmax__near_ridge'

def setup_inputs():

    _w = (lambda a: (lambda t: t.to(torch.bfloat16) if t.is_floating_point() else t)(torch.as_tensor(a)))
    B, H, Sq, Sk, D = 16, 32, 512, 512, 128
    return {
        "q": _w((lambda *s: torch.randn(*s, dtype=torch.bfloat16) * 0.8)(B, H, Sq, D)),
        "k": _w((lambda *s: torch.randn(*s, dtype=torch.bfloat16) * 0.8)(B, H, Sk, D)),
        "v": _w((lambda *s: torch.randn(*s, dtype=torch.bfloat16) * 0.05)(B, H, Sk, D)),
    }

def reference(q, k, v):
    scale = q.shape[-1] ** -0.5
    scores = torch.einsum("bhqd,bhkd->bhqk", q, k) * scale
    p = _softmax(scores, axis=-1)
    return torch.einsum("bhqk,bhkd->bhqd", p, v)
```

```asm
; @launch grid=(256,1,1) block=(256,1,1) lds=163840
.amdgcn_target "amdgcn-amd-amdhsa--gfx950"
.text
.globl standalone__mha_softmax__near_ridge_kernel
.p2align 8
.type standalone__mha_softmax__near_ridge_kernel,@function
standalone__mha_softmax__near_ridge_kernel:
    s_load_dwordx4 s[44:47], s[0:1], 0
    s_load_dwordx4 s[48:51], s[0:1], 16
    s_cmp_ge_u32 s2, 256
    s_cbranch_scc1 L_end
    v_lshrrev_b32 v224, 6, v0
    v_bfe_u32 v226, v0, 4, 2
    v_readfirstlane_b32 s40, v224
    v_and_b32 v225, 63, v0
    v_lshlrev_b32 v214, 4, v225
    s_getpc_b64 s[64:65]
L_pc:
    s_lshr_b32 s36, s2, 3
    s_and_b32 s36, s36, 15
    s_lshl_b32 s36, s36, 2
    s_add_u32 s36, s36, s40
    s_lshl_b32 s36, s36, 10
    v_add_u32 v230, s36, v214
    v_min_u32 v230, L_slow-L_pc, v230
    global_load_dwordx4 v[240:243], v230, s[64:65]
    v_and_b32 v227, 15, v0
    v_xor_b32 v231, v226, v227
    v_lshlrev_b32 v231, 4, v231
    v_lshl_add_u32 v215, v226, 8, v231
    v_xor_b32 v216, 64, v215
    v_xor_b32 v217, 0x80, v215
    v_xor_b32 v218, 0xc0, v215
    s_lshr_b32 s36, s2, 4
    s_lshl_b32 s36, s36, 20
    s_and_b32 s37, s2, 7
    s_lshl_b32 s37, s37, 17
    s_add_u32 s57, s36, s37
    s_and_b32 s37, s2, 8
    s_lshl_b32 s37, s37, 13
    s_add_u32 s58, s57, s37
    s_lshl_b32 s38, s40, 14
    s_add_u32 s58, s58, s38
    s_lshl_b32 s34, s40, 11
    s_and_b32 s36, s40, 1
    s_lshl_b32 s37, s36, 7
    s_or_b32 s37, s37, s34
    v_xor_b32 v208, s37, v215
    v_xor_b32 v209, s37, v216
    s_lshl_b32 s56, s36, 13
    s_and_b32 s37, s40, 2
    s_lshl_b32 s37, s37, 15
    s_add_u32 s56, s56, s37
    s_add_u32 s56, s56, 0xc000
    s_mov_b32 s14, 0x2000
    s_mov_b32 s15, 0x20000
    s_mov_b32 s10, 0x1000
    s_mov_b32 s11, 0x20000
    s_waitcnt lgkmcnt(0)
    s_add_u32 s12, s46, s57
    s_addc_u32 s13, s47, 0
    s_add_u32 m0, s34, 0
    s_nop 0
    buffer_load_dwordx4 v208, s[12:15], 0 offen nt lds
    buffer_load_dwordx4 v209, s[12:15], 0 offen offset:1024 nt lds
    s_add_u32 s8, s44, s58
    s_addc_u32 s9, s45, 0
    s_add_u32 m0, s56, 0
    s_nop 0
    buffer_load_dwordx4 v215, s[8:11], 0 offen nt lds
    buffer_load_dwordx4 v216, s[8:11], 0 offen offset:1024 nt lds
    buffer_load_dwordx4 v217, s[8:11], 0 offen offset:2048 nt lds
    buffer_load_dwordx4 v218, s[8:11], 0 offen offset:3072 nt lds
    s_add_u32 s8, s8, 0x1000
    s_addc_u32 s9, s9, 0
    s_add_u32 m0, s56, 0x1000
    s_nop 0
    buffer_load_dwordx4 v215, s[8:11], 0 offen nt lds
    buffer_load_dwordx4 v216, s[8:11], 0 offen offset:1024 nt lds
    buffer_load_dwordx4 v217, s[8:11], 0 offen offset:2048 nt lds
    buffer_load_dwordx4 v218, s[8:11], 0 offen offset:3072 nt lds
    s_add_u32 s8, s8, 0x1000
    s_addc_u32 s9, s9, 0
    s_add_u32 s12, s12, 0x2000
    s_addc_u32 s13, s13, 0
    s_lshl_b32 s35, s40, 13
    s_add_u32 s35, s35, 0x20000
    s_add_u32 s16, s48, s57
    s_addc_u32 s17, s49, 0
    s_mov_b32 s18, 0x2000
    s_mov_b32 s19, 0x20000
    s_mov_b32 s20, s50
    s_mov_b32 s21, s51
    s_mov_b32 s22, 0
    s_mov_b32 s23, 0x20000
    v_lshlrev_b32 v229, 1, v226
    v_xor_b32 v229, v229, v227
    v_lshlrev_b32 v229, 4, v229
    v_lshl_add_u32 v229, v226, 8, v229
    v_add_u32 v210, s34, v229
    v_xor_b32 v211, 0x80, v210
    v_lshl_add_u32 v196, v227, 8, v231
    v_xor_b32 v197, 64, v196
    v_xor_b32 v198, 0x80, v196
    v_xor_b32 v199, 0xc0, v196
    v_add_u32 v244, s35, v196
    v_add_u32 v245, s35, v197
    v_add_u32 v246, s35, v198
    v_add_u32 v247, s35, v199
    v_add_u32 v232, s56, v196
    v_add_u32 v233, s56, v197
    v_add_u32 v234, s56, v198
    v_add_u32 v235, s56, v199
    v_lshrrev_b32 v228, 2, v227
    v_lshl_add_u32 v228, v226, 2, v228
    v_and_b32 v229, 7, v228
    v_lshlrev_b32 v229, 1, v229
    v_bfe_u32 v230, v225, 1, 1
    v_xor_b32 v229, v229, v230
    v_lshlrev_b32 v229, 4, v229
    v_lshl_add_u32 v229, v228, 8, v229
    v_and_b32 v224, 1, v225
    v_lshl_add_u32 v229, v224, 3, v229
    v_add_u32 v200, 0x10000, v229
    v_xor_b32 v201, 32, v200
    v_xor_b32 v202, 64, v200
    v_xor_b32 v203, 0x60, v200
    v_xor_b32 v204, 0x80, v200
    v_xor_b32 v205, 0xa0, v200
    v_xor_b32 v206, 0xc0, v200
    v_xor_b32 v207, 0xe0, v200
    v_and_b32 v229, 7, v227
    v_lshrrev_b32 v224, 1, v226
    v_xor_b32 v229, v229, v224
    v_lshlrev_b32 v229, 4, v229
    v_lshl_add_u32 v229, v227, 8, v229
    v_and_b32 v224, 1, v226
    v_lshl_add_u32 v229, v224, 3, v229
    v_add_u32 v248, s35, v229
    v_xor_b32 v249, 32, v248
    v_xor_b32 v250, 64, v248
    v_xor_b32 v251, 0x60, v248
    v_add_u32 v236, 0x1000, v248
    v_add_u32 v237, 0x1000, v249
    v_add_u32 v238, 0x1000, v250
    v_add_u32 v239, 0x1000, v251
    v_add_u32 v212, s35, v215
    v_xor_b32 v213, 64, v212
    v_mov_b32 v220, 0x3f803f80
    v_mov_b32 v221, 0x3f803f80
    v_mov_b32 v222, 0x3f803f80
    v_mov_b32 v223, 0x3f803f80
    v_mov_b32 v219, 0x5f800000
    v_lshlrev_b32 v252, 2, v227
    s_mov_b32 s28, 0x3e0293ee
    s_mov_b32 s39, 0
    s_mov_b32 s32, s58
    s_mov_b32 s31, 0
    s_mov_b32 s30, 0x4000000
    s_mov_b32 s33, 0
    s_mov_b32 s56, 0
    s_add_u32 m0, s34, 0x10000
    s_nop 0
    buffer_load_dwordx4 v210, s[16:19], 0 offen nt lds
    buffer_load_dwordx4 v211, s[16:19], 0 offen offset:1024 nt lds
    s_add_u32 s16, s16, 0x2000
    s_addc_u32 s17, s17, 0
    s_add_u32 m0, s34, 0x2000
    s_nop 0
    buffer_load_dwordx4 v208, s[12:15], 0 offen nt lds
    buffer_load_dwordx4 v209, s[12:15], 0 offen offset:1024 nt lds
    s_add_u32 s12, s12, 0x2000
    s_addc_u32 s13, s13, 0
    s_add_u32 m0, s35, 0
    s_nop 0
    buffer_load_dwordx4 v215, s[8:11], 0 offen nt lds
    buffer_load_dwordx4 v216, s[8:11], 0 offen offset:1024 nt lds
    buffer_load_dwordx4 v217, s[8:11], 0 offen offset:2048 nt lds
    buffer_load_dwordx4 v218, s[8:11], 0 offen offset:3072 nt lds
    s_add_u32 s8, s8, 0x1000
    s_addc_u32 s9, s9, 0
    s_waitcnt vmcnt(16)
    s_barrier
    ds_read_b128 a[128:131], v196 offset:0
    ds_read_b128 a[132:135], v197 offset:0
    ds_read_b128 a[136:139], v198 offset:0
    ds_read_b128 a[140:143], v199 offset:0
    ds_read_b128 a[144:147], v196 offset:4096
    ds_read_b128 a[148:151], v197 offset:4096
    ds_read_b128 a[152:155], v198 offset:4096
    ds_read_b128 a[156:159], v199 offset:4096
    s_waitcnt vmcnt(8)
    ds_read_b128 a[0:3], v232 offset:0
    ds_read_b128 a[4:7], v233 offset:0
    ds_read_b128 a[8:11], v234 offset:0
    ds_read_b128 a[12:15], v235 offset:0
    ds_read_b128 a[16:19], v232 offset:4096
    ds_read_b128 a[20:23], v233 offset:4096
    ds_read_b128 a[24:27], v234 offset:4096
    ds_read_b128 a[28:31], v235 offset:4096
    s_waitcnt lgkmcnt(0)
    s_waitcnt lgkmcnt(8)
    v_mfma_f32_16x16x32_bf16 v[128:131], a[128:131], a[0:3], 0
    s_add_u32 m0, s35, 0x1000
    s_nop 0
    buffer_load_dwordx4 v215, s[8:11], 0 offen nt lds
    buffer_load_dwordx4 v216, s[8:11], 0 offen offset:1024 nt lds
    buffer_load_dwordx4 v217, s[8:11], 0 offen offset:2048 nt lds
    buffer_load_dwordx4 v218, s[8:11], 0 offen offset:3072 nt lds
    v_mfma_f32_16x16x32_bf16 v[128:131], a[132:135], a[4:7], v[128:131]
    s_add_u32 s8, s8, 0xffd000
    s_addc_u32 s9, s9, 0
    v_mfma_f32_16x16x32_bf16 v[128:131], a[136:139], a[8:11], v[128:131]
    s_add_u32 m0, s34, 0x12000
    s_nop 0
    buffer_load_dwordx4 v210, s[16:19], 0 offen nt lds
    buffer_load_dwordx4 v211, s[16:19], 0 offen offset:1024 nt lds
    s_add_u32 m0, s34, 0x4000
    s_nop 0
    buffer_load_dwordx4 v208, s[12:15], 0 offen nt lds
    buffer_load_dwordx4 v209, s[12:15], 0 offen offset:1024 nt lds
    v_mfma_f32_16x16x32_bf16 v[128:131], a[140:143], a[12:15], v[128:131]
    s_add_u32 s16, s16, 0x2000
    s_addc_u32 s17, s17, 0
    v_mfma_f32_16x16x32_bf16 v[132:135], a[128:131], a[16:19], 0
    s_add_u32 s12, s12, 0x2000
    s_addc_u32 s13, s13, 0
    v_mfma_f32_16x16x32_bf16 v[132:135], a[132:135], a[20:23], v[132:135]
    v_mfma_f32_16x16x32_bf16 v[132:135], a[136:139], a[24:27], v[132:135]
    v_mfma_f32_16x16x32_bf16 v[132:135], a[140:143], a[28:31], v[132:135]
    v_max3_f32 v224, v128, v129, v130
    v_max_f32 v224, v224, v131
    v_mfma_f32_16x16x32_bf16 v[136:139], a[144:147], a[0:3], 0
    v_mul_f32 v192, s28, v224
    v_mov_b32 v225, v192
    v_mfma_f32_16x16x32_bf16 v[136:139], a[148:151], a[4:7], v[136:139]
    v_mfma_f32_16x16x32_bf16 v[136:139], a[152:155], a[8:11], v[136:139]
    v_permlane16_swap_b32 v192, v225
    v_mfma_f32_16x16x32_bf16 v[136:139], a[156:159], a[12:15], v[136:139]
    v_max3_f32 v226, v132, v133, v134
    v_max_f32 v226, v226, v135
    v_mfma_f32_16x16x32_bf16 v[140:143], a[144:147], a[16:19], 0
    v_mul_f32 v193, s28, v226
    v_mov_b32 v227, v193
    v_mfma_f32_16x16x32_bf16 v[140:143], a[148:151], a[20:23], v[140:143]
    v_mov_b32 v225, v192
    v_permlane16_swap_b32 v193, v227
    v_mfma_f32_16x16x32_bf16 v[140:143], a[152:155], a[24:27], v[140:143]
    s_waitcnt vmcnt(12)
    s_barrier
    v_mov_b32 v227, v193
    v_mfma_f32_16x16x32_bf16 v[140:143], a[156:159], a[28:31], v[140:143]
    ds_read_b64_tr_b16 a[160:161], v200 offset:0
    ds_read_b64_tr_b16 a[162:163], v200 offset:4096
    ds_read_b64_tr_b16 a[164:165], v201 offset:0
    ds_read_b64_tr_b16 a[166:167], v201 offset:4096
    ds_read_b64_tr_b16 a[168:169], v202 offset:0
    ds_read_b64_tr_b16 a[170:171], v202 offset:4096
    ds_read_b64_tr_b16 a[172:173], v203 offset:0
    ds_read_b64_tr_b16 a[174:175], v203 offset:4096
    ds_read_b64_tr_b16 a[176:177], v204 offset:0
    ds_read_b64_tr_b16 a[178:179], v204 offset:4096
    ds_read_b64_tr_b16 a[180:181], v205 offset:0
    ds_read_b64_tr_b16 a[182:183], v205 offset:4096
    ds_read_b64_tr_b16 a[184:185], v206 offset:0
    ds_read_b64_tr_b16 a[186:187], v206 offset:4096
    ds_read_b64_tr_b16 a[188:189], v207 offset:0
    ds_read_b64_tr_b16 a[190:191], v207 offset:4096
    s_waitcnt vmcnt(4)
    ds_read_b128 a[32:35], v244 offset:0
    ds_read_b128 a[36:39], v245 offset:0
    ds_read_b128 a[40:43], v246 offset:0
    ds_read_b128 a[44:47], v247 offset:0
    ds_read_b128 a[48:51], v244 offset:4096
    ds_read_b128 a[52:55], v245 offset:4096
    ds_read_b128 a[56:59], v246 offset:4096
    ds_read_b128 a[60:63], v247 offset:4096
    s_waitcnt lgkmcnt(0)
    v_mfma_f32_16x16x32_bf16 v[144:147], a[128:131], a[32:35], 0
    v_permlane32_swap_b32 v192, v225
    v_mfma_f32_16x16x32_bf16 v[144:147], a[132:135], a[36:39], v[144:147]
    v_permlane32_swap_b32 v193, v227
    v_mfma_f32_16x16x32_bf16 v[144:147], a[136:139], a[40:43], v[144:147]
    v_fma_f32 v128, v128, s28, -v192
    v_fma_f32 v129, v129, s28, -v192
    v_mfma_f32_16x16x32_bf16 v[144:147], a[140:143], a[44:47], v[144:147]
    v_exp_f32 v128, v128
    v_mfma_f32_16x16x32_bf16 v[148:151], a[128:131], a[48:51], 0
    ds_read_b128 a[128:131], v196 offset:8192
    v_fma_f32 v130, v130, s28, -v192
    v_mfma_f32_16x16x32_bf16 v[148:151], a[132:135], a[52:55], v[148:151]
    ds_read_b128 a[132:135], v197 offset:8192
    v_fma_f32 v131, v131, s28, -v192
    v_mfma_f32_16x16x32_bf16 v[148:151], a[136:139], a[56:59], v[148:151]
    ds_read_b128 a[136:139], v198 offset:8192
    v_fma_f32 v132, v132, s28, -v193
    v_mfma_f32_16x16x32_bf16 v[148:151], a[140:143], a[60:63], v[148:151]
    ds_read_b128 a[140:143], v199 offset:8192
    v_fma_f32 v133, v133, s28, -v193
    v_mfma_f32_16x16x32_bf16 v[152:155], a[144:147], a[32:35], 0
    v_exp_f32 v129, v129
    v_mfma_f32_16x16x32_bf16 v[152:155], a[148:151], a[36:39], v[152:155]
    v_exp_f32 v130, v130
    v_mfma_f32_16x16x32_bf16 v[152:155], a[152:155], a[40:43], v[152:155]
    v_exp_f32 v131, v131
    v_mfma_f32_16x16x32_bf16 v[152:155], a[156:159], a[44:47], v[152:155]
    v_cvt_pk_bf16_f32 v160, v128, v129
    v_fma_f32 v134, v134, s28, -v193
    v_mfma_f32_16x16x32_bf16 v[156:159], a[144:147], a[48:51], 0
    ds_read_b128 a[144:147], v196 offset:12288
    v_cvt_pk_bf16_f32 v161, v130, v131
    v_mfma_f32_16x16x32_bf16 v[156:159], a[148:151], a[52:55], v[156:159]
    ds_read_b128 a[148:151], v197 offset:12288
    v_fma_f32 v135, v135, s28, -v193
    v_mfma_f32_16x16x32_bf16 v[156:159], a[152:155], a[56:59], v[156:159]
    ds_read_b128 a[152:155], v198 offset:12288
    v_fma_f32 v136, v136, s28, -v192
    v_mfma_f32_16x16x32_bf16 v[156:159], a[156:159], a[60:63], v[156:159]
    s_waitcnt lgkmcnt(15)
    ds_read_b128 a[156:159], v199 offset:12288
    v_fma_f32 v137, v137, s28, -v192
    v_exp_f32 v136, v136
    v_fma_f32 v138, v138, s28, -v192
    v_exp_f32 v137, v137
    v_fma_f32 v139, v139, s28, -v192
    v_exp_f32 v138, v138
    v_exp_f32 v139, v139
    v_cvt_pk_bf16_f32 v162, v136, v137
    v_cvt_pk_bf16_f32 v163, v138, v139
    s_nop 1
    v_mfma_f32_16x16x32_bf16 v[0:3], a[160:163], v[160:163], 0
    v_exp_f32 v132, v132
    v_exp_f32 v133, v133
    v_exp_f32 v134, v134
    v_exp_f32 v135, v135
    v_cvt_pk_bf16_f32 v164, v132, v133
    v_cvt_pk_bf16_f32 v165, v134, v135
    v_fma_f32 v140, v140, s28, -v193
    v_fma_f32 v141, v141, s28, -v193
    v_exp_f32 v140, v140
    v_fma_f32 v142, v142, s28, -v193
    v_exp_f32 v141, v141
    v_fma_f32 v143, v143, s28, -v193
    v_exp_f32 v142, v142
    v_exp_f32 v143, v143
    v_cvt_pk_bf16_f32 v166, v140, v141
    v_cvt_pk_bf16_f32 v167, v142, v143
    s_nop 1
    v_mfma_f32_16x16x32_bf16 v[32:35], a[160:163], v[164:167], 0
    s_add_u32 m0, s34, 0x14000
    v_max3_f32 v228, v144, v145, v146
    v_max_f32 v228, v228, v147
    v_mfma_f32_16x16x32_bf16 v[4:7], a[164:167], v[160:163], 0
    buffer_load_dwordx4 v210, s[16:19], 0 offen nt lds
    buffer_load_dwordx4 v211, s[16:19], 0 offen offset:1024 nt lds
    v_mfma_f32_16x16x32_bf16 v[36:39], a[164:167], v[164:167], 0
    s_add_u32 s16, s16, 0x2000
    s_addc_u32 s17, s17, 0
    v_mul_f32 v194, s28, v228
    v_mfma_f32_16x16x32_bf16 v[176:179], v[220:223], v[160:163], 0
    v_max3_f32 v230, v148, v149, v150
    v_max_f32 v230, v230, v151
    v_mfma_f32_16x16x32_bf16 v[8:11], a[168:171], v[160:163], 0
    v_mul_f32 v195, s28, v230
    v_mov_b32 v229, v194
    v_mfma_f32_16x16x32_bf16 v[180:183], v[220:223], v[164:167], 0
    s_add_u32 m0, s34, 0x6000
    v_mov_b32 v231, v195
    v_permlane16_swap_b32 v194, v229
    v_mfma_f32_16x16x32_bf16 v[40:43], a[168:171], v[164:167], 0
    buffer_load_dwordx4 v208, s[12:15], 0 offen nt lds
    buffer_load_dwordx4 v209, s[12:15], 0 offen offset:1024 nt lds
    v_mfma_f32_16x16x32_bf16 v[12:15], a[172:175], v[160:163], 0
    s_add_u32 s12, s12, 0x2000
    s_addc_u32 s13, s13, 0
    v_mov_b32 v229, v194
    v_mfma_f32_16x16x32_bf16 v[44:47], a[172:175], v[164:167], 0
    v_permlane16_swap_b32 v195, v231
    v_mfma_f32_16x16x32_bf16 v[16:19], a[176:179], v[160:163], 0
    v_mov_b32 v231, v195
    v_permlane32_swap_b32 v194, v229
    v_mfma_f32_16x16x32_bf16 v[48:51], a[176:179], v[164:167], 0
    v_permlane32_swap_b32 v195, v231
    v_mfma_f32_16x16x32_bf16 v[20:23], a[180:183], v[160:163], 0
    v_fma_f32 v144, v144, s28, -v194
    v_fma_f32 v145, v145, s28, -v194
    v_mfma_f32_16x16x32_bf16 v[52:55], a[180:183], v[164:167], 0
    v_exp_f32 v144, v144
    v_mfma_f32_16x16x32_bf16 v[24:27], a[184:187], v[160:163], 0
    v_fma_f32 v146, v146, s28, -v194
    v_fma_f32 v147, v147, s28, -v194
    v_mfma_f32_16x16x32_bf16 v[56:59], a[184:187], v[164:167], 0
    v_exp_f32 v145, v145
    v_mfma_f32_16x16x32_bf16 v[28:31], a[188:191], v[160:163], 0
    v_exp_f32 v146, v146
    v_mfma_f32_16x16x32_bf16 v[60:63], a[188:191], v[164:167], 0
    s_waitcnt lgkmcnt(0)
    v_fma_f32 v148, v148, s28, -v195
    v_cvt_pk_bf16_f32 v168, v144, v145
    v_mfma_f32_16x16x32_bf16 v[128:131], a[128:131], a[0:3], 0
    s_add_u32 m0, s34, 0x16000
    s_nop 0
    buffer_load_dwordx4 v210, s[16:19], 0 offen nt lds
    buffer_load_dwordx4 v211, s[16:19], 0 offen offset:1024 nt lds
    s_add_u32 m0, s34, 0x8000
    s_nop 0
    buffer_load_dwordx4 v208, s[12:15], 0 offen nt lds
    buffer_load_dwordx4 v209, s[12:15], 0 offen offset:1024 nt lds
    v_mfma_f32_16x16x32_bf16 v[128:131], a[132:135], a[4:7], v[128:131]
    s_add_u32 s16, s16, 0x2000
    s_addc_u32 s17, s17, 0
    v_fma_f32 v149, v149, s28, -v195
    v_mfma_f32_16x16x32_bf16 v[128:131], a[136:139], a[8:11], v[128:131]
    s_add_u32 s12, s12, 0x2000
    s_addc_u32 s13, s13, 0
    v_fma_f32 v150, v150, s28, -v195
    v_mfma_f32_16x16x32_bf16 v[128:131], a[140:143], a[12:15], v[128:131]
    v_exp_f32 v147, v147
    v_mfma_f32_16x16x32_bf16 v[132:135], a[128:131], a[16:19], 0
    v_exp_f32 v148, v148
    v_mfma_f32_16x16x32_bf16 v[132:135], a[132:135], a[20:23], v[132:135]
    v_exp_f32 v149, v149
    v_mfma_f32_16x16x32_bf16 v[132:135], a[136:139], a[24:27], v[132:135]
    v_cvt_pk_bf16_f32 v169, v146, v147
    v_fma_f32 v151, v151, s28, -v195
    v_mfma_f32_16x16x32_bf16 v[132:135], a[140:143], a[28:31], v[132:135]
    v_exp_f32 v150, v150
    v_mfma_f32_16x16x32_bf16 v[136:139], a[144:147], a[0:3], 0
    v_fma_f32 v152, v152, s28, -v194
    v_cvt_pk_bf16_f32 v172, v148, v149
    v_mfma_f32_16x16x32_bf16 v[136:139], a[148:151], a[4:7], v[136:139]
    v_exp_f32 v151, v151
    v_mfma_f32_16x16x32_bf16 v[136:139], a[152:155], a[8:11], v[136:139]
    v_fma_f32 v153, v153, s28, -v194
    v_fma_f32 v154, v154, s28, -v194
    v_mfma_f32_16x16x32_bf16 v[136:139], a[156:159], a[12:15], v[136:139]
    v_exp_f32 v152, v152
    v_mfma_f32_16x16x32_bf16 v[140:143], a[144:147], a[16:19], 0
    v_exp_f32 v153, v153
    v_mfma_f32_16x16x32_bf16 v[140:143], a[148:151], a[20:23], v[140:143]
    v_cvt_pk_bf16_f32 v173, v150, v151
    v_fma_f32 v155, v155, s28, -v194
    v_mfma_f32_16x16x32_bf16 v[140:143], a[152:155], a[24:27], v[140:143]
    s_waitcnt vmcnt(8)
    s_barrier
    v_exp_f32 v154, v154
    v_mfma_f32_16x16x32_bf16 v[140:143], a[156:159], a[28:31], v[140:143]
    v_fma_f32 v156, v156, s28, -v195
    v_cvt_pk_bf16_f32 v170, v152, v153
    v_exp_f32 v155, v155
    s_nop 0
    v_cvt_pk_bf16_f32 v171, v154, v155
    s_nop 1
    v_mfma_f32_16x16x32_bf16 v[64:67], a[160:163], v[168:171], 0
    v_fma_f32 v157, v157, s28, -v195
    v_fma_f32 v158, v158, s28, -v195
    v_exp_f32 v156, v156
    v_exp_f32 v157, v157
    v_fma_f32 v159, v159, s28, -v195
    v_exp_f32 v158, v158
    v_exp_f32 v159, v159
    v_cvt_pk_bf16_f32 v174, v156, v157
    v_cvt_pk_bf16_f32 v175, v158, v159
    s_nop 1
    v_mfma_f32_16x16x32_bf16 v[96:99], a[160:163], v[172:175], 0
    ds_read_b64_tr_b16 a[160:161], v200 offset:8192
    v_fma_f32 v128, v128, s28, -v192
    v_mfma_f32_16x16x32_bf16 v[68:71], a[164:167], v[168:171], 0
    ds_read_b64_tr_b16 a[162:163], v200 offset:12288
    v_fma_f32 v129, v129, s28, -v192
    v_mfma_f32_16x16x32_bf16 v[100:103], a[164:167], v[172:175], 0
    ds_read_b64_tr_b16 a[164:165], v201 offset:8192
    v_fma_f32 v130, v130, s28, -v192
    v_mfma_f32_16x16x32_bf16 v[184:187], v[220:223], v[168:171], 0
    ds_read_b64_tr_b16 a[166:167], v201 offset:12288
    v_fma_f32 v131, v131, s28, -v192
    v_mfma_f32_16x16x32_bf16 v[72:75], a[168:171], v[168:171], 0
    v_exp_f32 v128, v128
    v_mfma_f32_16x16x32_bf16 v[188:191], v[220:223], v[172:175], 0
    v_exp_f32 v129, v129
    v_mfma_f32_16x16x32_bf16 v[104:107], a[168:171], v[172:175], 0
    ds_read_b64_tr_b16 a[168:169], v202 offset:8192
    v_fma_f32 v132, v132, s28, -v193
    v_mfma_f32_16x16x32_bf16 v[76:79], a[172:175], v[168:171], 0
    ds_read_b64_tr_b16 a[170:171], v202 offset:12288
    v_cvt_pk_bf16_f32 v160, v128, v129
    v_mfma_f32_16x16x32_bf16 v[108:111], a[172:175], v[172:175], 0
    ds_read_b64_tr_b16 a[172:173], v203 offset:8192
    v_fma_f32 v133, v133, s28, -v193
    v_mfma_f32_16x16x32_bf16 v[80:83], a[176:179], v[168:171], 0
    ds_read_b64_tr_b16 a[174:175], v203 offset:12288
    v_fma_f32 v134, v134, s28, -v193
    v_mfma_f32_16x16x32_bf16 v[112:115], a[176:179], v[172:175], 0
    ds_read_b64_tr_b16 a[176:177], v204 offset:8192
    v_fma_f32 v135, v135, s28, -v193
    v_mfma_f32_16x16x32_bf16 v[84:87], a[180:183], v[168:171], 0
    ds_read_b64_tr_b16 a[178:179], v204 offset:12288
    v_exp_f32 v130, v130
    v_mfma_f32_16x16x32_bf16 v[116:119], a[180:183], v[172:175], 0
    ds_read_b64_tr_b16 a[180:181], v205 offset:8192
    v_fma_f32 v136, v136, s28, -v192
    v_mfma_f32_16x16x32_bf16 v[88:91], a[184:187], v[168:171], 0
    ds_read_b64_tr_b16 a[182:183], v205 offset:12288
    v_exp_f32 v131, v131
    v_mfma_f32_16x16x32_bf16 v[120:123], a[184:187], v[172:175], 0
    ds_read_b64_tr_b16 a[184:185], v206 offset:8192
    v_cvt_pk_bf16_f32 v161, v130, v131
    v_mfma_f32_16x16x32_bf16 v[92:95], a[188:191], v[168:171], 0
    ds_read_b64_tr_b16 a[186:187], v206 offset:12288
    v_fma_f32 v137, v137, s28, -v192
    v_mfma_f32_16x16x32_bf16 v[124:127], a[188:191], v[172:175], 0
    ds_read_b64_tr_b16 a[188:189], v207 offset:8192
    v_exp_f32 v132, v132
    v_mfma_f32_16x16x32_bf16 v[144:147], a[128:131], a[32:35], 0
    ds_read_b64_tr_b16 a[190:191], v207 offset:12288
    v_fma_f32 v138, v138, s28, -v192
    v_mfma_f32_16x16x32_bf16 v[144:147], a[132:135], a[36:39], v[144:147]
    v_exp_f32 v133, v133
    v_mfma_f32_16x16x32_bf16 v[144:147], a[136:139], a[40:43], v[144:147]
    v_exp_f32 v134, v134
    v_mfma_f32_16x16x32_bf16 v[144:147], a[140:143], a[44:47], v[144:147]
    v_exp_f32 v135, v135
    v_mfma_f32_16x16x32_bf16 v[148:151], a[128:131], a[48:51], 0
    ds_read_b128 a[128:131], v196 offset:16384
    v_cvt_pk_bf16_f32 v164, v132, v133
    v_mfma_f32_16x16x32_bf16 v[148:151], a[132:135], a[52:55], v[148:151]
    ds_read_b128 a[132:135], v197 offset:16384
    v_cvt_pk_bf16_f32 v165, v134, v135
    v_mfma_f32_16x16x32_bf16 v[148:151], a[136:139], a[56:59], v[148:151]
    ds_read_b128 a[136:139], v198 offset:16384
    v_fma_f32 v139, v139, s28, -v192
    v_mfma_f32_16x16x32_bf16 v[148:151], a[140:143], a[60:63], v[148:151]
    ds_read_b128 a[140:143], v199 offset:16384
    v_fma_f32 v140, v140, s28, -v193
    v_mfma_f32_16x16x32_bf16 v[152:155], a[144:147], a[32:35], 0
    v_exp_f32 v136, v136
    v_mfma_f32_16x16x32_bf16 v[152:155], a[148:151], a[36:39], v[152:155]
    v_exp_f32 v137, v137
    v_mfma_f32_16x16x32_bf16 v[152:155], a[152:155], a[40:43], v[152:155]
    v_exp_f32 v138, v138
    v_mfma_f32_16x16x32_bf16 v[152:155], a[156:159], a[44:47], v[152:155]
    v_exp_f32 v139, v139
    v_mfma_f32_16x16x32_bf16 v[156:159], a[144:147], a[48:51], 0
    ds_read_b128 a[144:147], v196 offset:20480
    v_cvt_pk_bf16_f32 v162, v136, v137
    v_mfma_f32_16x16x32_bf16 v[156:159], a[148:151], a[52:55], v[156:159]
    ds_read_b128 a[148:151], v197 offset:20480
    v_fma_f32 v141, v141, s28, -v193
    v_mfma_f32_16x16x32_bf16 v[156:159], a[152:155], a[56:59], v[156:159]
    ds_read_b128 a[152:155], v198 offset:20480
    v_fma_f32 v142, v142, s28, -v193
    v_mfma_f32_16x16x32_bf16 v[156:159], a[156:159], a[60:63], v[156:159]
    s_waitcnt lgkmcnt(7)
    ds_read_b128 a[156:159], v199 offset:20480
    v_cvt_pk_bf16_f32 v163, v138, v139
    s_nop 1
    v_mfma_f32_16x16x32_bf16 v[0:3], a[160:163], v[160:163], v[0:3]
    v_exp_f32 v140, v140
    v_exp_f32 v141, v141
    v_fma_f32 v143, v143, s28, -v193
    v_exp_f32 v142, v142
    v_exp_f32 v143, v143
    v_cvt_pk_bf16_f32 v166, v140, v141
    v_cvt_pk_bf16_f32 v167, v142, v143
    s_nop 1
    v_mfma_f32_16x16x32_bf16 v[32:35], a[160:163], v[164:167], v[32:35]
    s_add_u32 m0, s34, 0x18000
    v_fma_f32 v144, v144, s28, -v194
    v_fma_f32 v145, v145, s28, -v194
    v_mfma_f32_16x16x32_bf16 v[4:7], a[164:167], v[160:163], v[4:7]
    buffer_load_dwordx4 v210, s[16:19], 0 offen nt lds
    buffer_load_dwordx4 v211, s[16:19], 0 offen offset:1024 nt lds
    v_mfma_f32_16x16x32_bf16 v[36:39], a[164:167], v[164:167], v[36:39]
    s_add_u32 s16, s16, 0x2000
    s_addc_u32 s17, s17, 0
    v_fma_f32 v146, v146, s28, -v194
    v_mfma_f32_16x16x32_bf16 v[176:179], v[220:223], v[160:163], v[176:179]
    v_exp_f32 v144, v144
    v_mfma_f32_16x16x32_bf16 v[8:11], a[168:171], v[160:163], v[8:11]
    v_exp_f32 v145, v145
    v_mfma_f32_16x16x32_bf16 v[180:183], v[220:223], v[164:167], v[180:183]
    s_add_u32 m0, s34, 0xa000
    v_fma_f32 v147, v147, s28, -v194
    v_fma_f32 v148, v148, s28, -v195
    v_mfma_f32_16x16x32_bf16 v[40:43], a[168:171], v[164:167], v[40:43]
    buffer_load_dwordx4 v208, s[12:15], 0 offen nt lds
    buffer_load_dwordx4 v209, s[12:15], 0 offen offset:1024 nt lds
    v_mfma_f32_16x16x32_bf16 v[12:15], a[172:175], v[160:163], v[12:15]
    s_add_u32 s12, s12, 0x2000
    s_addc_u32 s13, s13, 0
    v_cvt_pk_bf16_f32 v168, v144, v145
    v_mfma_f32_16x16x32_bf16 v[44:47], a[172:175], v[164:167], v[44:47]
    v_exp_f32 v146, v146
    v_mfma_f32_16x16x32_bf16 v[16:19], a[176:179], v[160:163], v[16:19]
    v_exp_f32 v147, v147
    v_mfma_f32_16x16x32_bf16 v[48:51], a[176:179], v[164:167], v[48:51]
    v_fma_f32 v149, v149, s28, -v195
    v_fma_f32 v150, v150, s28, -v195
    v_mfma_f32_16x16x32_bf16 v[20:23], a[180:183], v[160:163], v[20:23]
    v_exp_f32 v148, v148
    v_mfma_f32_16x16x32_bf16 v[52:55], a[180:183], v[164:167], v[52:55]
    v_exp_f32 v149, v149
    v_mfma_f32_16x16x32_bf16 v[24:27], a[184:187], v[160:163], v[24:27]
    v_cvt_pk_bf16_f32 v169, v146, v147
    v_fma_f32 v151, v151, s28, -v195
    v_mfma_f32_16x16x32_bf16 v[56:59], a[184:187], v[164:167], v[56:59]
    v_exp_f32 v150, v150
    v_mfma_f32_16x16x32_bf16 v[28:31], a[188:191], v[160:163], v[28:31]
    v_fma_f32 v152, v152, s28, -v194
    v_cvt_pk_bf16_f32 v172, v148, v149
    v_mfma_f32_16x16x32_bf16 v[60:63], a[188:191], v[164:167], v[60:63]
    s_waitcnt lgkmcnt(0)
    v_exp_f32 v151, v151
    v_mfma_f32_16x16x32_bf16 v[128:131], a[128:131], a[0:3], 0
    v_fma_f32 v153, v153, s28, -v194
    v_fma_f32 v154, v154, s28, -v194
    v_mfma_f32_16x16x32_bf16 v[128:131], a[132:135], a[4:7], v[128:131]
    v_exp_f32 v152, v152
    v_mfma_f32_16x16x32_bf16 v[128:131], a[136:139], a[8:11], v[128:131]
    v_exp_f32 v153, v153
    v_mfma_f32_16x16x32_bf16 v[128:131], a[140:143], a[12:15], v[128:131]
    v_cvt_pk_bf16_f32 v173, v150, v151
    v_fma_f32 v155, v155, s28, -v194
    v_mfma_f32_16x16x32_bf16 v[132:135], a[128:131], a[16:19], 0
    v_exp_f32 v154, v154
    v_mfma_f32_16x16x32_bf16 v[132:135], a[132:135], a[20:23], v[132:135]
    v_fma_f32 v156, v156, s28, -v195
    v_cvt_pk_bf16_f32 v170, v152, v153
    v_mfma_f32_16x16x32_bf16 v[132:135], a[136:139], a[24:27], v[132:135]
    v_exp_f32 v155, v155
    v_mfma_f32_16x16x32_bf16 v[132:135], a[140:143], a[28:31], v[132:135]
    v_fma_f32 v157, v157, s28, -v195
    v_fma_f32 v158, v158, s28, -v195
    v_mfma_f32_16x16x32_bf16 v[136:139], a[144:147], a[0:3], 0
    v_exp_f32 v156, v156
    v_mfma_f32_16x16x32_bf16 v[136:139], a[148:151], a[4:7], v[136:139]
    v_exp_f32 v157, v157
    v_mfma_f32_16x16x32_bf16 v[136:139], a[152:155], a[8:11], v[136:139]
    v_cvt_pk_bf16_f32 v171, v154, v155
    v_fma_f32 v159, v159, s28, -v195
    v_mfma_f32_16x16x32_bf16 v[136:139], a[156:159], a[12:15], v[136:139]
    v_exp_f32 v158, v158
    v_mfma_f32_16x16x32_bf16 v[140:143], a[144:147], a[16:19], 0
    v_exp_f32 v159, v159
    v_mfma_f32_16x16x32_bf16 v[140:143], a[148:151], a[20:23], v[140:143]
    v_cvt_pk_bf16_f32 v174, v156, v157
    v_cvt_pk_bf16_f32 v175, v158, v159
    v_mfma_f32_16x16x32_bf16 v[140:143], a[152:155], a[24:27], v[140:143]
    s_waitcnt vmcnt(4)
    s_barrier
    v_fma_f32 v128, v128, s28, -v192
    v_mfma_f32_16x16x32_bf16 v[140:143], a[156:159], a[28:31], v[140:143]
    v_fma_f32 v129, v129, s28, -v192
    v_fma_f32 v130, v130, s28, -v192
    v_mfma_f32_16x16x32_bf16 v[64:67], a[160:163], v[168:171], v[64:67]
    v_exp_f32 v128, v128
    v_mfma_f32_16x16x32_bf16 v[96:99], a[160:163], v[172:175], v[96:99]
    ds_read_b64_tr_b16 a[160:161], v200 offset:16384
    v_fma_f32 v131, v131, s28, -v192
    v_mfma_f32_16x16x32_bf16 v[68:71], a[164:167], v[168:171], v[68:71]
    ds_read_b64_tr_b16 a[162:163], v200 offset:20480
    v_fma_f32 v132, v132, s28, -v193
    v_mfma_f32_16x16x32_bf16 v[100:103], a[164:167], v[172:175], v[100:103]
    ds_read_b64_tr_b16 a[164:165], v201 offset:16384
    v_fma_f32 v133, v133, s28, -v193
    v_mfma_f32_16x16x32_bf16 v[184:187], v[220:223], v[168:171], v[184:187]
    ds_read_b64_tr_b16 a[166:167], v201 offset:20480
    v_fma_f32 v134, v134, s28, -v193
    v_mfma_f32_16x16x32_bf16 v[72:75], a[168:171], v[168:171], v[72:75]
    v_exp_f32 v129, v129
    v_mfma_f32_16x16x32_bf16 v[188:191], v[220:223], v[172:175], v[188:191]
    v_exp_f32 v130, v130
    v_mfma_f32_16x16x32_bf16 v[104:107], a[168:171], v[172:175], v[104:107]
    ds_read_b64_tr_b16 a[168:169], v202 offset:16384
    v_cvt_pk_bf16_f32 v160, v128, v129
    v_mfma_f32_16x16x32_bf16 v[76:79], a[172:175], v[168:171], v[76:79]
    ds_read_b64_tr_b16 a[170:171], v202 offset:20480
    v_fma_f32 v135, v135, s28, -v193
    v_mfma_f32_16x16x32_bf16 v[108:111], a[172:175], v[172:175], v[108:111]
    ds_read_b64_tr_b16 a[172:173], v203 offset:16384
    v_fma_f32 v136, v136, s28, -v192
    v_mfma_f32_16x16x32_bf16 v[80:83], a[176:179], v[168:171], v[80:83]
    ds_read_b64_tr_b16 a[174:175], v203 offset:20480
    v_exp_f32 v131, v131
    v_mfma_f32_16x16x32_bf16 v[112:115], a[176:179], v[172:175], v[112:115]
    ds_read_b64_tr_b16 a[176:177], v204 offset:16384
    v_cvt_pk_bf16_f32 v161, v130, v131
    v_mfma_f32_16x16x32_bf16 v[84:87], a[180:183], v[168:171], v[84:87]
    ds_read_b64_tr_b16 a[178:179], v204 offset:20480
    v_fma_f32 v137, v137, s28, -v192
    v_mfma_f32_16x16x32_bf16 v[116:119], a[180:183], v[172:175], v[116:119]
    ds_read_b64_tr_b16 a[180:181], v205 offset:16384
    v_exp_f32 v132, v132
    v_mfma_f32_16x16x32_bf16 v[88:91], a[184:187], v[168:171], v[88:91]
    ds_read_b64_tr_b16 a[182:183], v205 offset:20480
    v_fma_f32 v138, v138, s28, -v192
    v_mfma_f32_16x16x32_bf16 v[120:123], a[184:187], v[172:175], v[120:123]
    ds_read_b64_tr_b16 a[184:185], v206 offset:16384
    v_exp_f32 v133, v133
    v_mfma_f32_16x16x32_bf16 v[92:95], a[188:191], v[168:171], v[92:95]
    ds_read_b64_tr_b16 a[186:187], v206 offset:20480
    v_cvt_pk_bf16_f32 v164, v132, v133
    v_mfma_f32_16x16x32_bf16 v[124:127], a[188:191], v[172:175], v[124:127]
    ds_read_b64_tr_b16 a[188:189], v207 offset:16384
    v_fma_f32 v139, v139, s28, -v192
    v_mfma_f32_16x16x32_bf16 v[144:147], a[128:131], a[32:35], 0
    ds_read_b64_tr_b16 a[190:191], v207 offset:20480
    v_exp_f32 v134, v134
    v_mfma_f32_16x16x32_bf16 v[144:147], a[132:135], a[36:39], v[144:147]
    s_add_u32 m0, s34, 0x1a000
    s_nop 0
    buffer_load_dwordx4 v210, s[16:19], 0 offen nt lds
    buffer_load_dwordx4 v211, s[16:19], 0 offen offset:1024 nt lds
    s_add_u32 m0, s34, 0xc000
    s_nop 0
    buffer_load_dwordx4 v208, s[12:15], 0 offen nt lds
    buffer_load_dwordx4 v209, s[12:15], 0 offen offset:1024 nt lds
    v_mfma_f32_16x16x32_bf16 v[144:147], a[136:139], a[40:43], v[144:147]
    s_add_u32 s16, s16, 0x2000
    s_addc_u32 s17, s17, 0
    v_fma_f32 v140, v140, s28, -v193
    v_mfma_f32_16x16x32_bf16 v[144:147], a[140:143], a[44:47], v[144:147]
    s_add_u32 s12, s12, 0x2000
    s_addc_u32 s13, s13, 0
    v_exp_f32 v135, v135
    v_mfma_f32_16x16x32_bf16 v[148:151], a[128:131], a[48:51], 0
    ds_read_b128 a[128:131], v196 offset:24576
    v_cvt_pk_bf16_f32 v165, v134, v135
    v_mfma_f32_16x16x32_bf16 v[148:151], a[132:135], a[52:55], v[148:151]
    ds_read_b128 a[132:135], v197 offset:24576
    v_fma_f32 v141, v141, s28, -v193
    v_mfma_f32_16x16x32_bf16 v[148:151], a[136:139], a[56:59], v[148:151]
    ds_read_b128 a[136:139], v198 offset:24576
    v_exp_f32 v136, v136
    v_mfma_f32_16x16x32_bf16 v[148:151], a[140:143], a[60:63], v[148:151]
    ds_read_b128 a[140:143], v199 offset:24576
    v_fma_f32 v142, v142, s28, -v193
    v_mfma_f32_16x16x32_bf16 v[152:155], a[144:147], a[32:35], 0
    v_exp_f32 v137, v137
    v_mfma_f32_16x16x32_bf16 v[152:155], a[148:151], a[36:39], v[152:155]
    v_exp_f32 v138, v138
    v_mfma_f32_16x16x32_bf16 v[152:155], a[152:155], a[40:43], v[152:155]
    v_exp_f32 v139, v139
    v_mfma_f32_16x16x32_bf16 v[152:155], a[156:159], a[44:47], v[152:155]
    v_cvt_pk_bf16_f32 v162, v136, v137
    v_cvt_pk_bf16_f32 v163, v138, v139
    v_mfma_f32_16x16x32_bf16 v[156:159], a[144:147], a[48:51], 0
    ds_read_b128 a[144:147], v196 offset:28672
    v_fma_f32 v143, v143, s28, -v193
    v_mfma_f32_16x16x32_bf16 v[156:159], a[148:151], a[52:55], v[156:159]
    ds_read_b128 a[148:151], v197 offset:28672
    v_exp_f32 v140, v140
    v_mfma_f32_16x16x32_bf16 v[156:159], a[152:155], a[56:59], v[156:159]
    ds_read_b128 a[152:155], v198 offset:28672
    v_fma_f32 v144, v144, s28, -v194
    v_mfma_f32_16x16x32_bf16 v[156:159], a[156:159], a[60:63], v[156:159]
    s_waitcnt lgkmcnt(7)
    ds_read_b128 a[156:159], v199 offset:28672
    v_fma_f32 v145, v145, s28, -v194
    v_mfma_f32_16x16x32_bf16 v[0:3], a[160:163], v[160:163], v[0:3]
    v_exp_f32 v141, v141
    v_exp_f32 v142, v142
    v_exp_f32 v143, v143
    v_cvt_pk_bf16_f32 v166, v140, v141
    v_cvt_pk_bf16_f32 v167, v142, v143
    s_nop 1
    v_mfma_f32_16x16x32_bf16 v[32:35], a[160:163], v[164:167], v[32:35]
    s_add_u32 m0, s34, 0x1c000
    v_exp_f32 v144, v144
    v_mfma_f32_16x16x32_bf16 v[4:7], a[164:167], v[160:163], v[4:7]
    buffer_load_dwordx4 v210, s[16:19], 0 offen nt lds
    buffer_load_dwordx4 v211, s[16:19], 0 offen offset:1024 nt lds
    v_mfma_f32_16x16x32_bf16 v[36:39], a[164:167], v[164:167], v[36:39]
    s_add_u32 s16, s16, 0x2000
    v_fma_f32 v146, v146, s28, -v194
    v_fma_f32 v147, v147, s28, -v194
    v_mfma_f32_16x16x32_bf16 v[176:179], v[220:223], v[160:163], v[176:179]
    s_addc_u32 s17, s17, 0
    v_exp_f32 v145, v145
    v_mfma_f32_16x16x32_bf16 v[8:11], a[168:171], v[160:163], v[8:11]
    v_exp_f32 v146, v146
    v_mfma_f32_16x16x32_bf16 v[180:183], v[220:223], v[164:167], v[180:183]
    s_add_u32 m0, s34, 0xe000
    v_fma_f32 v148, v148, s28, -v195
    v_cvt_pk_bf16_f32 v168, v144, v145
    v_mfma_f32_16x16x32_bf16 v[40:43], a[168:171], v[164:167], v[40:43]
    buffer_load_dwordx4 v208, s[12:15], 0 offen nt lds
    buffer_load_dwordx4 v209, s[12:15], 0 offen offset:1024 nt lds
    v_mfma_f32_16x16x32_bf16 v[12:15], a[172:175], v[160:163], v[12:15]
    s_add_u32 s12, s12, 0x2000
    v_exp_f32 v147, v147
    v_mfma_f32_16x16x32_bf16 v[44:47], a[172:175], v[164:167], v[44:47]
    s_addc_u32 s13, s13, 0
    v_fma_f32 v149, v149, s28, -v195
    v_fma_f32 v150, v150, s28, -v195
    v_mfma_f32_16x16x32_bf16 v[16:19], a[176:179], v[160:163], v[16:19]
    v_exp_f32 v148, v148
    v_mfma_f32_16x16x32_bf16 v[48:51], a[176:179], v[164:167], v[48:51]
    v_exp_f32 v149, v149
    v_mfma_f32_16x16x32_bf16 v[20:23], a[180:183], v[160:163], v[20:23]
    v_cvt_pk_bf16_f32 v169, v146, v147
    v_fma_f32 v151, v151, s28, -v195
    v_mfma_f32_16x16x32_bf16 v[52:55], a[180:183], v[164:167], v[52:55]
    v_exp_f32 v150, v150
    v_mfma_f32_16x16x32_bf16 v[24:27], a[184:187], v[160:163], v[24:27]
    v_fma_f32 v152, v152, s28, -v194
    v_cvt_pk_bf16_f32 v172, v148, v149
    v_mfma_f32_16x16x32_bf16 v[56:59], a[184:187], v[164:167], v[56:59]
    v_exp_f32 v151, v151
    v_mfma_f32_16x16x32_bf16 v[28:31], a[188:191], v[160:163], v[28:31]
    v_fma_f32 v153, v153, s28, -v194
    v_fma_f32 v154, v154, s28, -v194
    v_mfma_f32_16x16x32_bf16 v[60:63], a[188:191], v[164:167], v[60:63]
    s_waitcnt lgkmcnt(0)
    v_exp_f32 v152, v152
    v_mfma_f32_16x16x32_bf16 v[128:131], a[128:131], a[0:3], 0
    v_exp_f32 v153, v153
    v_mfma_f32_16x16x32_bf16 v[128:131], a[132:135], a[4:7], v[128:131]
    v_cvt_pk_bf16_f32 v173, v150, v151
    v_fma_f32 v155, v155, s28, -v194
    v_mfma_f32_16x16x32_bf16 v[128:131], a[136:139], a[8:11], v[128:131]
    v_exp_f32 v154, v154
    v_mfma_f32_16x16x32_bf16 v[128:131], a[140:143], a[12:15], v[128:131]
    v_fma_f32 v156, v156, s28, -v195
    v_cvt_pk_bf16_f32 v170, v152, v153
    v_mfma_f32_16x16x32_bf16 v[132:135], a[128:131], a[16:19], 0
    v_exp_f32 v155, v155
    v_mfma_f32_16x16x32_bf16 v[132:135], a[132:135], a[20:23], v[132:135]
    v_fma_f32 v157, v157, s28, -v195
    v_fma_f32 v158, v158, s28, -v195
    v_mfma_f32_16x16x32_bf16 v[132:135], a[136:139], a[24:27], v[132:135]
    v_exp_f32 v156, v156
    v_mfma_f32_16x16x32_bf16 v[132:135], a[140:143], a[28:31], v[132:135]
    v_exp_f32 v157, v157
    v_mfma_f32_16x16x32_bf16 v[136:139], a[144:147], a[0:3], 0
    v_cvt_pk_bf16_f32 v171, v154, v155
    v_fma_f32 v159, v159, s28, -v195
    v_mfma_f32_16x16x32_bf16 v[136:139], a[148:151], a[4:7], v[136:139]
    v_exp_f32 v158, v158
    v_mfma_f32_16x16x32_bf16 v[136:139], a[152:155], a[8:11], v[136:139]
    v_exp_f32 v159, v159
    v_mfma_f32_16x16x32_bf16 v[136:139], a[156:159], a[12:15], v[136:139]
    v_cvt_pk_bf16_f32 v174, v156, v157
    v_cvt_pk_bf16_f32 v175, v158, v159
    v_mfma_f32_16x16x32_bf16 v[140:143], a[144:147], a[16:19], 0
    v_fma_f32 v128, v128, s28, -v192
    v_fma_f32 v129, v129, s28, -v192
    v_mfma_f32_16x16x32_bf16 v[140:143], a[148:151], a[20:23], v[140:143]
    v_exp_f32 v128, v128
    v_mfma_f32_16x16x32_bf16 v[140:143], a[152:155], a[24:27], v[140:143]
    v_fma_f32 v130, v130, s28, -v192
    v_fma_f32 v131, v131, s28, -v192
    v_mfma_f32_16x16x32_bf16 v[140:143], a[156:159], a[28:31], v[140:143]
    v_exp_f32 v129, v129
    v_mfma_f32_16x16x32_bf16 v[64:67], a[160:163], v[168:171], v[64:67]
    v_exp_f32 v130, v130
    v_mfma_f32_16x16x32_bf16 v[96:99], a[160:163], v[172:175], v[96:99]
    ds_read_b64_tr_b16 a[160:161], v200 offset:24576
    v_fma_f32 v132, v132, s28, -v193
    v_mfma_f32_16x16x32_bf16 v[68:71], a[164:167], v[168:171], v[68:71]
    ds_read_b64_tr_b16 a[162:163], v200 offset:28672
    v_cvt_pk_bf16_f32 v160, v128, v129
    v_mfma_f32_16x16x32_bf16 v[100:103], a[164:167], v[172:175], v[100:103]
    ds_read_b64_tr_b16 a[164:165], v201 offset:24576
    v_fma_f32 v133, v133, s28, -v193
    v_mfma_f32_16x16x32_bf16 v[184:187], v[220:223], v[168:171], v[184:187]
    ds_read_b64_tr_b16 a[166:167], v201 offset:28672
    v_fma_f32 v134, v134, s28, -v193
    v_mfma_f32_16x16x32_bf16 v[72:75], a[168:171], v[168:171], v[72:75]
    v_exp_f32 v131, v131
    v_mfma_f32_16x16x32_bf16 v[188:191], v[220:223], v[172:175], v[188:191]
    v_exp_f32 v132, v132
    v_mfma_f32_16x16x32_bf16 v[104:107], a[168:171], v[172:175], v[104:107]
    ds_read_b64_tr_b16 a[168:169], v202 offset:24576
    v_cvt_pk_bf16_f32 v161, v130, v131
    v_mfma_f32_16x16x32_bf16 v[76:79], a[172:175], v[168:171], v[76:79]
    ds_read_b64_tr_b16 a[170:171], v202 offset:28672
    v_fma_f32 v135, v135, s28, -v193
    v_mfma_f32_16x16x32_bf16 v[108:111], a[172:175], v[172:175], v[108:111]
    ds_read_b64_tr_b16 a[172:173], v203 offset:24576
    v_fma_f32 v136, v136, s28, -v192
    v_mfma_f32_16x16x32_bf16 v[80:83], a[176:179], v[168:171], v[80:83]
    ds_read_b64_tr_b16 a[174:175], v203 offset:28672
    v_fma_f32 v137, v137, s28, -v192
    v_mfma_f32_16x16x32_bf16 v[112:115], a[176:179], v[172:175], v[112:115]
    ds_read_b64_tr_b16 a[176:177], v204 offset:24576
    v_fma_f32 v138, v138, s28, -v192
    v_mfma_f32_16x16x32_bf16 v[84:87], a[180:183], v[168:171], v[84:87]
    ds_read_b64_tr_b16 a[178:179], v204 offset:28672
    v_exp_f32 v133, v133
    v_mfma_f32_16x16x32_bf16 v[116:119], a[180:183], v[172:175], v[116:119]
    ds_read_b64_tr_b16 a[180:181], v205 offset:24576
    v_cvt_pk_bf16_f32 v164, v132, v133
    v_mfma_f32_16x16x32_bf16 v[88:91], a[184:187], v[168:171], v[88:91]
    ds_read_b64_tr_b16 a[182:183], v205 offset:28672
    v_fma_f32 v139, v139, s28, -v192
    v_mfma_f32_16x16x32_bf16 v[120:123], a[184:187], v[172:175], v[120:123]
    ds_read_b64_tr_b16 a[184:185], v206 offset:24576
    v_exp_f32 v134, v134
    v_mfma_f32_16x16x32_bf16 v[92:95], a[188:191], v[168:171], v[92:95]
    ds_read_b64_tr_b16 a[186:187], v206 offset:28672
    v_fma_f32 v140, v140, s28, -v193
    v_mfma_f32_16x16x32_bf16 v[124:127], a[188:191], v[172:175], v[124:127]
    ds_read_b64_tr_b16 a[188:189], v207 offset:24576
    v_exp_f32 v135, v135
    v_mfma_f32_16x16x32_bf16 v[144:147], a[128:131], a[32:35], 0
    ds_read_b64_tr_b16 a[190:191], v207 offset:28672
    v_cvt_pk_bf16_f32 v165, v134, v135
    v_mfma_f32_16x16x32_bf16 v[144:147], a[132:135], a[36:39], v[144:147]
    s_add_u32 m0, s34, 0x1e000
    s_nop 0
    buffer_load_dwordx4 v210, s[16:19], 0 offen nt lds
    buffer_load_dwordx4 v211, s[16:19], 0 offen offset:1024 nt lds
    s_add_u32 m0, s34, 0
    s_nop 0
    buffer_load_dwordx4 v208, s[12:15], 0 offen nt lds
    buffer_load_dwordx4 v209, s[12:15], 0 offen offset:1024 nt lds
    v_mfma_f32_16x16x32_bf16 v[144:147], a[136:139], a[40:43], v[144:147]
    s_add_u32 s16, s16, 0x2000
    s_addc_u32 s17, s17, 0
    v_fma_f32 v141, v141, s28, -v193
    v_mfma_f32_16x16x32_bf16 v[144:147], a[140:143], a[44:47], v[144:147]
    s_add_u32 s12, s12, 0x2000
    s_addc_u32 s13, s13, 0
    v_exp_f32 v136, v136
    v_mfma_f32_16x16x32_bf16 v[148:151], a[128:131], a[48:51], 0
    ds_read_b128 a[128:131], v196 offset:32768
    v_fma_f32 v142, v142, s28, -v193
    v_mfma_f32_16x16x32_bf16 v[148:151], a[132:135], a[52:55], v[148:151]
    ds_read_b128 a[132:135], v197 offset:32768
    v_exp_f32 v137, v137
    v_mfma_f32_16x16x32_bf16 v[148:151], a[136:139], a[56:59], v[148:151]
    ds_read_b128 a[136:139], v198 offset:32768
    v_cvt_pk_bf16_f32 v162, v136, v137
    v_mfma_f32_16x16x32_bf16 v[148:151], a[140:143], a[60:63], v[148:151]
    ds_read_b128 a[140:143], v199 offset:32768
    v_fma_f32 v143, v143, s28, -v193
    v_mfma_f32_16x16x32_bf16 v[152:155], a[144:147], a[32:35], 0
    v_exp_f32 v138, v138
    v_mfma_f32_16x16x32_bf16 v[152:155], a[148:151], a[36:39], v[152:155]
    v_exp_f32 v139, v139
    v_mfma_f32_16x16x32_bf16 v[152:155], a[152:155], a[40:43], v[152:155]
    v_exp_f32 v140, v140
    v_mfma_f32_16x16x32_bf16 v[152:155], a[156:159], a[44:47], v[152:155]
    v_exp_f32 v141, v141
    v_mfma_f32_16x16x32_bf16 v[156:159], a[144:147], a[48:51], 0
    ds_read_b128 a[144:147], v196 offset:36864
    v_cvt_pk_bf16_f32 v163, v138, v139
    v_mfma_f32_16x16x32_bf16 v[156:159], a[148:151], a[52:55], v[156:159]
    ds_read_b128 a[148:151], v197 offset:36864
    v_cvt_pk_bf16_f32 v166, v140, v141
    v_mfma_f32_16x16x32_bf16 v[156:159], a[152:155], a[56:59], v[156:159]
    ds_read_b128 a[152:155], v198 offset:36864
    v_fma_f32 v144, v144, s28, -v194
    v_mfma_f32_16x16x32_bf16 v[156:159], a[156:159], a[60:63], v[156:159]
    s_waitcnt lgkmcnt(7)
    ds_read_b128 a[156:159], v199 offset:36864
    v_fma_f32 v145, v145, s28, -v194
    v_mfma_f32_16x16x32_bf16 v[0:3], a[160:163], v[160:163], v[0:3]
    v_exp_f32 v142, v142
    v_exp_f32 v143, v143
    s_nop 0
    v_cvt_pk_bf16_f32 v167, v142, v143
    s_nop 1
    v_mfma_f32_16x16x32_bf16 v[32:35], a[160:163], v[164:167], v[32:35]
    s_add_u32 m0, s34, 0x10000
    v_exp_f32 v144, v144
    v_mfma_f32_16x16x32_bf16 v[4:7], a[164:167], v[160:163], v[4:7]
    buffer_load_dwordx4 v210, s[16:19], 0 offen nt lds
    buffer_load_dwordx4 v211, s[16:19], 0 offen offset:1024 nt lds
    v_mfma_f32_16x16x32_bf16 v[36:39], a[164:167], v[164:167], v[36:39]
    s_add_u32 s16, s16, 0x2000
    v_fma_f32 v146, v146, s28, -v194
    v_fma_f32 v147, v147, s28, -v194
    v_mfma_f32_16x16x32_bf16 v[176:179], v[220:223], v[160:163], v[176:179]
    s_addc_u32 s17, s17, 0
    v_exp_f32 v145, v145
    v_mfma_f32_16x16x32_bf16 v[8:11], a[168:171], v[160:163], v[8:11]
    v_exp_f32 v146, v146
    v_mfma_f32_16x16x32_bf16 v[180:183], v[220:223], v[164:167], v[180:183]
    s_add_u32 m0, s34, 0x2000
    v_fma_f32 v148, v148, s28, -v195
    v_cvt_pk_bf16_f32 v168, v144, v145
    v_mfma_f32_16x16x32_bf16 v[40:43], a[168:171], v[164:167], v[40:43]
    buffer_load_dwordx4 v208, s[12:15], 0 offen nt lds
    buffer_load_dwordx4 v209, s[12:15], 0 offen offset:1024 nt lds
    v_mfma_f32_16x16x32_bf16 v[12:15], a[172:175], v[160:163], v[12:15]
    s_add_u32 s12, s12, 0x2000
    v_exp_f32 v147, v147
    v_mfma_f32_16x16x32_bf16 v[44:47], a[172:175], v[164:167], v[44:47]
    s_addc_u32 s13, s13, 0
    v_fma_f32 v149, v149, s28, -v195
    v_fma_f32 v150, v150, s28, -v195
    v_mfma_f32_16x16x32_bf16 v[16:19], a[176:179], v[160:163], v[16:19]
    v_exp_f32 v148, v148
    v_mfma_f32_16x16x32_bf16 v[48:51], a[176:179], v[164:167], v[48:51]
    v_exp_f32 v149, v149
    v_mfma_f32_16x16x32_bf16 v[20:23], a[180:183], v[160:163], v[20:23]
    v_cvt_pk_bf16_f32 v169, v146, v147
    v_fma_f32 v151, v151, s28, -v195
    v_mfma_f32_16x16x32_bf16 v[52:55], a[180:183], v[164:167], v[52:55]
    v_exp_f32 v150, v150
    v_mfma_f32_16x16x32_bf16 v[24:27], a[184:187], v[160:163], v[24:27]
    v_fma_f32 v152, v152, s28, -v194
    v_cvt_pk_bf16_f32 v172, v148, v149
    v_mfma_f32_16x16x32_bf16 v[56:59], a[184:187], v[164:167], v[56:59]
    v_exp_f32 v151, v151
    v_mfma_f32_16x16x32_bf16 v[28:31], a[188:191], v[160:163], v[28:31]
    v_fma_f32 v153, v153, s28, -v194
    v_fma_f32 v154, v154, s28, -v194
    v_mfma_f32_16x16x32_bf16 v[60:63], a[188:191], v[164:167], v[60:63]
    s_waitcnt lgkmcnt(0)
    v_exp_f32 v152, v152
    v_mfma_f32_16x16x32_bf16 v[128:131], a[128:131], a[0:3], 0
    v_exp_f32 v153, v153
    v_mfma_f32_16x16x32_bf16 v[128:131], a[132:135], a[4:7], v[128:131]
    v_cvt_pk_bf16_f32 v173, v150, v151
    v_fma_f32 v155, v155, s28, -v194
    v_mfma_f32_16x16x32_bf16 v[128:131], a[136:139], a[8:11], v[128:131]
    v_exp_f32 v154, v154
    v_mfma_f32_16x16x32_bf16 v[128:131], a[140:143], a[12:15], v[128:131]
    v_fma_f32 v156, v156, s28, -v195
    v_cvt_pk_bf16_f32 v170, v152, v153
    v_mfma_f32_16x16x32_bf16 v[132:135], a[128:131], a[16:19], 0
    v_exp_f32 v155, v155
    v_mfma_f32_16x16x32_bf16 v[132:135], a[132:135], a[20:23], v[132:135]
    v_fma_f32 v157, v157, s28, -v195
    v_fma_f32 v158, v158, s28, -v195
    v_mfma_f32_16x16x32_bf16 v[132:135], a[136:139], a[24:27], v[132:135]
    v_exp_f32 v156, v156
    v_mfma_f32_16x16x32_bf16 v[132:135], a[140:143], a[28:31], v[132:135]
    v_exp_f32 v157, v157
    v_mfma_f32_16x16x32_bf16 v[136:139], a[144:147], a[0:3], 0
    v_cvt_pk_bf16_f32 v171, v154, v155
    v_fma_f32 v159, v159, s28, -v195
    v_mfma_f32_16x16x32_bf16 v[136:139], a[148:151], a[4:7], v[136:139]
    v_exp_f32 v158, v158
    v_mfma_f32_16x16x32_bf16 v[136:139], a[152:155], a[8:11], v[136:139]
    v_exp_f32 v159, v159
    v_mfma_f32_16x16x32_bf16 v[136:139], a[156:159], a[12:15], v[136:139]
    v_cvt_pk_bf16_f32 v174, v156, v157
    v_cvt_pk_bf16_f32 v175, v158, v159
    v_mfma_f32_16x16x32_bf16 v[140:143], a[144:147], a[16:19], 0
    v_fma_f32 v128, v128, s28, -v192
    v_fma_f32 v129, v129, s28, -v192
    v_mfma_f32_16x16x32_bf16 v[140:143], a[148:151], a[20:23], v[140:143]
    v_exp_f32 v128, v128
    v_mfma_f32_16x16x32_bf16 v[140:143], a[152:155], a[24:27], v[140:143]
    s_waitcnt vmcnt(12)
    s_barrier
    v_fma_f32 v130, v130, s28, -v192
    v_mfma_f32_16x16x32_bf16 v[140:143], a[156:159], a[28:31], v[140:143]
    v_exp_f32 v129, v129
    v_mfma_f32_16x16x32_bf16 v[64:67], a[160:163], v[168:171], v[64:67]
    v_fma_f32 v131, v131, s28, -v192
    v_fma_f32 v132, v132, s28, -v193
    v_mfma_f32_16x16x32_bf16 v[96:99], a[160:163], v[172:175], v[96:99]
    ds_read_b64_tr_b16 a[160:161], v200 offset:32768
    v_cvt_pk_bf16_f32 v160, v128, v129
    v_mfma_f32_16x16x32_bf16 v[68:71], a[164:167], v[168:171], v[68:71]
    ds_read_b64_tr_b16 a[162:163], v200 offset:36864
    v_fma_f32 v133, v133, s28, -v193
    v_mfma_f32_16x16x32_bf16 v[100:103], a[164:167], v[172:175], v[100:103]
    ds_read_b64_tr_b16 a[164:165], v201 offset:32768
    v_fma_f32 v134, v134, s28, -v193
    v_mfma_f32_16x16x32_bf16 v[184:187], v[220:223], v[168:171], v[184:187]
    ds_read_b64_tr_b16 a[166:167], v201 offset:36864
    v_fma_f32 v135, v135, s28, -v193
    v_mfma_f32_16x16x32_bf16 v[72:75], a[168:171], v[168:171], v[72:75]
    v_exp_f32 v130, v130
    v_mfma_f32_16x16x32_bf16 v[188:191], v[220:223], v[172:175], v[188:191]
    v_exp_f32 v131, v131
    v_mfma_f32_16x16x32_bf16 v[104:107], a[168:171], v[172:175], v[104:107]
    ds_read_b64_tr_b16 a[168:169], v202 offset:32768
    v_cvt_pk_bf16_f32 v161, v130, v131
    v_mfma_f32_16x16x32_bf16 v[76:79], a[172:175], v[168:171], v[76:79]
    ds_read_b64_tr_b16 a[170:171], v202 offset:36864
    v_fma_f32 v136, v136, s28, -v192
    v_mfma_f32_16x16x32_bf16 v[108:111], a[172:175], v[172:175], v[108:111]
    ds_read_b64_tr_b16 a[172:173], v203 offset:32768
    v_fma_f32 v137, v137, s28, -v192
    v_mfma_f32_16x16x32_bf16 v[80:83], a[176:179], v[168:171], v[80:83]
    ds_read_b64_tr_b16 a[174:175], v203 offset:36864
    v_exp_f32 v132, v132
    v_mfma_f32_16x16x32_bf16 v[112:115], a[176:179], v[172:175], v[112:115]
    ds_read_b64_tr_b16 a[176:177], v204 offset:32768
    v_fma_f32 v138, v138, s28, -v192
    v_mfma_f32_16x16x32_bf16 v[84:87], a[180:183], v[168:171], v[84:87]
    ds_read_b64_tr_b16 a[178:179], v204 offset:36864
    v_exp_f32 v133, v133
    v_mfma_f32_16x16x32_bf16 v[116:119], a[180:183], v[172:175], v[116:119]
    ds_read_b64_tr_b16 a[180:181], v205 offset:32768
    v_cvt_pk_bf16_f32 v164, v132, v133
    v_mfma_f32_16x16x32_bf16 v[88:91], a[184:187], v[168:171], v[88:91]
    ds_read_b64_tr_b16 a[182:183], v205 offset:36864
    v_fma_f32 v139, v139, s28, -v192
    v_mfma_f32_16x16x32_bf16 v[120:123], a[184:187], v[172:175], v[120:123]
    ds_read_b64_tr_b16 a[184:185], v206 offset:32768
    v_exp_f32 v134, v134
    v_mfma_f32_16x16x32_bf16 v[92:95], a[188:191], v[168:171], v[92:95]
    ds_read_b64_tr_b16 a[186:187], v206 offset:36864
    v_fma_f32 v140, v140, s28, -v193
    v_mfma_f32_16x16x32_bf16 v[124:127], a[188:191], v[172:175], v[124:127]
    ds_read_b64_tr_b16 a[188:189], v207 offset:32768
    v_exp_f32 v135, v135
    v_mfma_f32_16x16x32_bf16 v[144:147], a[128:131], a[32:35], 0
    ds_read_b64_tr_b16 a[190:191], v207 offset:36864
    v_cvt_pk_bf16_f32 v165, v134, v135
    v_mfma_f32_16x16x32_bf16 v[144:147], a[132:135], a[36:39], v[144:147]
    s_add_u32 m0, s34, 0x12000
    s_nop 0
    buffer_load_dwordx4 v210, s[16:19], 0 offen nt lds
    buffer_load_dwordx4 v211, s[16:19], 0 offen offset:1024 nt lds
    s_add_u32 m0, s34, 0x4000
    s_nop 0
    buffer_load_dwordx4 v208, s[12:15], 0 offen nt lds
    buffer_load_dwordx4 v209, s[12:15], 0 offen offset:1024 nt lds
    v_mfma_f32_16x16x32_bf16 v[144:147], a[136:139], a[40:43], v[144:147]
    s_add_u32 s16, s16, 0x2000
    s_addc_u32 s17, s17, 0
    v_fma_f32 v141, v141, s28, -v193
    v_mfma_f32_16x16x32_bf16 v[144:147], a[140:143], a[44:47], v[144:147]
    s_add_u32 s12, s12, 0x2000
    s_addc_u32 s13, s13, 0
    v_exp_f32 v136, v136
    v_mfma_f32_16x16x32_bf16 v[148:151], a[128:131], a[48:51], 0
    ds_read_b128 a[128:131], v196 offset:40960
    v_fma_f32 v142, v142, s28, -v193
    v_mfma_f32_16x16x32_bf16 v[148:151], a[132:135], a[52:55], v[148:151]
    ds_read_b128 a[132:135], v197 offset:40960
    v_exp_f32 v137, v137
    v_mfma_f32_16x16x32_bf16 v[148:151], a[136:139], a[56:59], v[148:151]
    ds_read_b128 a[136:139], v198 offset:40960
    v_cvt_pk_bf16_f32 v162, v136, v137
    v_mfma_f32_16x16x32_bf16 v[148:151], a[140:143], a[60:63], v[148:151]
    ds_read_b128 a[140:143], v199 offset:40960
    v_fma_f32 v143, v143, s28, -v193
    v_mfma_f32_16x16x32_bf16 v[152:155], a[144:147], a[32:35], 0
    v_exp_f32 v138, v138
    v_mfma_f32_16x16x32_bf16 v[152:155], a[148:151], a[36:39], v[152:155]
    v_exp_f32 v139, v139
    v_mfma_f32_16x16x32_bf16 v[152:155], a[152:155], a[40:43], v[152:155]
    v_exp_f32 v140, v140
    v_mfma_f32_16x16x32_bf16 v[152:155], a[156:159], a[44:47], v[152:155]
    v_exp_f32 v141, v141
    v_mfma_f32_16x16x32_bf16 v[156:159], a[144:147], a[48:51], 0
    ds_read_b128 a[144:147], v196 offset:45056
    v_cvt_pk_bf16_f32 v163, v138, v139
    v_mfma_f32_16x16x32_bf16 v[156:159], a[148:151], a[52:55], v[156:159]
    ds_read_b128 a[148:151], v197 offset:45056
    v_cvt_pk_bf16_f32 v166, v140, v141
    v_mfma_f32_16x16x32_bf16 v[156:159], a[152:155], a[56:59], v[156:159]
    ds_read_b128 a[152:155], v198 offset:45056
    v_fma_f32 v144, v144, s28, -v194
    v_mfma_f32_16x16x32_bf16 v[156:159], a[156:159], a[60:63], v[156:159]
    s_waitcnt lgkmcnt(7)
    ds_read_b128 a[156:159], v199 offset:45056
    v_fma_f32 v145, v145, s28, -v194
    v_mfma_f32_16x16x32_bf16 v[0:3], a[160:163], v[160:163], v[0:3]
    v_exp_f32 v142, v142
    v_exp_f32 v143, v143
    s_nop 0
    v_cvt_pk_bf16_f32 v167, v142, v143
    s_nop 1
    v_mfma_f32_16x16x32_bf16 v[32:35], a[160:163], v[164:167], v[32:35]
    s_add_u32 m0, s34, 0x14000
    v_exp_f32 v144, v144
    v_mfma_f32_16x16x32_bf16 v[4:7], a[164:167], v[160:163], v[4:7]
    buffer_load_dwordx4 v210, s[16:19], 0 offen nt lds
    buffer_load_dwordx4 v211, s[16:19], 0 offen offset:1024 nt lds
    v_mfma_f32_16x16x32_bf16 v[36:39], a[164:167], v[164:167], v[36:39]
    s_add_u32 s16, s16, 0x2000
    v_fma_f32 v146, v146, s28, -v194
    v_fma_f32 v147, v147, s28, -v194
    v_mfma_f32_16x16x32_bf16 v[176:179], v[220:223], v[160:163], v[176:179]
    s_addc_u32 s17, s17, 0
    v_exp_f32 v145, v145
    v_mfma_f32_16x16x32_bf16 v[8:11], a[168:171], v[160:163], v[8:11]
    v_exp_f32 v146, v146
    v_mfma_f32_16x16x32_bf16 v[180:183], v[220:223], v[164:167], v[180:183]
    s_add_u32 m0, s34, 0x6000
    v_fma_f32 v148, v148, s28, -v195
    v_cvt_pk_bf16_f32 v168, v144, v145
    v_mfma_f32_16x16x32_bf16 v[40:43], a[168:171], v[164:167], v[40:43]
    buffer_load_dwordx4 v208, s[12:15], 0 offen nt lds
    buffer_load_dwordx4 v209, s[12:15], 0 offen offset:1024 nt lds
    v_mfma_f32_16x16x32_bf16 v[12:15], a[172:175], v[160:163], v[12:15]
    s_add_u32 s12, s12, 0x2000
    v_exp_f32 v147, v147
    v_mfma_f32_16x16x32_bf16 v[44:47], a[172:175], v[164:167], v[44:47]
    s_addc_u32 s13, s13, 0
    v_fma_f32 v149, v149, s28, -v195
    v_fma_f32 v150, v150, s28, -v195
    v_mfma_f32_16x16x32_bf16 v[16:19], a[176:179], v[160:163], v[16:19]
    v_exp_f32 v148, v148
    v_mfma_f32_16x16x32_bf16 v[48:51], a[176:179], v[164:167], v[48:51]
    v_exp_f32 v149, v149
    v_mfma_f32_16x16x32_bf16 v[20:23], a[180:183], v[160:163], v[20:23]
    v_cvt_pk_bf16_f32 v169, v146, v147
    v_fma_f32 v151, v151, s28, -v195
    v_mfma_f32_16x16x32_bf16 v[52:55], a[180:183], v[164:167], v[52:55]
    v_exp_f32 v150, v150
    v_mfma_f32_16x16x32_bf16 v[24:27], a[184:187], v[160:163], v[24:27]
    v_fma_f32 v152, v152, s28, -v194
    v_cvt_pk_bf16_f32 v172, v148, v149
    v_mfma_f32_16x16x32_bf16 v[56:59], a[184:187], v[164:167], v[56:59]
    v_exp_f32 v151, v151
    v_mfma_f32_16x16x32_bf16 v[28:31], a[188:191], v[160:163], v[28:31]
    v_fma_f32 v153, v153, s28, -v194
    v_fma_f32 v154, v154, s28, -v194
    v_exp_f32 v152, v152
    v_exp_f32 v153, v153
    v_mfma_f32_16x16x32_bf16 v[60:63], a[188:191], v[164:167], v[60:63]
    s_waitcnt lgkmcnt(0)
    s_branch L_join
L_loop:
    s_waitcnt lgkmcnt(8)
    v_mfma_f32_16x16x32_bf16 v[128:131], a[128:131], a[0:3], 0
    v_fma_f32 v144, v144, s28, -v194
    v_fma_f32 v145, v145, s28, -v194
    v_mfma_f32_16x16x32_bf16 v[128:131], a[132:135], a[4:7], v[128:131]
    v_exp_f32 v144, v144
    v_mfma_f32_16x16x32_bf16 v[128:131], a[136:139], a[8:11], v[128:131]
    s_waitcnt lgkmcnt(0)
    v_fma_f32 v146, v146, s28, -v194
    v_fma_f32 v147, v147, s28, -v194
    v_mfma_f32_16x16x32_bf16 v[128:131], a[140:143], a[12:15], v[128:131]
    v_exp_f32 v145, v145
    v_mfma_f32_16x16x32_bf16 v[132:135], a[128:131], a[16:19], 0
    ds_write_b64 v248, v[0:1] offset:0
    v_mfma_f32_16x16x32_bf16 v[132:135], a[132:135], a[20:23], v[132:135]
    v_exp_f32 v146, v146
    v_mfma_f32_16x16x32_bf16 v[132:135], a[136:139], a[24:27], v[132:135]
    ds_write_b64 v249, v[4:5] offset:0
    v_mfma_f32_16x16x32_bf16 v[132:135], a[140:143], a[28:31], v[132:135]
    v_fma_f32 v148, v148, s28, -v195
    v_cvt_pk_bf16_f32 v168, v144, v145
    v_mfma_f32_16x16x32_bf16 v[136:139], a[144:147], a[0:3], 0
    ds_write_b64 v250, v[8:9] offset:0
    v_mfma_f32_16x16x32_bf16 v[136:139], a[148:151], a[4:7], v[136:139]
    v_exp_f32 v147, v147
    v_mfma_f32_16x16x32_bf16 v[136:139], a[152:155], a[8:11], v[136:139]
    ds_write_b64 v251, v[12:13] offset:0
    v_mfma_f32_16x16x32_bf16 v[136:139], a[156:159], a[12:15], v[136:139]
    v_fma_f32 v149, v149, s28, -v195
    v_fma_f32 v150, v150, s28, -v195
    v_mfma_f32_16x16x32_bf16 v[140:143], a[144:147], a[16:19], 0
    ds_write_b64 v248, v[16:17] offset:128
    v_mfma_f32_16x16x32_bf16 v[140:143], a[148:151], a[20:23], v[140:143]
    v_exp_f32 v148, v148
    v_mfma_f32_16x16x32_bf16 v[140:143], a[152:155], a[24:27], v[140:143]
    s_waitcnt vmcnt(23)
    s_barrier
    ds_write_b64 v249, v[20:21] offset:128
    v_mfma_f32_16x16x32_bf16 v[140:143], a[156:159], a[28:31], v[140:143]
    v_exp_f32 v149, v149
    v_cvt_pk_bf16_f32 v169, v146, v147
    v_fma_f32 v152, v152, s28, -v194
    v_fma_f32 v153, v153, s28, -v194
    v_exp_f32 v152, v152
    v_fma_f32 v154, v154, s28, -v194
    v_exp_f32 v153, v153
    v_fma_f32 v155, v155, s28, -v194
    v_exp_f32 v154, v154
    v_exp_f32 v155, v155
    v_cvt_pk_bf16_f32 v170, v152, v153
    v_cvt_pk_bf16_f32 v171, v154, v155
    s_nop 1
    v_mfma_f32_16x16x32_bf16 v[64:67], a[160:163], v[168:171], v[64:67]
    ds_write_b64 v250, v[24:25] offset:128
    v_fma_f32 v151, v151, s28, -v195
    v_exp_f32 v150, v150
    v_exp_f32 v151, v151
    v_cvt_pk_bf16_f32 v172, v148, v149
    v_cvt_pk_bf16_f32 v173, v150, v151
    v_fma_f32 v156, v156, s28, -v195
    v_fma_f32 v157, v157, s28, -v195
    v_exp_f32 v156, v156
    v_fma_f32 v158, v158, s28, -v195
    v_exp_f32 v157, v157
    v_fma_f32 v159, v159, s28, -v195
    v_exp_f32 v158, v158
    v_exp_f32 v159, v159
    v_cvt_pk_bf16_f32 v174, v156, v157
    v_cvt_pk_bf16_f32 v175, v158, v159
    s_nop 1
    v_mfma_f32_16x16x32_bf16 v[96:99], a[160:163], v[172:175], v[96:99]
    ds_read_b64_tr_b16 a[160:161], v200 offset:0
    v_cmp_nlt_f32 vcc, v176, v219
    v_mfma_f32_16x16x32_bf16 v[68:71], a[164:167], v[168:171], v[68:71]
    ds_read_b64_tr_b16 a[162:163], v200 offset:4096
    ds_write_b64 v251, v[28:29] offset:128
    v_mfma_f32_16x16x32_bf16 v[100:103], a[164:167], v[172:175], v[100:103]
    ds_read_b64_tr_b16 a[164:165], v201 offset:0
    s_mov_b64 s[54:55], vcc
    v_mfma_f32_16x16x32_bf16 v[184:187], v[220:223], v[168:171], v[184:187]
    ds_read_b64_tr_b16 a[166:167], v201 offset:4096
    ds_write_b64 v248, v[32:33] offset:4096
    v_mfma_f32_16x16x32_bf16 v[72:75], a[168:171], v[168:171], v[72:75]
    v_cmp_nlt_f32 vcc, v180, v219
    v_max3_f32 v224, v128, v129, v130
    v_mfma_f32_16x16x32_bf16 v[188:191], v[220:223], v[172:175], v[188:191]
    ds_write_b64 v249, v[36:37] offset:4096
    v_mfma_f32_16x16x32_bf16 v[104:107], a[168:171], v[172:175], v[104:107]
    ds_read_b64_tr_b16 a[168:169], v202 offset:0
    v_rcp_f32 v232, v184
    v_mfma_f32_16x16x32_bf16 v[76:79], a[172:175], v[168:171], v[76:79]
    ds_read_b64_tr_b16 a[170:171], v202 offset:4096
    ds_write_b64 v250, v[40:41] offset:4096
    v_mfma_f32_16x16x32_bf16 v[108:111], a[172:175], v[172:175], v[108:111]
    ds_read_b64_tr_b16 a[172:173], v203 offset:0
    v_rcp_f32 v234, v188
    v_mfma_f32_16x16x32_bf16 v[80:83], a[176:179], v[168:171], v[80:83]
    ds_read_b64_tr_b16 a[174:175], v203 offset:4096
    ds_write_b64 v251, v[44:45] offset:4096
    v_mfma_f32_16x16x32_bf16 v[112:115], a[176:179], v[172:175], v[112:115]
    ds_read_b64_tr_b16 a[176:177], v204 offset:0
    s_or_b64 s[54:55], s[54:55], vcc
    v_mfma_f32_16x16x32_bf16 v[84:87], a[180:183], v[168:171], v[84:87]
    ds_read_b64_tr_b16 a[178:179], v204 offset:4096
    ds_write_b64 v248, v[48:49] offset:4224
    v_mfma_f32_16x16x32_bf16 v[116:119], a[180:183], v[172:175], v[116:119]
    ds_read_b64_tr_b16 a[180:181], v205 offset:0
    v_max_f32 v224, v224, v131
    v_mfma_f32_16x16x32_bf16 v[88:91], a[184:187], v[168:171], v[88:91]
    ds_read_b64_tr_b16 a[182:183], v205 offset:4096
    ds_write_b64 v249, v[52:53] offset:4224
    v_mfma_f32_16x16x32_bf16 v[120:123], a[184:187], v[172:175], v[120:123]
    ds_read_b64_tr_b16 a[184:185], v206 offset:0
    v_mul_f32 v192, s28, v224
    v_mfma_f32_16x16x32_bf16 v[92:95], a[188:191], v[168:171], v[92:95]
    ds_read_b64_tr_b16 a[186:187], v206 offset:4096
    ds_write_b64 v250, v[56:57] offset:4224
    v_mfma_f32_16x16x32_bf16 v[124:127], a[188:191], v[172:175], v[124:127]
    ds_read_b64_tr_b16 a[188:189], v207 offset:0
    v_max3_f32 v226, v132, v133, v134
    s_waitcnt lgkmcnt(15)
    v_mfma_f32_16x16x32_bf16 v[144:147], a[128:131], a[32:35], 0
    ds_read_b64_tr_b16 a[190:191], v207 offset:4096
    ds_write_b64 v251, v[60:61] offset:4224
    v_pk_mul_f32 v[64:65], v[64:65], v[232:233] op_sel_hi:[1,0]
    v_pk_mul_f32 v[66:67], v[66:67], v[232:233] op_sel_hi:[1,0]
    v_pk_mul_f32 v[68:69], v[68:69], v[232:233] op_sel_hi:[1,0]
    v_pk_mul_f32 v[70:71], v[70:71], v[232:233] op_sel_hi:[1,0]
    v_pk_mul_f32 v[72:73], v[72:73], v[232:233] op_sel_hi:[1,0]
    v_pk_mul_f32 v[74:75], v[74:75], v[232:233] op_sel_hi:[1,0]
    v_pk_mul_f32 v[76:77], v[76:77], v[232:233] op_sel_hi:[1,0]
    v_pk_mul_f32 v[78:79], v[78:79], v[232:233] op_sel_hi:[1,0]
    v_pk_mul_f32 v[80:81], v[80:81], v[232:233] op_sel_hi:[1,0]
    v_pk_mul_f32 v[82:83], v[82:83], v[232:233] op_sel_hi:[1,0]
    v_pk_mul_f32 v[84:85], v[84:85], v[232:233] op_sel_hi:[1,0]
    v_pk_mul_f32 v[86:87], v[86:87], v[232:233] op_sel_hi:[1,0]
    v_pk_mul_f32 v[88:89], v[88:89], v[232:233] op_sel_hi:[1,0]
    v_pk_mul_f32 v[90:91], v[90:91], v[232:233] op_sel_hi:[1,0]
    v_pk_mul_f32 v[92:93], v[92:93], v[232:233] op_sel_hi:[1,0]
    v_pk_mul_f32 v[94:95], v[94:95], v[232:233] op_sel_hi:[1,0]
    v_cvt_pk_bf16_f32 v64, v64, v65
    v_cvt_pk_bf16_f32 v65, v66, v67
    v_cvt_pk_bf16_f32 v68, v68, v69
    v_cvt_pk_bf16_f32 v69, v70, v71
    v_cvt_pk_bf16_f32 v72, v72, v73
    v_cvt_pk_bf16_f32 v73, v74, v75
    v_cvt_pk_bf16_f32 v76, v76, v77
    v_cvt_pk_bf16_f32 v77, v78, v79
    v_cvt_pk_bf16_f32 v80, v80, v81
    v_cvt_pk_bf16_f32 v81, v82, v83
    v_cvt_pk_bf16_f32 v84, v84, v85
    v_cvt_pk_bf16_f32 v85, v86, v87
    v_cvt_pk_bf16_f32 v88, v88, v89
    v_cvt_pk_bf16_f32 v89, v90, v91
    v_cvt_pk_bf16_f32 v92, v92, v93
    v_cvt_pk_bf16_f32 v93, v94, v95
    v_pk_mul_f32 v[96:97], v[96:97], v[234:235] op_sel_hi:[1,0]
    v_pk_mul_f32 v[98:99], v[98:99], v[234:235] op_sel_hi:[1,0]
    v_pk_mul_f32 v[100:101], v[100:101], v[234:235] op_sel_hi:[1,0]
    v_pk_mul_f32 v[102:103], v[102:103], v[234:235] op_sel_hi:[1,0]
    v_pk_mul_f32 v[104:105], v[104:105], v[234:235] op_sel_hi:[1,0]
    v_pk_mul_f32 v[106:107], v[106:107], v[234:235] op_sel_hi:[1,0]
    v_pk_mul_f32 v[108:109], v[108:109], v[234:235] op_sel_hi:[1,0]
    v_pk_mul_f32 v[110:111], v[110:111], v[234:235] op_sel_hi:[1,0]
    v_pk_mul_f32 v[112:113], v[112:113], v[234:235] op_sel_hi:[1,0]
    v_pk_mul_f32 v[114:115], v[114:115], v[234:235] op_sel_hi:[1,0]
    v_pk_mul_f32 v[116:117], v[116:117], v[234:235] op_sel_hi:[1,0]
    v_pk_mul_f32 v[118:119], v[118:119], v[234:235] op_sel_hi:[1,0]
    v_pk_mul_f32 v[120:121], v[120:121], v[234:235] op_sel_hi:[1,0]
    v_pk_mul_f32 v[122:123], v[122:123], v[234:235] op_sel_hi:[1,0]
    v_pk_mul_f32 v[124:125], v[124:125], v[234:235] op_sel_hi:[1,0]
    v_pk_mul_f32 v[126:127], v[126:127], v[234:235] op_sel_hi:[1,0]
    v_cvt_pk_bf16_f32 v96, v96, v97
    v_cvt_pk_bf16_f32 v97, v98, v99
    v_cvt_pk_bf16_f32 v100, v100, v101
    v_cvt_pk_bf16_f32 v101, v102, v103
    v_cvt_pk_bf16_f32 v104, v104, v105
    v_cvt_pk_bf16_f32 v105, v106, v107
    v_cvt_pk_bf16_f32 v108, v108, v109
    v_cvt_pk_bf16_f32 v109, v110, v111
    v_cvt_pk_bf16_f32 v112, v112, v113
    v_cvt_pk_bf16_f32 v113, v114, v115
    v_cvt_pk_bf16_f32 v116, v116, v117
    v_cvt_pk_bf16_f32 v117, v118, v119
    v_cvt_pk_bf16_f32 v120, v120, v121
    v_cvt_pk_bf16_f32 v121, v122, v123
    v_cvt_pk_bf16_f32 v124, v124, v125
    v_cvt_pk_bf16_f32 v125, v126, v127
    v_mfma_f32_16x16x32_bf16 v[144:147], a[132:135], a[36:39], v[144:147]
    v_max_f32 v226, v226, v135
    v_mul_f32 v193, s28, v226
    v_mfma_f32_16x16x32_bf16 v[144:147], a[136:139], a[40:43], v[144:147]
    v_mov_b32 v225, v192
    v_mov_b32 v227, v193
    v_mfma_f32_16x16x32_bf16 v[144:147], a[140:143], a[44:47], v[144:147]
    s_waitcnt lgkmcnt(0)
    ds_read_b128 a[192:195], v212 offset:0
    v_permlane16_swap_b32 v192, v225
    v_mfma_f32_16x16x32_bf16 v[148:151], a[128:131], a[48:51], 0
    ds_read_b128 a[128:131], v196 offset:8192
    ds_read_b128 a[196:199], v213 offset:1024
    v_mfma_f32_16x16x32_bf16 v[148:151], a[132:135], a[52:55], v[148:151]
    ds_read_b128 a[132:135], v197 offset:8192
    ds_read_b128 a[200:203], v212 offset:2048
    v_mfma_f32_16x16x32_bf16 v[148:151], a[136:139], a[56:59], v[148:151]
    ds_read_b128 a[136:139], v198 offset:8192
    ds_read_b128 a[204:207], v213 offset:3072
    v_mfma_f32_16x16x32_bf16 v[148:151], a[140:143], a[60:63], v[148:151]
    ds_read_b128 a[140:143], v199 offset:8192
    ds_read_b128 a[208:211], v212 offset:4096
    v_mfma_f32_16x16x32_bf16 v[152:155], a[144:147], a[32:35], 0
    ds_read_b128 a[212:215], v213 offset:5120
    v_mov_b32 v225, v192
    v_mfma_f32_16x16x32_bf16 v[152:155], a[148:151], a[36:39], v[152:155]
    ds_read_b128 a[216:219], v212 offset:6144
    v_permlane16_swap_b32 v193, v227
    v_mfma_f32_16x16x32_bf16 v[152:155], a[152:155], a[40:43], v[152:155]
    ds_read_b128 a[220:223], v213 offset:7168
    v_mov_b32 v227, v193
    v_mfma_f32_16x16x32_bf16 v[152:155], a[156:159], a[44:47], v[152:155]
    v_permlane32_swap_b32 v192, v225
    v_mfma_f32_16x16x32_bf16 v[156:159], a[144:147], a[48:51], 0
    ds_read_b128 a[144:147], v196 offset:12288
    v_fma_f32 v128, v128, s28, -v192
    v_mfma_f32_16x16x32_bf16 v[156:159], a[148:151], a[52:55], v[156:159]
    ds_read_b128 a[148:151], v197 offset:12288
    v_fma_f32 v129, v129, s28, -v192
    v_mfma_f32_16x16x32_bf16 v[156:159], a[152:155], a[56:59], v[156:159]
    ds_read_b128 a[152:155], v198 offset:12288
    s_waitcnt lgkmcnt(3)
    v_mfma_f32_16x16x32_bf16 v[156:159], a[156:159], a[60:63], v[156:159]
    s_waitcnt lgkmcnt(15)
    ds_read_b128 a[156:159], v199 offset:12288
    v_fma_f32 v130, v130, s28, -v192
    v_exp_f32 v128, v128
    v_exp_f32 v129, v129
    v_fma_f32 v131, v131, s28, -v192
    v_exp_f32 v130, v130
    v_exp_f32 v131, v131
    v_cvt_pk_bf16_f32 v160, v128, v129
    v_cvt_pk_bf16_f32 v161, v130, v131
    v_fma_f32 v136, v136, s28, -v192
    v_fma_f32 v137, v137, s28, -v192
    v_exp_f32 v136, v136
    v_fma_f32 v138, v138, s28, -v192
    v_exp_f32 v137, v137
    v_fma_f32 v139, v139, s28, -v192
    v_exp_f32 v138, v138
    v_exp_f32 v139, v139
    v_cvt_pk_bf16_f32 v162, v136, v137
    v_cvt_pk_bf16_f32 v163, v138, v139
    s_nop 1
    v_mfma_f32_16x16x32_bf16 v[0:3], a[160:163], v[160:163], 0
    ds_write_b64 v248, v[64:65] offset:0
    v_permlane32_swap_b32 v193, v227
    v_fma_f32 v132, v132, s28, -v193
    v_fma_f32 v133, v133, s28, -v193
    v_exp_f32 v132, v132
    v_fma_f32 v134, v134, s28, -v193
    v_exp_f32 v133, v133
    v_fma_f32 v135, v135, s28, -v193
    v_exp_f32 v134, v134
    v_exp_f32 v135, v135
    v_cvt_pk_bf16_f32 v164, v132, v133
    v_cvt_pk_bf16_f32 v165, v134, v135
    v_fma_f32 v140, v140, s28, -v193
    v_fma_f32 v141, v141, s28, -v193
    v_exp_f32 v140, v140
    v_fma_f32 v142, v142, s28, -v193
    v_exp_f32 v141, v141
    v_fma_f32 v143, v143, s28, -v193
    v_exp_f32 v142, v142
    v_exp_f32 v143, v143
    v_cvt_pk_bf16_f32 v166, v140, v141
    v_cvt_pk_bf16_f32 v167, v142, v143
    s_nop 1
    v_mfma_f32_16x16x32_bf16 v[32:35], a[160:163], v[164:167], 0
    s_add_u32 m0, s34, 0x1c000
    v_cmp_nlt_f32 vcc, v184, v219
    v_max3_f32 v228, v144, v145, v146
    v_mfma_f32_16x16x32_bf16 v[4:7], a[164:167], v[160:163], 0
    buffer_load_dwordx4 v210, s[16:19], 0 offen nt lds
    buffer_load_dwordx4 v211, s[16:19], 0 offen offset:1024 nt lds
    v_mfma_f32_16x16x32_bf16 v[36:39], a[164:167], v[164:167], 0
    s_add_u32 s16, s16, 0x2000
    s_addc_u32 s17, s17, 0
    ds_write_b64 v249, v[68:69] offset:0
    v_mfma_f32_16x16x32_bf16 v[176:179], v[220:223], v[160:163], 0
    s_or_b64 s[54:55], s[54:55], vcc
    v_cmp_nlt_f32 vcc, v188, v219
    v_mfma_f32_16x16x32_bf16 v[8:11], a[168:171], v[160:163], 0
    ds_write_b64 v250, v[72:73] offset:0
    v_mfma_f32_16x16x32_bf16 v[180:183], v[220:223], v[164:167], 0
    s_add_u32 m0, s34, 0xe000
    s_or_b64 s[54:55], s[54:55], vcc
    v_max_f32 v228, v228, v147
    v_mfma_f32_16x16x32_bf16 v[40:43], a[168:171], v[164:167], 0
    buffer_load_dwordx4 v208, s[12:15], 0 offen nt lds
    buffer_load_dwordx4 v209, s[12:15], 0 offen offset:1024 nt lds
    v_mfma_f32_16x16x32_bf16 v[12:15], a[172:175], v[160:163], 0
    s_add_u32 s12, s12, 0x2000
    s_addc_u32 s13, s13, 0
    ds_write_b64 v251, v[76:77] offset:0
    v_mfma_f32_16x16x32_bf16 v[44:47], a[172:175], v[164:167], 0
    v_mul_f32 v194, s28, v228
    v_max3_f32 v230, v148, v149, v150
    v_mfma_f32_16x16x32_bf16 v[16:19], a[176:179], v[160:163], 0
    ds_write_b64 v248, v[80:81] offset:128
    v_mfma_f32_16x16x32_bf16 v[48:51], a[176:179], v[164:167], 0
    v_max_f32 v230, v230, v151
    v_mul_f32 v195, s28, v230
    v_mfma_f32_16x16x32_bf16 v[20:23], a[180:183], v[160:163], 0
    ds_write_b64 v249, v[84:85] offset:128
    v_mfma_f32_16x16x32_bf16 v[52:55], a[180:183], v[164:167], 0
    v_mov_b32 v229, v194
    v_mov_b32 v231, v195
    v_mfma_f32_16x16x32_bf16 v[24:27], a[184:187], v[160:163], 0
    ds_write_b64 v250, v[88:89] offset:128
    v_mfma_f32_16x16x32_bf16 v[56:59], a[184:187], v[164:167], 0
    v_permlane16_swap_b32 v194, v229
    v_mfma_f32_16x16x32_bf16 v[28:31], a[188:191], v[160:163], 0
    ds_write_b64 v251, v[92:93] offset:128
    v_mfma_f32_16x16x32_bf16 v[60:63], a[188:191], v[164:167], 0
    s_waitcnt lgkmcnt(8)
    v_permlane16_swap_b32 v195, v231
    v_mfma_f32_16x16x32_bf16 v[128:131], a[128:131], a[0:3], 0
    ds_write_b64 v248, v[96:97] offset:4096
    v_mfma_f32_16x16x32_bf16 v[128:131], a[132:135], a[4:7], v[128:131]
    v_mov_b32 v229, v194
    v_mov_b32 v231, v195
    v_mfma_f32_16x16x32_bf16 v[128:131], a[136:139], a[8:11], v[128:131]
    ds_write_b64 v249, v[100:101] offset:4096
    v_mfma_f32_16x16x32_bf16 v[128:131], a[140:143], a[12:15], v[128:131]
    v_permlane32_swap_b32 v194, v229
    v_mfma_f32_16x16x32_bf16 v[132:135], a[128:131], a[16:19], 0
    ds_write_b64 v250, v[104:105] offset:4096
    v_mfma_f32_16x16x32_bf16 v[132:135], a[132:135], a[20:23], v[132:135]
    v_permlane32_swap_b32 v195, v231
    v_mfma_f32_16x16x32_bf16 v[132:135], a[136:139], a[24:27], v[132:135]
    ds_write_b64 v251, v[108:109] offset:4096
    v_mfma_f32_16x16x32_bf16 v[132:135], a[140:143], a[28:31], v[132:135]
    v_fma_f32 v144, v144, s28, -v194
    v_fma_f32 v145, v145, s28, -v194
    v_mfma_f32_16x16x32_bf16 v[136:139], a[144:147], a[0:3], 0
    ds_write_b64 v248, v[112:113] offset:4224
    v_mfma_f32_16x16x32_bf16 v[136:139], a[148:151], a[4:7], v[136:139]
    v_exp_f32 v144, v144
    v_mfma_f32_16x16x32_bf16 v[136:139], a[152:155], a[8:11], v[136:139]
    ds_write_b64 v249, v[116:117] offset:4224
    v_mfma_f32_16x16x32_bf16 v[136:139], a[156:159], a[12:15], v[136:139]
    v_fma_f32 v146, v146, s28, -v194
    v_fma_f32 v147, v147, s28, -v194
    v_mfma_f32_16x16x32_bf16 v[140:143], a[144:147], a[16:19], 0
    ds_write_b64 v250, v[120:121] offset:4224
    v_mfma_f32_16x16x32_bf16 v[140:143], a[148:151], a[20:23], v[140:143]
    v_exp_f32 v145, v145
    v_mfma_f32_16x16x32_bf16 v[140:143], a[152:155], a[24:27], v[140:143]
    ds_write_b64 v251, v[124:125] offset:4224
    v_mfma_f32_16x16x32_bf16 v[140:143], a[156:159], a[28:31], v[140:143]
    v_exp_f32 v146, v146
    v_exp_f32 v147, v147
    v_cvt_pk_bf16_f32 v168, v144, v145
    v_cvt_pk_bf16_f32 v169, v146, v147
    v_fma_f32 v152, v152, s28, -v194
    v_fma_f32 v153, v153, s28, -v194
    v_exp_f32 v152, v152
    v_fma_f32 v154, v154, s28, -v194
    v_exp_f32 v153, v153
    v_fma_f32 v155, v155, s28, -v194
    v_exp_f32 v154, v154
    v_exp_f32 v155, v155
    v_cvt_pk_bf16_f32 v170, v152, v153
    v_cvt_pk_bf16_f32 v171, v154, v155
    s_nop 1
    v_mfma_f32_16x16x32_bf16 v[64:67], a[160:163], v[168:171], 0
    v_fma_f32 v148, v148, s28, -v195
    v_fma_f32 v149, v149, s28, -v195
    v_exp_f32 v148, v148
    v_fma_f32 v150, v150, s28, -v195
    v_exp_f32 v149, v149
    v_fma_f32 v151, v151, s28, -v195
    v_exp_f32 v150, v150
    v_exp_f32 v151, v151
    v_cvt_pk_bf16_f32 v172, v148, v149
    v_cvt_pk_bf16_f32 v173, v150, v151
    v_fma_f32 v156, v156, s28, -v195
    v_fma_f32 v157, v157, s28, -v195
    v_exp_f32 v156, v156
    v_fma_f32 v158, v158, s28, -v195
    v_exp_f32 v157, v157
    v_fma_f32 v159, v159, s28, -v195
    v_exp_f32 v158, v158
    v_exp_f32 v159, v159
    v_cvt_pk_bf16_f32 v174, v156, v157
    v_cvt_pk_bf16_f32 v175, v158, v159
    s_nop 1
    v_mfma_f32_16x16x32_bf16 v[96:99], a[160:163], v[172:175], 0
    ds_read_b64_tr_b16 a[160:161], v200 offset:8192
    s_waitcnt lgkmcnt(1)
    v_mfma_f32_16x16x32_bf16 v[68:71], a[164:167], v[168:171], 0
    ds_read_b64_tr_b16 a[162:163], v200 offset:12288
    s_cmp_eq_u32 s33, 1
    s_cbranch_scc1 L_rb1
    ds_read_b128 a[224:227], v212 offset:0
    ds_read_b128 a[228:231], v213 offset:1024
    ds_read_b128 a[232:235], v212 offset:2048
    ds_read_b128 a[236:239], v213 offset:3072
    ds_read_b128 a[240:243], v212 offset:4096
    ds_read_b128 a[244:247], v213 offset:5120
    ds_read_b128 a[248:251], v212 offset:6144
    ds_read_b128 a[252:255], v213 offset:7168
    s_branch L_rb2
L_rb1:
    ds_read_b128 a[96:99], v212 offset:0
    ds_read_b128 a[100:103], v213 offset:1024
    ds_read_b128 a[104:107], v212 offset:2048
    ds_read_b128 a[108:111], v213 offset:3072
    ds_read_b128 a[112:115], v212 offset:4096
    ds_read_b128 a[116:119], v213 offset:5120
    ds_read_b128 a[120:123], v212 offset:6144
    ds_read_b128 a[124:127], v213 offset:7168
L_rb2:
    v_mfma_f32_16x16x32_bf16 v[100:103], a[164:167], v[172:175], 0
    ds_read_b64_tr_b16 a[164:165], v201 offset:8192
    v_fma_f32 v128, v128, s28, -v192
    v_mfma_f32_16x16x32_bf16 v[184:187], v[220:223], v[168:171], 0
    ds_read_b64_tr_b16 a[166:167], v201 offset:12288
    v_fma_f32 v129, v129, s28, -v192
    v_mfma_f32_16x16x32_bf16 v[72:75], a[168:171], v[168:171], 0
    v_exp_f32 v128, v128
    v_mfma_f32_16x16x32_bf16 v[188:191], v[220:223], v[172:175], 0
    v_fma_f32 v130, v130, s28, -v192
    v_fma_f32 v131, v131, s28, -v192
    v_mfma_f32_16x16x32_bf16 v[104:107], a[168:171], v[172:175], 0
    ds_read_b64_tr_b16 a[168:169], v202 offset:8192
    v_fma_f32 v132, v132, s28, -v193
    v_mfma_f32_16x16x32_bf16 v[76:79], a[172:175], v[168:171], 0
    ds_read_b64_tr_b16 a[170:171], v202 offset:12288
    v_fma_f32 v133, v133, s28, -v193
    v_mfma_f32_16x16x32_bf16 v[108:111], a[172:175], v[172:175], 0
    ds_read_b64_tr_b16 a[172:173], v203 offset:8192
    s_cmp_lg_u64 s[54:55], 0
    s_cselect_b32 s54, s56, 0
    s_or_b32 s39, s39, s54
    v_mfma_f32_16x16x32_bf16 v[80:83], a[176:179], v[168:171], 0
    ds_read_b64_tr_b16 a[174:175], v203 offset:12288
    v_fma_f32 v134, v134, s28, -v193
    v_mfma_f32_16x16x32_bf16 v[112:115], a[176:179], v[172:175], 0
    ds_read_b64_tr_b16 a[176:177], v204 offset:8192
    v_exp_f32 v129, v129
    v_mfma_f32_16x16x32_bf16 v[84:87], a[180:183], v[168:171], 0
    ds_read_b64_tr_b16 a[178:179], v204 offset:12288
    v_cvt_pk_bf16_f32 v160, v128, v129
    v_mfma_f32_16x16x32_bf16 v[116:119], a[180:183], v[172:175], 0
    ds_read_b64_tr_b16 a[180:181], v205 offset:8192
    v_fma_f32 v135, v135, s28, -v193
    v_mfma_f32_16x16x32_bf16 v[88:91], a[184:187], v[168:171], 0
    ds_read_b64_tr_b16 a[182:183], v205 offset:12288
    v_exp_f32 v130, v130
    v_mfma_f32_16x16x32_bf16 v[120:123], a[184:187], v[172:175], 0
    ds_read_b64_tr_b16 a[184:185], v206 offset:8192
    v_fma_f32 v136, v136, s28, -v192
    v_mfma_f32_16x16x32_bf16 v[92:95], a[188:191], v[168:171], 0
    ds_read_b64_tr_b16 a[186:187], v206 offset:12288
    v_exp_f32 v131, v131
    v_mfma_f32_16x16x32_bf16 v[124:127], a[188:191], v[172:175], 0
    ds_read_b64_tr_b16 a[188:189], v207 offset:8192
    v_cvt_pk_bf16_f32 v161, v130, v131
    v_mfma_f32_16x16x32_bf16 v[144:147], a[128:131], a[32:35], 0
    ds_read_b64_tr_b16 a[190:191], v207 offset:12288
    v_fma_f32 v137, v137, s28, -v192
    v_mfma_f32_16x16x32_bf16 v[144:147], a[132:135], a[36:39], v[144:147]
    v_exp_f32 v132, v132
    v_mfma_f32_16x16x32_bf16 v[144:147], a[136:139], a[40:43], v[144:147]
    v_exp_f32 v133, v133
    v_mfma_f32_16x16x32_bf16 v[144:147], a[140:143], a[44:47], v[144:147]
    v_exp_f32 v134, v134
    v_mfma_f32_16x16x32_bf16 v[148:151], a[128:131], a[48:51], 0
    ds_read_b128 a[128:131], v196 offset:16384
    v_cvt_pk_bf16_f32 v164, v132, v133
    v_mfma_f32_16x16x32_bf16 v[148:151], a[132:135], a[52:55], v[148:151]
    ds_read_b128 a[132:135], v197 offset:16384
    v_fma_f32 v138, v138, s28, -v192
    v_mfma_f32_16x16x32_bf16 v[148:151], a[136:139], a[56:59], v[148:151]
    ds_read_b128 a[136:139], v198 offset:16384
    v_fma_f32 v139, v139, s28, -v192
    v_mfma_f32_16x16x32_bf16 v[148:151], a[140:143], a[60:63], v[148:151]
    ds_read_b128 a[140:143], v199 offset:16384
    v_fma_f32 v140, v140, s28, -v193
    v_mfma_f32_16x16x32_bf16 v[152:155], a[144:147], a[32:35], 0
    v_exp_f32 v135, v135
    v_mfma_f32_16x16x32_bf16 v[152:155], a[148:151], a[36:39], v[152:155]
    v_exp_f32 v136, v136
    v_mfma_f32_16x16x32_bf16 v[152:155], a[152:155], a[40:43], v[152:155]
    v_exp_f32 v137, v137
    v_mfma_f32_16x16x32_bf16 v[152:155], a[156:159], a[44:47], v[152:155]
    v_cvt_pk_bf16_f32 v165, v134, v135
    v_cvt_pk_bf16_f32 v162, v136, v137
    v_mfma_f32_16x16x32_bf16 v[156:159], a[144:147], a[48:51], 0
    ds_read_b128 a[144:147], v196 offset:20480
    v_fma_f32 v141, v141, s28, -v193
    v_mfma_f32_16x16x32_bf16 v[156:159], a[148:151], a[52:55], v[156:159]
    ds_read_b128 a[148:151], v197 offset:20480
    v_fma_f32 v142, v142, s28, -v193
    v_mfma_f32_16x16x32_bf16 v[156:159], a[152:155], a[56:59], v[156:159]
    ds_read_b128 a[152:155], v198 offset:20480
    v_fma_f32 v143, v143, s28, -v193
    v_mfma_f32_16x16x32_bf16 v[156:159], a[156:159], a[60:63], v[156:159]
    s_waitcnt lgkmcnt(7)
    ds_read_b128 a[156:159], v199 offset:20480
    v_exp_f32 v138, v138
    v_exp_f32 v139, v139
    s_nop 0
    v_cvt_pk_bf16_f32 v163, v138, v139
    s_nop 1
    v_mfma_f32_16x16x32_bf16 v[0:3], a[160:163], v[160:163], v[0:3]
    v_exp_f32 v140, v140
    v_exp_f32 v141, v141
    v_exp_f32 v142, v142
    v_exp_f32 v143, v143
    v_cvt_pk_bf16_f32 v166, v140, v141
    v_cvt_pk_bf16_f32 v167, v142, v143
    s_nop 1
    v_mfma_f32_16x16x32_bf16 v[32:35], a[160:163], v[164:167], v[32:35]
    s_add_u32 m0, s34, 0x1e000
    v_fma_f32 v144, v144, s28, -v194
    v_fma_f32 v145, v145, s28, -v194
    v_mfma_f32_16x16x32_bf16 v[4:7], a[164:167], v[160:163], v[4:7]
    buffer_load_dwordx4 v210, s[16:19], 0 offen nt lds
    buffer_load_dwordx4 v211, s[16:19], 0 offen offset:1024 nt lds
    v_mfma_f32_16x16x32_bf16 v[36:39], a[164:167], v[164:167], v[36:39]
    s_add_u32 s16, s16, 0x2000
    s_addc_u32 s17, s17, 0
    v_fma_f32 v146, v146, s28, -v194
    v_mfma_f32_16x16x32_bf16 v[176:179], v[220:223], v[160:163], v[176:179]
    v_exp_f32 v144, v144
    v_mfma_f32_16x16x32_bf16 v[8:11], a[168:171], v[160:163], v[8:11]
    v_exp_f32 v145, v145
    v_mfma_f32_16x16x32_bf16 v[180:183], v[220:223], v[164:167], v[180:183]
    s_add_u32 m0, s34, 0
    v_fma_f32 v147, v147, s28, -v194
    v_fma_f32 v148, v148, s28, -v195
    v_mfma_f32_16x16x32_bf16 v[40:43], a[168:171], v[164:167], v[40:43]
    buffer_load_dwordx4 v208, s[12:15], 0 offen nt lds
    buffer_load_dwordx4 v209, s[12:15], 0 offen offset:1024 nt lds
    v_mfma_f32_16x16x32_bf16 v[12:15], a[172:175], v[160:163], v[12:15]
    s_add_u32 s12, s12, 0x2000
    s_addc_u32 s13, s13, 0
    v_cvt_pk_bf16_f32 v168, v144, v145
    v_mfma_f32_16x16x32_bf16 v[44:47], a[172:175], v[164:167], v[44:47]
    v_exp_f32 v146, v146
    v_mfma_f32_16x16x32_bf16 v[16:19], a[176:179], v[160:163], v[16:19]
    v_exp_f32 v147, v147
    v_mfma_f32_16x16x32_bf16 v[48:51], a[176:179], v[164:167], v[48:51]
    v_fma_f32 v149, v149, s28, -v195
    v_fma_f32 v150, v150, s28, -v195
    v_mfma_f32_16x16x32_bf16 v[20:23], a[180:183], v[160:163], v[20:23]
    v_exp_f32 v148, v148
    v_mfma_f32_16x16x32_bf16 v[52:55], a[180:183], v[164:167], v[52:55]
    v_exp_f32 v149, v149
    v_mfma_f32_16x16x32_bf16 v[24:27], a[184:187], v[160:163], v[24:27]
    v_cvt_pk_bf16_f32 v169, v146, v147
    v_fma_f32 v151, v151, s28, -v195
    v_mfma_f32_16x16x32_bf16 v[56:59], a[184:187], v[164:167], v[56:59]
    v_exp_f32 v150, v150
    v_mfma_f32_16x16x32_bf16 v[28:31], a[188:191], v[160:163], v[28:31]
    v_fma_f32 v152, v152, s28, -v194
    v_cvt_pk_bf16_f32 v172, v148, v149
    v_mfma_f32_16x16x32_bf16 v[60:63], a[188:191], v[164:167], v[60:63]
    s_waitcnt lgkmcnt(0)
    v_exp_f32 v151, v151
    v_mfma_f32_16x16x32_bf16 v[128:131], a[128:131], a[0:3], 0
    v_fma_f32 v153, v153, s28, -v194
    v_fma_f32 v154, v154, s28, -v194
    v_mfma_f32_16x16x32_bf16 v[128:131], a[132:135], a[4:7], v[128:131]
    v_exp_f32 v152, v152
    v_mfma_f32_16x16x32_bf16 v[128:131], a[136:139], a[8:11], v[128:131]
    v_exp_f32 v153, v153
    v_mfma_f32_16x16x32_bf16 v[128:131], a[140:143], a[12:15], v[128:131]
    v_cvt_pk_bf16_f32 v173, v150, v151
    v_fma_f32 v155, v155, s28, -v194
    v_mfma_f32_16x16x32_bf16 v[132:135], a[128:131], a[16:19], 0
    v_exp_f32 v154, v154
    v_mfma_f32_16x16x32_bf16 v[132:135], a[132:135], a[20:23], v[132:135]
    v_fma_f32 v156, v156, s28, -v195
    v_cvt_pk_bf16_f32 v170, v152, v153
    v_mfma_f32_16x16x32_bf16 v[132:135], a[136:139], a[24:27], v[132:135]
    v_exp_f32 v155, v155
    v_mfma_f32_16x16x32_bf16 v[132:135], a[140:143], a[28:31], v[132:135]
    v_fma_f32 v157, v157, s28, -v195
    v_fma_f32 v158, v158, s28, -v195
    v_mfma_f32_16x16x32_bf16 v[136:139], a[144:147], a[0:3], 0
    v_exp_f32 v156, v156
    v_mfma_f32_16x16x32_bf16 v[136:139], a[148:151], a[4:7], v[136:139]
    v_exp_f32 v157, v157
    v_mfma_f32_16x16x32_bf16 v[136:139], a[152:155], a[8:11], v[136:139]
    v_cvt_pk_bf16_f32 v171, v154, v155
    v_fma_f32 v159, v159, s28, -v195
    v_mfma_f32_16x16x32_bf16 v[136:139], a[156:159], a[12:15], v[136:139]
    v_exp_f32 v158, v158
    v_mfma_f32_16x16x32_bf16 v[140:143], a[144:147], a[16:19], 0
    v_exp_f32 v159, v159
    v_mfma_f32_16x16x32_bf16 v[140:143], a[148:151], a[20:23], v[140:143]
    v_cvt_pk_bf16_f32 v174, v156, v157
    v_cvt_pk_bf16_f32 v175, v158, v159
    v_mfma_f32_16x16x32_bf16 v[140:143], a[152:155], a[24:27], v[140:143]
    s_waitcnt vmcnt(18)
    s_barrier
    v_fma_f32 v128, v128, s28, -v192
    v_mfma_f32_16x16x32_bf16 v[140:143], a[156:159], a[28:31], v[140:143]
    v_fma_f32 v129, v129, s28, -v192
    v_fma_f32 v130, v130, s28, -v192
    v_mfma_f32_16x16x32_bf16 v[64:67], a[160:163], v[168:171], v[64:67]
    v_exp_f32 v128, v128
    v_mfma_f32_16x16x32_bf16 v[96:99], a[160:163], v[172:175], v[96:99]
    ds_read_b64_tr_b16 a[160:161], v200 offset:16384
    v_fma_f32 v131, v131, s28, -v192
    v_mfma_f32_16x16x32_bf16 v[68:71], a[164:167], v[168:171], v[68:71]
    ds_read_b64_tr_b16 a[162:163], v200 offset:20480
    v_fma_f32 v132, v132, s28, -v193
    v_mfma_f32_16x16x32_bf16 v[100:103], a[164:167], v[172:175], v[100:103]
    ds_read_b64_tr_b16 a[164:165], v201 offset:16384
    v_fma_f32 v133, v133, s28, -v193
    v_mfma_f32_16x16x32_bf16 v[184:187], v[220:223], v[168:171], v[184:187]
    ds_read_b64_tr_b16 a[166:167], v201 offset:20480
    v_fma_f32 v134, v134, s28, -v193
    v_mfma_f32_16x16x32_bf16 v[72:75], a[168:171], v[168:171], v[72:75]
    v_exp_f32 v129, v129
    v_mfma_f32_16x16x32_bf16 v[188:191], v[220:223], v[172:175], v[188:191]
    v_exp_f32 v130, v130
    v_mfma_f32_16x16x32_bf16 v[104:107], a[168:171], v[172:175], v[104:107]
    ds_read_b64_tr_b16 a[168:169], v202 offset:16384
    v_cvt_pk_bf16_f32 v160, v128, v129
    v_mfma_f32_16x16x32_bf16 v[76:79], a[172:175], v[168:171], v[76:79]
    ds_read_b64_tr_b16 a[170:171], v202 offset:20480
    v_fma_f32 v135, v135, s28, -v193
    v_mfma_f32_16x16x32_bf16 v[108:111], a[172:175], v[172:175], v[108:111]
    ds_read_b64_tr_b16 a[172:173], v203 offset:16384
    v_fma_f32 v136, v136, s28, -v192
    v_mfma_f32_16x16x32_bf16 v[80:83], a[176:179], v[168:171], v[80:83]
    ds_read_b64_tr_b16 a[174:175], v203 offset:20480
    v_exp_f32 v131, v131
    v_mfma_f32_16x16x32_bf16 v[112:115], a[176:179], v[172:175], v[112:115]
    ds_read_b64_tr_b16 a[176:177], v204 offset:16384
    v_cvt_pk_bf16_f32 v161, v130, v131
    v_mfma_f32_16x16x32_bf16 v[84:87], a[180:183], v[168:171], v[84:87]
    ds_read_b64_tr_b16 a[178:179], v204 offset:20480
    v_fma_f32 v137, v137, s28, -v192
    v_mfma_f32_16x16x32_bf16 v[116:119], a[180:183], v[172:175], v[116:119]
    ds_read_b64_tr_b16 a[180:181], v205 offset:16384
    v_exp_f32 v132, v132
    v_mfma_f32_16x16x32_bf16 v[88:91], a[184:187], v[168:171], v[88:91]
    ds_read_b64_tr_b16 a[182:183], v205 offset:20480
    v_fma_f32 v138, v138, s28, -v192
    v_mfma_f32_16x16x32_bf16 v[120:123], a[184:187], v[172:175], v[120:123]
    ds_read_b64_tr_b16 a[184:185], v206 offset:16384
    v_exp_f32 v133, v133
    v_mfma_f32_16x16x32_bf16 v[92:95], a[188:191], v[168:171], v[92:95]
    ds_read_b64_tr_b16 a[186:187], v206 offset:20480
    v_cvt_pk_bf16_f32 v164, v132, v133
    v_mfma_f32_16x16x32_bf16 v[124:127], a[188:191], v[172:175], v[124:127]
    ds_read_b64_tr_b16 a[188:189], v207 offset:16384
    v_fma_f32 v139, v139, s28, -v192
    v_mfma_f32_16x16x32_bf16 v[144:147], a[128:131], a[32:35], 0
    ds_read_b64_tr_b16 a[190:191], v207 offset:20480
    v_exp_f32 v134, v134
    v_mfma_f32_16x16x32_bf16 v[144:147], a[132:135], a[36:39], v[144:147]
    v_exp_f32 v135, v135
    v_mfma_f32_16x16x32_bf16 v[144:147], a[136:139], a[40:43], v[144:147]
    v_exp_f32 v136, v136
    v_mfma_f32_16x16x32_bf16 v[144:147], a[140:143], a[44:47], v[144:147]
    v_exp_f32 v137, v137
    v_mfma_f32_16x16x32_bf16 v[148:151], a[128:131], a[48:51], 0
    ds_read_b128 a[128:131], v196 offset:24576
    v_cvt_pk_bf16_f32 v165, v134, v135
    v_mfma_f32_16x16x32_bf16 v[148:151], a[132:135], a[52:55], v[148:151]
    ds_read_b128 a[132:135], v197 offset:24576
    v_fma_f32 v140, v140, s28, -v193
    v_mfma_f32_16x16x32_bf16 v[148:151], a[136:139], a[56:59], v[148:151]
    ds_read_b128 a[136:139], v198 offset:24576
    v_cvt_pk_bf16_f32 v162, v136, v137
    v_mfma_f32_16x16x32_bf16 v[148:151], a[140:143], a[60:63], v[148:151]
    ds_read_b128 a[140:143], v199 offset:24576
    v_fma_f32 v141, v141, s28, -v193
    v_mfma_f32_16x16x32_bf16 v[152:155], a[144:147], a[32:35], 0
    v_exp_f32 v138, v138
    v_mfma_f32_16x16x32_bf16 v[152:155], a[148:151], a[36:39], v[152:155]
    v_exp_f32 v139, v139
    v_mfma_f32_16x16x32_bf16 v[152:155], a[152:155], a[40:43], v[152:155]
    v_exp_f32 v140, v140
    v_mfma_f32_16x16x32_bf16 v[152:155], a[156:159], a[44:47], v[152:155]
    v_fma_f32 v142, v142, s28, -v193
    v_cvt_pk_bf16_f32 v163, v138, v139
    v_mfma_f32_16x16x32_bf16 v[156:159], a[144:147], a[48:51], 0
    ds_read_b128 a[144:147], v196 offset:28672
    v_fma_f32 v143, v143, s28, -v193
    v_mfma_f32_16x16x32_bf16 v[156:159], a[148:151], a[52:55], v[156:159]
    ds_read_b128 a[148:151], v197 offset:28672
    v_fma_f32 v144, v144, s28, -v194
    v_mfma_f32_16x16x32_bf16 v[156:159], a[152:155], a[56:59], v[156:159]
    ds_read_b128 a[152:155], v198 offset:28672
    v_fma_f32 v145, v145, s28, -v194
    v_mfma_f32_16x16x32_bf16 v[156:159], a[156:159], a[60:63], v[156:159]
    s_waitcnt lgkmcnt(7)
    ds_read_b128 a[156:159], v199 offset:28672
    v_exp_f32 v141, v141
    v_mfma_f32_16x16x32_bf16 v[0:3], a[160:163], v[160:163], v[0:3]
    v_exp_f32 v142, v142
    v_exp_f32 v143, v143
    v_cvt_pk_bf16_f32 v166, v140, v141
    v_cvt_pk_bf16_f32 v167, v142, v143
    s_nop 1
    v_mfma_f32_16x16x32_bf16 v[32:35], a[160:163], v[164:167], v[32:35]
    s_add_u32 m0, s34, 0x10000
    v_exp_f32 v144, v144
    v_mfma_f32_16x16x32_bf16 v[4:7], a[164:167], v[160:163], v[4:7]
    buffer_load_dwordx4 v210, s[16:19], 0 offen nt lds
    buffer_load_dwordx4 v211, s[16:19], 0 offen offset:1024 nt lds
    v_mfma_f32_16x16x32_bf16 v[36:39], a[164:167], v[164:167], v[36:39]
    s_add_u32 s16, s16, 0x2000
    v_fma_f32 v146, v146, s28, -v194
    v_fma_f32 v147, v147, s28, -v194
    v_mfma_f32_16x16x32_bf16 v[176:179], v[220:223], v[160:163], v[176:179]
    s_addc_u32 s17, s17, 0
    v_exp_f32 v145, v145
    v_mfma_f32_16x16x32_bf16 v[8:11], a[168:171], v[160:163], v[8:11]
    v_exp_f32 v146, v146
    v_mfma_f32_16x16x32_bf16 v[180:183], v[220:223], v[164:167], v[180:183]
    s_add_u32 m0, s34, 0x2000
    v_fma_f32 v148, v148, s28, -v195
    v_cvt_pk_bf16_f32 v168, v144, v145
    v_mfma_f32_16x16x32_bf16 v[40:43], a[168:171], v[164:167], v[40:43]
    buffer_load_dwordx4 v208, s[12:15], 0 offen nt lds
    buffer_load_dwordx4 v209, s[12:15], 0 offen offset:1024 nt lds
    v_mfma_f32_16x16x32_bf16 v[12:15], a[172:175], v[160:163], v[12:15]
    s_add_u32 s12, s12, 0x2000
    v_exp_f32 v147, v147
    v_mfma_f32_16x16x32_bf16 v[44:47], a[172:175], v[164:167], v[44:47]
    s_addc_u32 s13, s13, 0
    v_fma_f32 v149, v149, s28, -v195
    v_fma_f32 v150, v150, s28, -v195
    v_mfma_f32_16x16x32_bf16 v[16:19], a[176:179], v[160:163], v[16:19]
    v_exp_f32 v148, v148
    v_mfma_f32_16x16x32_bf16 v[48:51], a[176:179], v[164:167], v[48:51]
    v_exp_f32 v149, v149
    v_mfma_f32_16x16x32_bf16 v[20:23], a[180:183], v[160:163], v[20:23]
    v_cvt_pk_bf16_f32 v169, v146, v147
    v_fma_f32 v151, v151, s28, -v195
    v_mfma_f32_16x16x32_bf16 v[52:55], a[180:183], v[164:167], v[52:55]
    v_exp_f32 v150, v150
    v_mfma_f32_16x16x32_bf16 v[24:27], a[184:187], v[160:163], v[24:27]
    v_fma_f32 v152, v152, s28, -v194
    v_cvt_pk_bf16_f32 v172, v148, v149
    v_mfma_f32_16x16x32_bf16 v[56:59], a[184:187], v[164:167], v[56:59]
    v_exp_f32 v151, v151
    v_mfma_f32_16x16x32_bf16 v[28:31], a[188:191], v[160:163], v[28:31]
    v_fma_f32 v153, v153, s28, -v194
    v_fma_f32 v154, v154, s28, -v194
    v_mfma_f32_16x16x32_bf16 v[60:63], a[188:191], v[164:167], v[60:63]
    s_waitcnt lgkmcnt(0)
    v_exp_f32 v152, v152
    v_mfma_f32_16x16x32_bf16 v[128:131], a[128:131], a[0:3], 0
    v_exp_f32 v153, v153
    v_mfma_f32_16x16x32_bf16 v[128:131], a[132:135], a[4:7], v[128:131]
    s_waitcnt lgkmcnt(15)
    v_cvt_pk_bf16_f32 v173, v150, v151
    v_fma_f32 v155, v155, s28, -v194
    v_mfma_f32_16x16x32_bf16 v[128:131], a[136:139], a[8:11], v[128:131]
    s_add_u32 s38, s32, 0
    v_exp_f32 v154, v154
    v_mfma_f32_16x16x32_bf16 v[128:131], a[140:143], a[12:15], v[128:131]
    buffer_store_dwordx4 a[192:195], v214, s[20:23], s38 offen sc1
    v_fma_f32 v156, v156, s28, -v195
    v_exp_f32 v155, v155
    v_mfma_f32_16x16x32_bf16 v[132:135], a[128:131], a[16:19], 0
    v_cvt_pk_bf16_f32 v170, v152, v153
    v_fma_f32 v157, v157, s28, -v195
    v_mfma_f32_16x16x32_bf16 v[132:135], a[132:135], a[20:23], v[132:135]
    v_exp_f32 v156, v156
    v_mfma_f32_16x16x32_bf16 v[132:135], a[136:139], a[24:27], v[132:135]
    v_fma_f32 v158, v158, s28, -v195
    v_cvt_pk_bf16_f32 v171, v154, v155
    v_mfma_f32_16x16x32_bf16 v[132:135], a[140:143], a[28:31], v[132:135]
    v_exp_f32 v157, v157
    v_mfma_f32_16x16x32_bf16 v[136:139], a[144:147], a[0:3], 0
    v_fma_f32 v159, v159, s28, -v195
    v_cvt_pk_bf16_f32 v174, v156, v157
    v_mfma_f32_16x16x32_bf16 v[136:139], a[148:151], a[4:7], v[136:139]
    v_exp_f32 v158, v158
    v_mfma_f32_16x16x32_bf16 v[136:139], a[152:155], a[8:11], v[136:139]
    v_exp_f32 v159, v159
    v_mfma_f32_16x16x32_bf16 v[136:139], a[156:159], a[12:15], v[136:139]
    v_cvt_pk_bf16_f32 v175, v158, v159
    v_fma_f32 v128, v128, s28, -v192
    v_mfma_f32_16x16x32_bf16 v[140:143], a[144:147], a[16:19], 0
    v_fma_f32 v129, v129, s28, -v192
    v_fma_f32 v130, v130, s28, -v192
    v_mfma_f32_16x16x32_bf16 v[140:143], a[148:151], a[20:23], v[140:143]
    v_exp_f32 v128, v128
    v_mfma_f32_16x16x32_bf16 v[140:143], a[152:155], a[24:27], v[140:143]
    v_exp_f32 v129, v129
    v_mfma_f32_16x16x32_bf16 v[140:143], a[156:159], a[28:31], v[140:143]
    v_fma_f32 v131, v131, s28, -v192
    v_fma_f32 v132, v132, s28, -v193
    v_mfma_f32_16x16x32_bf16 v[64:67], a[160:163], v[168:171], v[64:67]
    v_exp_f32 v130, v130
    v_mfma_f32_16x16x32_bf16 v[96:99], a[160:163], v[172:175], v[96:99]
    ds_read_b64_tr_b16 a[160:161], v200 offset:24576
    v_cvt_pk_bf16_f32 v160, v128, v129
    v_mfma_f32_16x16x32_bf16 v[68:71], a[164:167], v[168:171], v[68:71]
    ds_read_b64_tr_b16 a[162:163], v200 offset:28672
    v_fma_f32 v133, v133, s28, -v193
    v_mfma_f32_16x16x32_bf16 v[100:103], a[164:167], v[172:175], v[100:103]
    ds_read_b64_tr_b16 a[164:165], v201 offset:24576
    v_fma_f32 v134, v134, s28, -v193
    v_mfma_f32_16x16x32_bf16 v[184:187], v[220:223], v[168:171], v[184:187]
    ds_read_b64_tr_b16 a[166:167], v201 offset:28672
    v_fma_f32 v135, v135, s28, -v193
    v_mfma_f32_16x16x32_bf16 v[72:75], a[168:171], v[168:171], v[72:75]
    v_exp_f32 v131, v131
    v_mfma_f32_16x16x32_bf16 v[188:191], v[220:223], v[172:175], v[188:191]
    v_exp_f32 v132, v132
    v_mfma_f32_16x16x32_bf16 v[104:107], a[168:171], v[172:175], v[104:107]
    ds_read_b64_tr_b16 a[168:169], v202 offset:24576
    v_cvt_pk_bf16_f32 v161, v130, v131
    v_mfma_f32_16x16x32_bf16 v[76:79], a[172:175], v[168:171], v[76:79]
    ds_read_b64_tr_b16 a[170:171], v202 offset:28672
    v_fma_f32 v136, v136, s28, -v192
    v_mfma_f32_16x16x32_bf16 v[108:111], a[172:175], v[172:175], v[108:111]
    ds_read_b64_tr_b16 a[172:173], v203 offset:24576
    v_fma_f32 v137, v137, s28, -v192
    v_mfma_f32_16x16x32_bf16 v[80:83], a[176:179], v[168:171], v[80:83]
    ds_read_b64_tr_b16 a[174:175], v203 offset:28672
    v_fma_f32 v138, v138, s28, -v192
    v_mfma_f32_16x16x32_bf16 v[112:115], a[176:179], v[172:175], v[112:115]
    ds_read_b64_tr_b16 a[176:177], v204 offset:24576
    v_exp_f32 v133, v133
    v_mfma_f32_16x16x32_bf16 v[84:87], a[180:183], v[168:171], v[84:87]
    ds_read_b64_tr_b16 a[178:179], v204 offset:28672
    v_cvt_pk_bf16_f32 v164, v132, v133
    v_mfma_f32_16x16x32_bf16 v[116:119], a[180:183], v[172:175], v[116:119]
    ds_read_b64_tr_b16 a[180:181], v205 offset:24576
    v_fma_f32 v139, v139, s28, -v192
    v_mfma_f32_16x16x32_bf16 v[88:91], a[184:187], v[168:171], v[88:91]
    ds_read_b64_tr_b16 a[182:183], v205 offset:28672
    v_exp_f32 v134, v134
    v_mfma_f32_16x16x32_bf16 v[120:123], a[184:187], v[172:175], v[120:123]
    ds_read_b64_tr_b16 a[184:185], v206 offset:24576
    v_fma_f32 v140, v140, s28, -v193
    v_mfma_f32_16x16x32_bf16 v[92:95], a[188:191], v[168:171], v[92:95]
    ds_read_b64_tr_b16 a[186:187], v206 offset:28672
    v_exp_f32 v135, v135
    v_mfma_f32_16x16x32_bf16 v[124:127], a[188:191], v[172:175], v[124:127]
    ds_read_b64_tr_b16 a[188:189], v207 offset:24576
    v_cvt_pk_bf16_f32 v165, v134, v135
    v_mfma_f32_16x16x32_bf16 v[144:147], a[128:131], a[32:35], 0
    ds_read_b64_tr_b16 a[190:191], v207 offset:28672
    v_fma_f32 v141, v141, s28, -v193
    v_mfma_f32_16x16x32_bf16 v[144:147], a[132:135], a[36:39], v[144:147]
    v_exp_f32 v136, v136
    v_mfma_f32_16x16x32_bf16 v[144:147], a[136:139], a[40:43], v[144:147]
    v_exp_f32 v137, v137
    v_mfma_f32_16x16x32_bf16 v[144:147], a[140:143], a[44:47], v[144:147]
    v_exp_f32 v138, v138
    v_mfma_f32_16x16x32_bf16 v[148:151], a[128:131], a[48:51], 0
    ds_read_b128 a[128:131], v196 offset:32768
    v_cvt_pk_bf16_f32 v162, v136, v137
    v_mfma_f32_16x16x32_bf16 v[148:151], a[132:135], a[52:55], v[148:151]
    ds_read_b128 a[132:135], v197 offset:32768
    v_fma_f32 v142, v142, s28, -v193
    v_mfma_f32_16x16x32_bf16 v[148:151], a[136:139], a[56:59], v[148:151]
    ds_read_b128 a[136:139], v198 offset:32768
    v_fma_f32 v143, v143, s28, -v193
    v_mfma_f32_16x16x32_bf16 v[148:151], a[140:143], a[60:63], v[148:151]
    ds_read_b128 a[140:143], v199 offset:32768
    v_exp_f32 v139, v139
    v_mfma_f32_16x16x32_bf16 v[152:155], a[144:147], a[32:35], 0
    v_exp_f32 v140, v140
    v_mfma_f32_16x16x32_bf16 v[152:155], a[148:151], a[36:39], v[152:155]
    v_exp_f32 v141, v141
    v_mfma_f32_16x16x32_bf16 v[152:155], a[152:155], a[40:43], v[152:155]
    v_cvt_pk_bf16_f32 v163, v138, v139
    v_cvt_pk_bf16_f32 v166, v140, v141
    v_mfma_f32_16x16x32_bf16 v[152:155], a[156:159], a[44:47], v[152:155]
    v_exp_f32 v142, v142
    v_mfma_f32_16x16x32_bf16 v[156:159], a[144:147], a[48:51], 0
    ds_read_b128 a[144:147], v196 offset:36864
    v_fma_f32 v144, v144, s28, -v194
    v_mfma_f32_16x16x32_bf16 v[156:159], a[148:151], a[52:55], v[156:159]
    ds_read_b128 a[148:151], v197 offset:36864
    v_fma_f32 v145, v145, s28, -v194
    v_mfma_f32_16x16x32_bf16 v[156:159], a[152:155], a[56:59], v[156:159]
    ds_read_b128 a[152:155], v198 offset:36864
    v_fma_f32 v146, v146, s28, -v194
    v_mfma_f32_16x16x32_bf16 v[156:159], a[156:159], a[60:63], v[156:159]
    s_waitcnt lgkmcnt(7)
    ds_read_b128 a[156:159], v199 offset:36864
    v_fma_f32 v147, v147, s28, -v194
    v_mfma_f32_16x16x32_bf16 v[0:3], a[160:163], v[160:163], v[0:3]
    v_exp_f32 v143, v143
    s_nop 0
    v_cvt_pk_bf16_f32 v167, v142, v143
    s_nop 1
    v_mfma_f32_16x16x32_bf16 v[32:35], a[160:163], v[164:167], v[32:35]
    s_add_u32 m0, s34, 0x12000
    v_exp_f32 v144, v144
    v_mfma_f32_16x16x32_bf16 v[4:7], a[164:167], v[160:163], v[4:7]
    buffer_load_dwordx4 v210, s[16:19], 0 offen nt lds
    buffer_load_dwordx4 v211, s[16:19], 0 offen offset:1024 nt lds
    v_mfma_f32_16x16x32_bf16 v[36:39], a[164:167], v[164:167], v[36:39]
    s_add_u32 s16, s16, 0x2000
    v_exp_f32 v145, v145
    v_mfma_f32_16x16x32_bf16 v[176:179], v[220:223], v[160:163], v[176:179]
    s_addc_u32 s17, s17, 0
    v_exp_f32 v146, v146
    v_mfma_f32_16x16x32_bf16 v[8:11], a[168:171], v[160:163], v[8:11]
    v_fma_f32 v148, v148, s28, -v195
    v_cvt_pk_bf16_f32 v168, v144, v145
    v_mfma_f32_16x16x32_bf16 v[180:183], v[220:223], v[164:167], v[180:183]
    s_add_u32 m0, s34, 0x4000
    v_exp_f32 v147, v147
    v_mfma_f32_16x16x32_bf16 v[40:43], a[168:171], v[164:167], v[40:43]
    buffer_load_dwordx4 v208, s[12:15], 0 offen nt lds
    buffer_load_dwordx4 v209, s[12:15], 0 offen offset:1024 nt lds
    v_mfma_f32_16x16x32_bf16 v[12:15], a[172:175], v[160:163], v[12:15]
    s_add_u32 s12, s12, 0x2000
    v_fma_f32 v149, v149, s28, -v195
    v_fma_f32 v150, v150, s28, -v195
    v_mfma_f32_16x16x32_bf16 v[44:47], a[172:175], v[164:167], v[44:47]
    s_addc_u32 s13, s13, 0
    v_exp_f32 v148, v148
    v_mfma_f32_16x16x32_bf16 v[16:19], a[176:179], v[160:163], v[16:19]
    v_exp_f32 v149, v149
    v_mfma_f32_16x16x32_bf16 v[48:51], a[176:179], v[164:167], v[48:51]
    v_cvt_pk_bf16_f32 v169, v146, v147
    v_fma_f32 v151, v151, s28, -v195
    v_mfma_f32_16x16x32_bf16 v[20:23], a[180:183], v[160:163], v[20:23]
    v_exp_f32 v150, v150
    v_mfma_f32_16x16x32_bf16 v[52:55], a[180:183], v[164:167], v[52:55]
    v_fma_f32 v152, v152, s28, -v194
    v_cvt_pk_bf16_f32 v172, v148, v149
    v_mfma_f32_16x16x32_bf16 v[24:27], a[184:187], v[160:163], v[24:27]
    v_exp_f32 v151, v151
    v_mfma_f32_16x16x32_bf16 v[56:59], a[184:187], v[164:167], v[56:59]
    v_fma_f32 v153, v153, s28, -v194
    v_fma_f32 v154, v154, s28, -v194
    v_mfma_f32_16x16x32_bf16 v[28:31], a[188:191], v[160:163], v[28:31]
    v_exp_f32 v152, v152
    v_mfma_f32_16x16x32_bf16 v[60:63], a[188:191], v[164:167], v[60:63]
    s_waitcnt lgkmcnt(0)
    v_exp_f32 v153, v153
    v_mfma_f32_16x16x32_bf16 v[128:131], a[128:131], a[0:3], 0
    v_cvt_pk_bf16_f32 v173, v150, v151
    v_fma_f32 v155, v155, s28, -v194
    v_mfma_f32_16x16x32_bf16 v[128:131], a[132:135], a[4:7], v[128:131]
    v_exp_f32 v154, v154
    v_mfma_f32_16x16x32_bf16 v[128:131], a[136:139], a[8:11], v[128:131]
    v_fma_f32 v156, v156, s28, -v195
    v_cvt_pk_bf16_f32 v170, v152, v153
    v_mfma_f32_16x16x32_bf16 v[128:131], a[140:143], a[12:15], v[128:131]
    v_exp_f32 v155, v155
    v_mfma_f32_16x16x32_bf16 v[132:135], a[128:131], a[16:19], 0
    v_fma_f32 v157, v157, s28, -v195
    v_fma_f32 v158, v158, s28, -v195
    v_mfma_f32_16x16x32_bf16 v[132:135], a[132:135], a[20:23], v[132:135]
    v_exp_f32 v156, v156
    v_mfma_f32_16x16x32_bf16 v[132:135], a[136:139], a[24:27], v[132:135]
    v_exp_f32 v157, v157
    v_mfma_f32_16x16x32_bf16 v[132:135], a[140:143], a[28:31], v[132:135]
    v_cvt_pk_bf16_f32 v171, v154, v155
    v_fma_f32 v159, v159, s28, -v195
    v_mfma_f32_16x16x32_bf16 v[136:139], a[144:147], a[0:3], 0
    v_exp_f32 v158, v158
    v_mfma_f32_16x16x32_bf16 v[136:139], a[148:151], a[4:7], v[136:139]
    v_exp_f32 v159, v159
    v_mfma_f32_16x16x32_bf16 v[136:139], a[152:155], a[8:11], v[136:139]
    v_cvt_pk_bf16_f32 v174, v156, v157
    v_cvt_pk_bf16_f32 v175, v158, v159
    v_mfma_f32_16x16x32_bf16 v[136:139], a[156:159], a[12:15], v[136:139]
    v_fma_f32 v128, v128, s28, -v192
    v_fma_f32 v129, v129, s28, -v192
    v_mfma_f32_16x16x32_bf16 v[140:143], a[144:147], a[16:19], 0
    v_exp_f32 v128, v128
    v_mfma_f32_16x16x32_bf16 v[140:143], a[148:151], a[20:23], v[140:143]
    v_fma_f32 v130, v130, s28, -v192
    v_fma_f32 v131, v131, s28, -v192
    v_mfma_f32_16x16x32_bf16 v[140:143], a[152:155], a[24:27], v[140:143]
    s_waitcnt vmcnt(17)
    s_barrier
    v_exp_f32 v129, v129
    v_mfma_f32_16x16x32_bf16 v[140:143], a[156:159], a[28:31], v[140:143]
    v_exp_f32 v130, v130
    v_mfma_f32_16x16x32_bf16 v[64:67], a[160:163], v[168:171], v[64:67]
    v_fma_f32 v132, v132, s28, -v193
    v_cvt_pk_bf16_f32 v160, v128, v129
    v_mfma_f32_16x16x32_bf16 v[96:99], a[160:163], v[172:175], v[96:99]
    ds_read_b64_tr_b16 a[160:161], v200 offset:32768
    v_fma_f32 v133, v133, s28, -v193
    v_mfma_f32_16x16x32_bf16 v[68:71], a[164:167], v[168:171], v[68:71]
    ds_read_b64_tr_b16 a[162:163], v200 offset:36864
    v_fma_f32 v134, v134, s28, -v193
    v_mfma_f32_16x16x32_bf16 v[100:103], a[164:167], v[172:175], v[100:103]
    ds_read_b64_tr_b16 a[164:165], v201 offset:32768
    v_fma_f32 v135, v135, s28, -v193
    v_mfma_f32_16x16x32_bf16 v[184:187], v[220:223], v[168:171], v[184:187]
    ds_read_b64_tr_b16 a[166:167], v201 offset:36864
    v_fma_f32 v136, v136, s28, -v192
    v_mfma_f32_16x16x32_bf16 v[72:75], a[168:171], v[168:171], v[72:75]
    v_exp_f32 v131, v131
    v_mfma_f32_16x16x32_bf16 v[188:191], v[220:223], v[172:175], v[188:191]
    v_exp_f32 v132, v132
    v_mfma_f32_16x16x32_bf16 v[104:107], a[168:171], v[172:175], v[104:107]
    ds_read_b64_tr_b16 a[168:169], v202 offset:32768
    v_cvt_pk_bf16_f32 v161, v130, v131
    v_mfma_f32_16x16x32_bf16 v[76:79], a[172:175], v[168:171], v[76:79]
    ds_read_b64_tr_b16 a[170:171], v202 offset:36864
    v_fma_f32 v137, v137, s28, -v192
    v_mfma_f32_16x16x32_bf16 v[108:111], a[172:175], v[172:175], v[108:111]
    ds_read_b64_tr_b16 a[172:173], v203 offset:32768
    v_fma_f32 v138, v138, s28, -v192
    v_mfma_f32_16x16x32_bf16 v[80:83], a[176:179], v[168:171], v[80:83]
    ds_read_b64_tr_b16 a[174:175], v203 offset:36864
    v_exp_f32 v133, v133
    v_mfma_f32_16x16x32_bf16 v[112:115], a[176:179], v[172:175], v[112:115]
    ds_read_b64_tr_b16 a[176:177], v204 offset:32768
    v_cvt_pk_bf16_f32 v164, v132, v133
    v_mfma_f32_16x16x32_bf16 v[84:87], a[180:183], v[168:171], v[84:87]
    ds_read_b64_tr_b16 a[178:179], v204 offset:36864
    v_fma_f32 v139, v139, s28, -v192
    v_mfma_f32_16x16x32_bf16 v[116:119], a[180:183], v[172:175], v[116:119]
    ds_read_b64_tr_b16 a[180:181], v205 offset:32768
    v_exp_f32 v134, v134
    v_mfma_f32_16x16x32_bf16 v[88:91], a[184:187], v[168:171], v[88:91]
    ds_read_b64_tr_b16 a[182:183], v205 offset:36864
    v_fma_f32 v140, v140, s28, -v193
    v_mfma_f32_16x16x32_bf16 v[120:123], a[184:187], v[172:175], v[120:123]
    ds_read_b64_tr_b16 a[184:185], v206 offset:32768
    v_exp_f32 v135, v135
    v_mfma_f32_16x16x32_bf16 v[92:95], a[188:191], v[168:171], v[92:95]
    ds_read_b64_tr_b16 a[186:187], v206 offset:36864
    v_cvt_pk_bf16_f32 v165, v134, v135
    v_mfma_f32_16x16x32_bf16 v[124:127], a[188:191], v[172:175], v[124:127]
    ds_read_b64_tr_b16 a[188:189], v207 offset:32768
    v_fma_f32 v141, v141, s28, -v193
    v_mfma_f32_16x16x32_bf16 v[144:147], a[128:131], a[32:35], 0
    ds_read_b64_tr_b16 a[190:191], v207 offset:36864
    v_exp_f32 v136, v136
    v_mfma_f32_16x16x32_bf16 v[144:147], a[132:135], a[36:39], v[144:147]
    v_exp_f32 v137, v137
    v_mfma_f32_16x16x32_bf16 v[144:147], a[136:139], a[40:43], v[144:147]
    v_exp_f32 v138, v138
    v_mfma_f32_16x16x32_bf16 v[144:147], a[140:143], a[44:47], v[144:147]
    v_exp_f32 v139, v139
    v_mfma_f32_16x16x32_bf16 v[148:151], a[128:131], a[48:51], 0
    ds_read_b128 a[128:131], v196 offset:40960
    v_cvt_pk_bf16_f32 v162, v136, v137
    v_mfma_f32_16x16x32_bf16 v[148:151], a[132:135], a[52:55], v[148:151]
    ds_read_b128 a[132:135], v197 offset:40960
    v_fma_f32 v142, v142, s28, -v193
    v_mfma_f32_16x16x32_bf16 v[148:151], a[136:139], a[56:59], v[148:151]
    ds_read_b128 a[136:139], v198 offset:40960
    v_cvt_pk_bf16_f32 v163, v138, v139
    v_mfma_f32_16x16x32_bf16 v[148:151], a[140:143], a[60:63], v[148:151]
    ds_read_b128 a[140:143], v199 offset:40960
    v_fma_f32 v143, v143, s28, -v193
    v_mfma_f32_16x16x32_bf16 v[152:155], a[144:147], a[32:35], 0
    v_exp_f32 v140, v140
    v_mfma_f32_16x16x32_bf16 v[152:155], a[148:151], a[36:39], v[152:155]
    v_exp_f32 v141, v141
    v_mfma_f32_16x16x32_bf16 v[152:155], a[152:155], a[40:43], v[152:155]
    v_exp_f32 v142, v142
    v_mfma_f32_16x16x32_bf16 v[152:155], a[156:159], a[44:47], v[152:155]
    v_exp_f32 v143, v143
    v_mfma_f32_16x16x32_bf16 v[156:159], a[144:147], a[48:51], 0
    ds_read_b128 a[144:147], v196 offset:45056
    v_cvt_pk_bf16_f32 v166, v140, v141
    v_mfma_f32_16x16x32_bf16 v[156:159], a[148:151], a[52:55], v[156:159]
    ds_read_b128 a[148:151], v197 offset:45056
    v_cvt_pk_bf16_f32 v167, v142, v143
    v_mfma_f32_16x16x32_bf16 v[156:159], a[152:155], a[56:59], v[156:159]
    ds_read_b128 a[152:155], v198 offset:45056
    v_fma_f32 v144, v144, s28, -v194
    v_mfma_f32_16x16x32_bf16 v[156:159], a[156:159], a[60:63], v[156:159]
    s_waitcnt lgkmcnt(7)
    ds_read_b128 a[156:159], v199 offset:45056
    v_fma_f32 v145, v145, s28, -v194
    v_mfma_f32_16x16x32_bf16 v[0:3], a[160:163], v[160:163], v[0:3]
    v_exp_f32 v144, v144
    v_mfma_f32_16x16x32_bf16 v[32:35], a[160:163], v[164:167], v[32:35]
    s_add_u32 m0, s34, 0x14000
    v_fma_f32 v146, v146, s28, -v194
    v_fma_f32 v147, v147, s28, -v194
    v_mfma_f32_16x16x32_bf16 v[4:7], a[164:167], v[160:163], v[4:7]
    buffer_load_dwordx4 v210, s[16:19], 0 offen nt lds
    buffer_load_dwordx4 v211, s[16:19], 0 offen offset:1024 nt lds
    v_mfma_f32_16x16x32_bf16 v[36:39], a[164:167], v[164:167], v[36:39]
    s_add_u32 s16, s16, 0x2000
    v_exp_f32 v145, v145
    v_mfma_f32_16x16x32_bf16 v[176:179], v[220:223], v[160:163], v[176:179]
    s_addc_u32 s17, s17, 0
    v_exp_f32 v146, v146
    v_mfma_f32_16x16x32_bf16 v[8:11], a[168:171], v[160:163], v[8:11]
    v_fma_f32 v148, v148, s28, -v195
    v_cvt_pk_bf16_f32 v168, v144, v145
    v_mfma_f32_16x16x32_bf16 v[180:183], v[220:223], v[164:167], v[180:183]
    s_add_u32 m0, s34, 0x6000
    v_exp_f32 v147, v147
    v_mfma_f32_16x16x32_bf16 v[40:43], a[168:171], v[164:167], v[40:43]
    buffer_load_dwordx4 v208, s[12:15], 0 offen nt lds
    buffer_load_dwordx4 v209, s[12:15], 0 offen offset:1024 nt lds
    v_mfma_f32_16x16x32_bf16 v[12:15], a[172:175], v[160:163], v[12:15]
    s_add_u32 s12, s12, 0x2000
    v_fma_f32 v149, v149, s28, -v195
    v_fma_f32 v150, v150, s28, -v195
    v_mfma_f32_16x16x32_bf16 v[44:47], a[172:175], v[164:167], v[44:47]
    s_addc_u32 s13, s13, 0
    v_exp_f32 v148, v148
    v_mfma_f32_16x16x32_bf16 v[16:19], a[176:179], v[160:163], v[16:19]
    v_exp_f32 v149, v149
    v_mfma_f32_16x16x32_bf16 v[48:51], a[176:179], v[164:167], v[48:51]
    v_cvt_pk_bf16_f32 v169, v146, v147
    v_fma_f32 v151, v151, s28, -v195
    v_mfma_f32_16x16x32_bf16 v[20:23], a[180:183], v[160:163], v[20:23]
    v_exp_f32 v150, v150
    v_mfma_f32_16x16x32_bf16 v[52:55], a[180:183], v[164:167], v[52:55]
    v_fma_f32 v152, v152, s28, -v194
    v_cvt_pk_bf16_f32 v172, v148, v149
    v_mfma_f32_16x16x32_bf16 v[24:27], a[184:187], v[160:163], v[24:27]
    v_exp_f32 v151, v151
    v_mfma_f32_16x16x32_bf16 v[56:59], a[184:187], v[164:167], v[56:59]
    v_fma_f32 v153, v153, s28, -v194
    v_fma_f32 v154, v154, s28, -v194
    v_mfma_f32_16x16x32_bf16 v[28:31], a[188:191], v[160:163], v[28:31]
    v_exp_f32 v152, v152
    v_mfma_f32_16x16x32_bf16 v[60:63], a[188:191], v[164:167], v[60:63]
    s_waitcnt lgkmcnt(0)
    v_exp_f32 v153, v153
L_join:
    v_mfma_f32_16x16x32_bf16 v[128:131], a[128:131], a[0:3], 0
    v_cvt_pk_bf16_f32 v173, v150, v151
    v_fma_f32 v155, v155, s28, -v194
    v_mfma_f32_16x16x32_bf16 v[128:131], a[132:135], a[4:7], v[128:131]
    s_add_u32 s38, s32, 0
    v_exp_f32 v154, v154
    v_mfma_f32_16x16x32_bf16 v[128:131], a[136:139], a[8:11], v[128:131]
    buffer_store_dwordx4 a[196:199], v214, s[20:23], s38 offen offset:1024 sc1
    v_fma_f32 v156, v156, s28, -v195
    v_exp_f32 v155, v155
    v_mfma_f32_16x16x32_bf16 v[128:131], a[140:143], a[12:15], v[128:131]
    v_cvt_pk_bf16_f32 v170, v152, v153
    v_fma_f32 v157, v157, s28, -v195
    v_mfma_f32_16x16x32_bf16 v[132:135], a[128:131], a[16:19], 0
    v_exp_f32 v156, v156
    v_mfma_f32_16x16x32_bf16 v[132:135], a[132:135], a[20:23], v[132:135]
    v_fma_f32 v158, v158, s28, -v195
    v_cvt_pk_bf16_f32 v171, v154, v155
    v_mfma_f32_16x16x32_bf16 v[132:135], a[136:139], a[24:27], v[132:135]
    v_exp_f32 v157, v157
    v_mfma_f32_16x16x32_bf16 v[132:135], a[140:143], a[28:31], v[132:135]
    v_fma_f32 v159, v159, s28, -v195
    v_cvt_pk_bf16_f32 v174, v156, v157
    v_mfma_f32_16x16x32_bf16 v[136:139], a[144:147], a[0:3], 0
    v_exp_f32 v158, v158
    v_mfma_f32_16x16x32_bf16 v[136:139], a[148:151], a[4:7], v[136:139]
    v_exp_f32 v159, v159
    v_mfma_f32_16x16x32_bf16 v[136:139], a[152:155], a[8:11], v[136:139]
    v_cvt_pk_bf16_f32 v175, v158, v159
    v_fma_f32 v128, v128, s28, -v192
    v_mfma_f32_16x16x32_bf16 v[136:139], a[156:159], a[12:15], v[136:139]
    v_fma_f32 v129, v129, s28, -v192
    v_fma_f32 v130, v130, s28, -v192
    v_mfma_f32_16x16x32_bf16 v[140:143], a[144:147], a[16:19], 0
    v_exp_f32 v128, v128
    v_mfma_f32_16x16x32_bf16 v[140:143], a[148:151], a[20:23], v[140:143]
    v_exp_f32 v129, v129
    v_mfma_f32_16x16x32_bf16 v[140:143], a[152:155], a[24:27], v[140:143]
    v_fma_f32 v131, v131, s28, -v192
    v_fma_f32 v132, v132, s28, -v193
    v_mfma_f32_16x16x32_bf16 v[140:143], a[156:159], a[28:31], v[140:143]
    v_exp_f32 v130, v130
    v_mfma_f32_16x16x32_bf16 v[64:67], a[160:163], v[168:171], v[64:67]
    v_exp_f32 v131, v131
    v_mfma_f32_16x16x32_bf16 v[96:99], a[160:163], v[172:175], v[96:99]
    ds_read_b64_tr_b16 a[160:161], v200 offset:40960
    v_cvt_pk_bf16_f32 v160, v128, v129
    v_mfma_f32_16x16x32_bf16 v[68:71], a[164:167], v[168:171], v[68:71]
    ds_read_b64_tr_b16 a[162:163], v200 offset:45056
    v_fma_f32 v133, v133, s28, -v193
    v_mfma_f32_16x16x32_bf16 v[100:103], a[164:167], v[172:175], v[100:103]
    ds_read_b64_tr_b16 a[164:165], v201 offset:40960
    v_fma_f32 v134, v134, s28, -v193
    v_mfma_f32_16x16x32_bf16 v[184:187], v[220:223], v[168:171], v[184:187]
    ds_read_b64_tr_b16 a[166:167], v201 offset:45056
    v_cvt_pk_bf16_f32 v161, v130, v131
    v_mfma_f32_16x16x32_bf16 v[72:75], a[168:171], v[168:171], v[72:75]
    v_exp_f32 v132, v132
    v_mfma_f32_16x16x32_bf16 v[188:191], v[220:223], v[172:175], v[188:191]
    v_exp_f32 v133, v133
    v_mfma_f32_16x16x32_bf16 v[104:107], a[168:171], v[172:175], v[104:107]
    ds_read_b64_tr_b16 a[168:169], v202 offset:40960
    v_fma_f32 v135, v135, s28, -v193
    v_mfma_f32_16x16x32_bf16 v[76:79], a[172:175], v[168:171], v[76:79]
    ds_read_b64_tr_b16 a[170:171], v202 offset:45056
    v_fma_f32 v136, v136, s28, -v192
    v_mfma_f32_16x16x32_bf16 v[108:111], a[172:175], v[172:175], v[108:111]
    ds_read_b64_tr_b16 a[172:173], v203 offset:40960
    v_cvt_pk_bf16_f32 v164, v132, v133
    v_mfma_f32_16x16x32_bf16 v[80:83], a[176:179], v[168:171], v[80:83]
    ds_read_b64_tr_b16 a[174:175], v203 offset:45056
    v_fma_f32 v137, v137, s28, -v192
    v_mfma_f32_16x16x32_bf16 v[112:115], a[176:179], v[172:175], v[112:115]
    ds_read_b64_tr_b16 a[176:177], v204 offset:40960
    v_fma_f32 v138, v138, s28, -v192
    v_mfma_f32_16x16x32_bf16 v[84:87], a[180:183], v[168:171], v[84:87]
    ds_read_b64_tr_b16 a[178:179], v204 offset:45056
    v_fma_f32 v139, v139, s28, -v192
    v_mfma_f32_16x16x32_bf16 v[116:119], a[180:183], v[172:175], v[116:119]
    ds_read_b64_tr_b16 a[180:181], v205 offset:40960
    v_exp_f32 v134, v134
    v_mfma_f32_16x16x32_bf16 v[88:91], a[184:187], v[168:171], v[88:91]
    ds_read_b64_tr_b16 a[182:183], v205 offset:45056
    v_fma_f32 v140, v140, s28, -v193
    v_mfma_f32_16x16x32_bf16 v[120:123], a[184:187], v[172:175], v[120:123]
    ds_read_b64_tr_b16 a[184:185], v206 offset:40960
    v_exp_f32 v135, v135
    v_mfma_f32_16x16x32_bf16 v[92:95], a[188:191], v[168:171], v[92:95]
    ds_read_b64_tr_b16 a[186:187], v206 offset:45056
    v_cvt_pk_bf16_f32 v165, v134, v135
    v_mfma_f32_16x16x32_bf16 v[124:127], a[188:191], v[172:175], v[124:127]
    ds_read_b64_tr_b16 a[188:189], v207 offset:40960
    v_fma_f32 v141, v141, s28, -v193
    v_mfma_f32_16x16x32_bf16 v[144:147], a[128:131], a[32:35], 0
    ds_read_b64_tr_b16 a[190:191], v207 offset:45056
    v_exp_f32 v136, v136
    v_mfma_f32_16x16x32_bf16 v[144:147], a[132:135], a[36:39], v[144:147]
    s_waitcnt lgkmcnt(15)
    v_exp_f32 v137, v137
    v_mfma_f32_16x16x32_bf16 v[144:147], a[136:139], a[40:43], v[144:147]
    s_add_u32 m0, s35, 0
    v_exp_f32 v138, v138
    v_mfma_f32_16x16x32_bf16 v[144:147], a[140:143], a[44:47], v[144:147]
    buffer_load_dwordx4 v215, s[8:11], 0 offen nt lds
    buffer_load_dwordx4 v216, s[8:11], 0 offen offset:1024 nt lds
    v_mfma_f32_16x16x32_bf16 v[148:151], a[128:131], a[48:51], 0
    ds_read_b128 a[128:131], v196 offset:49152
    v_cvt_pk_bf16_f32 v162, v136, v137
    v_mfma_f32_16x16x32_bf16 v[148:151], a[132:135], a[52:55], v[148:151]
    ds_read_b128 a[132:135], v197 offset:49152
    v_fma_f32 v142, v142, s28, -v193
    v_mfma_f32_16x16x32_bf16 v[148:151], a[136:139], a[56:59], v[148:151]
    ds_read_b128 a[136:139], v198 offset:49152
    v_fma_f32 v143, v143, s28, -v193
    v_mfma_f32_16x16x32_bf16 v[148:151], a[140:143], a[60:63], v[148:151]
    ds_read_b128 a[140:143], v199 offset:49152
    v_exp_f32 v139, v139
    v_mfma_f32_16x16x32_bf16 v[152:155], a[144:147], a[32:35], 0
    buffer_load_dwordx4 v217, s[8:11], 0 offen offset:2048 nt lds
    buffer_load_dwordx4 v218, s[8:11], 0 offen offset:3072 nt lds
    v_mfma_f32_16x16x32_bf16 v[152:155], a[148:151], a[36:39], v[152:155]
    s_add_u32 s8, s8, 0x1000
    s_addc_u32 s9, s9, 0
    v_cvt_pk_bf16_f32 v163, v138, v139
    v_mfma_f32_16x16x32_bf16 v[152:155], a[152:155], a[40:43], v[152:155]
    v_exp_f32 v140, v140
    v_mfma_f32_16x16x32_bf16 v[152:155], a[156:159], a[44:47], v[152:155]
    v_exp_f32 v141, v141
    v_mfma_f32_16x16x32_bf16 v[156:159], a[144:147], a[48:51], 0
    ds_read_b128 a[144:147], v196 offset:53248
    v_cvt_pk_bf16_f32 v166, v140, v141
    v_mfma_f32_16x16x32_bf16 v[156:159], a[148:151], a[52:55], v[156:159]
    ds_read_b128 a[148:151], v197 offset:53248
    v_fma_f32 v144, v144, s28, -v194
    v_mfma_f32_16x16x32_bf16 v[156:159], a[152:155], a[56:59], v[156:159]
    ds_read_b128 a[152:155], v198 offset:53248
    v_fma_f32 v145, v145, s28, -v194
    v_mfma_f32_16x16x32_bf16 v[156:159], a[156:159], a[60:63], v[156:159]
    s_waitcnt lgkmcnt(7)
    ds_read_b128 a[156:159], v199 offset:53248
    v_fma_f32 v146, v146, s28, -v194
    v_mfma_f32_16x16x32_bf16 v[0:3], a[160:163], v[160:163], v[0:3]
    v_exp_f32 v142, v142
    v_exp_f32 v143, v143
    s_nop 0
    v_cvt_pk_bf16_f32 v167, v142, v143
    s_nop 1
    v_mfma_f32_16x16x32_bf16 v[32:35], a[160:163], v[164:167], v[32:35]
    s_add_u32 m0, s34, 0x16000
    v_exp_f32 v144, v144
    v_mfma_f32_16x16x32_bf16 v[4:7], a[164:167], v[160:163], v[4:7]
    buffer_load_dwordx4 v210, s[16:19], 0 offen nt lds
    buffer_load_dwordx4 v211, s[16:19], 0 offen offset:1024 nt lds
    v_mfma_f32_16x16x32_bf16 v[36:39], a[164:167], v[164:167], v[36:39]
    s_add_u32 s16, s16, 0x2000
    v_exp_f32 v145, v145
    v_mfma_f32_16x16x32_bf16 v[176:179], v[220:223], v[160:163], v[176:179]
    s_addc_u32 s17, s17, 0
    v_fma_f32 v147, v147, s28, -v194
    v_fma_f32 v148, v148, s28, -v195
    v_mfma_f32_16x16x32_bf16 v[8:11], a[168:171], v[160:163], v[8:11]
    v_exp_f32 v146, v146
    v_mfma_f32_16x16x32_bf16 v[180:183], v[220:223], v[164:167], v[180:183]
    s_add_u32 m0, s34, 0x8000
    v_exp_f32 v147, v147
    v_mfma_f32_16x16x32_bf16 v[40:43], a[168:171], v[164:167], v[40:43]
    buffer_load_dwordx4 v208, s[12:15], 0 offen nt lds
    buffer_load_dwordx4 v209, s[12:15], 0 offen offset:1024 nt lds
    v_mfma_f32_16x16x32_bf16 v[12:15], a[172:175], v[160:163], v[12:15]
    s_add_u32 s12, s12, 0x2000
    v_cvt_pk_bf16_f32 v168, v144, v145
    v_fma_f32 v149, v149, s28, -v195
    v_mfma_f32_16x16x32_bf16 v[44:47], a[172:175], v[164:167], v[44:47]
    s_addc_u32 s13, s13, 0
    v_exp_f32 v148, v148
    v_mfma_f32_16x16x32_bf16 v[16:19], a[176:179], v[160:163], v[16:19]
    v_fma_f32 v150, v150, s28, -v195
    v_cvt_pk_bf16_f32 v169, v146, v147
    v_mfma_f32_16x16x32_bf16 v[48:51], a[176:179], v[164:167], v[48:51]
    v_exp_f32 v149, v149
    v_mfma_f32_16x16x32_bf16 v[20:23], a[180:183], v[160:163], v[20:23]
    v_fma_f32 v151, v151, s28, -v195
    v_fma_f32 v152, v152, s28, -v194
    v_mfma_f32_16x16x32_bf16 v[52:55], a[180:183], v[164:167], v[52:55]
    v_exp_f32 v150, v150
    v_mfma_f32_16x16x32_bf16 v[24:27], a[184:187], v[160:163], v[24:27]
    v_exp_f32 v151, v151
    v_mfma_f32_16x16x32_bf16 v[56:59], a[184:187], v[164:167], v[56:59]
    v_cvt_pk_bf16_f32 v172, v148, v149
    v_fma_f32 v153, v153, s28, -v194
    v_mfma_f32_16x16x32_bf16 v[28:31], a[188:191], v[160:163], v[28:31]
    v_exp_f32 v152, v152
    v_mfma_f32_16x16x32_bf16 v[60:63], a[188:191], v[164:167], v[60:63]
    s_waitcnt lgkmcnt(0)
    v_fma_f32 v154, v154, s28, -v194
    v_cvt_pk_bf16_f32 v173, v150, v151
    v_mfma_f32_16x16x32_bf16 v[128:131], a[128:131], a[0:3], 0
    v_exp_f32 v153, v153
    v_mfma_f32_16x16x32_bf16 v[128:131], a[132:135], a[4:7], v[128:131]
    v_fma_f32 v155, v155, s28, -v194
    v_fma_f32 v156, v156, s28, -v195
    v_mfma_f32_16x16x32_bf16 v[128:131], a[136:139], a[8:11], v[128:131]
    v_exp_f32 v154, v154
    v_mfma_f32_16x16x32_bf16 v[128:131], a[140:143], a[12:15], v[128:131]
    v_exp_f32 v155, v155
    v_mfma_f32_16x16x32_bf16 v[132:135], a[128:131], a[16:19], 0
    v_cvt_pk_bf16_f32 v170, v152, v153
    v_fma_f32 v157, v157, s28, -v195
    v_mfma_f32_16x16x32_bf16 v[132:135], a[132:135], a[20:23], v[132:135]
    v_exp_f32 v156, v156
    v_mfma_f32_16x16x32_bf16 v[132:135], a[136:139], a[24:27], v[132:135]
    v_fma_f32 v158, v158, s28, -v195
    v_cvt_pk_bf16_f32 v171, v154, v155
    v_mfma_f32_16x16x32_bf16 v[132:135], a[140:143], a[28:31], v[132:135]
    v_exp_f32 v157, v157
    v_mfma_f32_16x16x32_bf16 v[136:139], a[144:147], a[0:3], 0
    v_fma_f32 v159, v159, s28, -v195
    v_cvt_pk_bf16_f32 v174, v156, v157
    v_mfma_f32_16x16x32_bf16 v[136:139], a[148:151], a[4:7], v[136:139]
    v_exp_f32 v158, v158
    v_mfma_f32_16x16x32_bf16 v[136:139], a[152:155], a[8:11], v[136:139]
    v_exp_f32 v159, v159
    v_mfma_f32_16x16x32_bf16 v[136:139], a[156:159], a[12:15], v[136:139]
    v_cvt_pk_bf16_f32 v175, v158, v159
    v_fma_f32 v128, v128, s28, -v192
    v_mfma_f32_16x16x32_bf16 v[140:143], a[144:147], a[16:19], 0
    v_fma_f32 v129, v129, s28, -v192
    v_fma_f32 v130, v130, s28, -v192
    v_mfma_f32_16x16x32_bf16 v[140:143], a[148:151], a[20:23], v[140:143]
    v_exp_f32 v128, v128
    v_mfma_f32_16x16x32_bf16 v[140:143], a[152:155], a[24:27], v[140:143]
    s_waitcnt vmcnt(21)
    s_barrier
    v_exp_f32 v129, v129
    v_mfma_f32_16x16x32_bf16 v[140:143], a[156:159], a[28:31], v[140:143]
    v_fma_f32 v131, v131, s28, -v192
    v_fma_f32 v132, v132, s28, -v193
    v_mfma_f32_16x16x32_bf16 v[64:67], a[160:163], v[168:171], v[64:67]
    v_exp_f32 v130, v130
    v_mfma_f32_16x16x32_bf16 v[96:99], a[160:163], v[172:175], v[96:99]
    ds_read_b64_tr_b16 a[160:161], v200 offset:49152
    v_cvt_pk_bf16_f32 v160, v128, v129
    v_mfma_f32_16x16x32_bf16 v[68:71], a[164:167], v[168:171], v[68:71]
    ds_read_b64_tr_b16 a[162:163], v200 offset:53248
    v_fma_f32 v133, v133, s28, -v193
    v_mfma_f32_16x16x32_bf16 v[100:103], a[164:167], v[172:175], v[100:103]
    ds_read_b64_tr_b16 a[164:165], v201 offset:49152
    v_fma_f32 v134, v134, s28, -v193
    v_mfma_f32_16x16x32_bf16 v[184:187], v[220:223], v[168:171], v[184:187]
    ds_read_b64_tr_b16 a[166:167], v201 offset:53248
    v_fma_f32 v135, v135, s28, -v193
    v_mfma_f32_16x16x32_bf16 v[72:75], a[168:171], v[168:171], v[72:75]
    v_exp_f32 v131, v131
    v_mfma_f32_16x16x32_bf16 v[188:191], v[220:223], v[172:175], v[188:191]
    v_exp_f32 v132, v132
    v_mfma_f32_16x16x32_bf16 v[104:107], a[168:171], v[172:175], v[104:107]
    ds_read_b64_tr_b16 a[168:169], v202 offset:49152
    v_cvt_pk_bf16_f32 v161, v130, v131
    v_mfma_f32_16x16x32_bf16 v[76:79], a[172:175], v[168:171], v[76:79]
    ds_read_b64_tr_b16 a[170:171], v202 offset:53248
    v_fma_f32 v136, v136, s28, -v192
    v_mfma_f32_16x16x32_bf16 v[108:111], a[172:175], v[172:175], v[108:111]
    ds_read_b64_tr_b16 a[172:173], v203 offset:49152
    v_fma_f32 v137, v137, s28, -v192
    v_mfma_f32_16x16x32_bf16 v[80:83], a[176:179], v[168:171], v[80:83]
    ds_read_b64_tr_b16 a[174:175], v203 offset:53248
    v_fma_f32 v138, v138, s28, -v192
    v_mfma_f32_16x16x32_bf16 v[112:115], a[176:179], v[172:175], v[112:115]
    ds_read_b64_tr_b16 a[176:177], v204 offset:49152
    v_exp_f32 v133, v133
    v_mfma_f32_16x16x32_bf16 v[84:87], a[180:183], v[168:171], v[84:87]
    ds_read_b64_tr_b16 a[178:179], v204 offset:53248
    v_cvt_pk_bf16_f32 v164, v132, v133
    v_mfma_f32_16x16x32_bf16 v[116:119], a[180:183], v[172:175], v[116:119]
    ds_read_b64_tr_b16 a[180:181], v205 offset:49152
    v_fma_f32 v139, v139, s28, -v192
    v_mfma_f32_16x16x32_bf16 v[88:91], a[184:187], v[168:171], v[88:91]
    ds_read_b64_tr_b16 a[182:183], v205 offset:53248
    v_exp_f32 v134, v134
    v_mfma_f32_16x16x32_bf16 v[120:123], a[184:187], v[172:175], v[120:123]
    ds_read_b64_tr_b16 a[184:185], v206 offset:49152
    v_fma_f32 v140, v140, s28, -v193
    v_mfma_f32_16x16x32_bf16 v[92:95], a[188:191], v[168:171], v[92:95]
    ds_read_b64_tr_b16 a[186:187], v206 offset:53248
    v_exp_f32 v135, v135
    v_mfma_f32_16x16x32_bf16 v[124:127], a[188:191], v[172:175], v[124:127]
    ds_read_b64_tr_b16 a[188:189], v207 offset:49152
    v_cvt_pk_bf16_f32 v165, v134, v135
    v_mfma_f32_16x16x32_bf16 v[144:147], a[128:131], a[32:35], 0
    ds_read_b64_tr_b16 a[190:191], v207 offset:53248
    v_fma_f32 v141, v141, s28, -v193
    v_mfma_f32_16x16x32_bf16 v[144:147], a[132:135], a[36:39], v[144:147]
    v_exp_f32 v136, v136
    v_mfma_f32_16x16x32_bf16 v[144:147], a[136:139], a[40:43], v[144:147]
    v_exp_f32 v137, v137
    v_mfma_f32_16x16x32_bf16 v[144:147], a[140:143], a[44:47], v[144:147]
    v_exp_f32 v138, v138
    v_mfma_f32_16x16x32_bf16 v[148:151], a[128:131], a[48:51], 0
    ds_read_b128 a[128:131], v196 offset:57344
    v_cvt_pk_bf16_f32 v162, v136, v137
    v_mfma_f32_16x16x32_bf16 v[148:151], a[132:135], a[52:55], v[148:151]
    ds_read_b128 a[132:135], v197 offset:57344
    v_fma_f32 v142, v142, s28, -v193
    v_mfma_f32_16x16x32_bf16 v[148:151], a[136:139], a[56:59], v[148:151]
    ds_read_b128 a[136:139], v198 offset:57344
    v_fma_f32 v143, v143, s28, -v193
    v_mfma_f32_16x16x32_bf16 v[148:151], a[140:143], a[60:63], v[148:151]
    ds_read_b128 a[140:143], v199 offset:57344
    v_exp_f32 v139, v139
    v_mfma_f32_16x16x32_bf16 v[152:155], a[144:147], a[32:35], 0
    v_exp_f32 v140, v140
    v_mfma_f32_16x16x32_bf16 v[152:155], a[148:151], a[36:39], v[152:155]
    v_exp_f32 v141, v141
    v_mfma_f32_16x16x32_bf16 v[152:155], a[152:155], a[40:43], v[152:155]
    v_cvt_pk_bf16_f32 v163, v138, v139
    v_cvt_pk_bf16_f32 v166, v140, v141
    v_mfma_f32_16x16x32_bf16 v[152:155], a[156:159], a[44:47], v[152:155]
    v_exp_f32 v142, v142
    v_mfma_f32_16x16x32_bf16 v[156:159], a[144:147], a[48:51], 0
    ds_read_b128 a[144:147], v196 offset:61440
    v_fma_f32 v144, v144, s28, -v194
    v_mfma_f32_16x16x32_bf16 v[156:159], a[148:151], a[52:55], v[156:159]
    ds_read_b128 a[148:151], v197 offset:61440
    v_fma_f32 v145, v145, s28, -v194
    v_mfma_f32_16x16x32_bf16 v[156:159], a[152:155], a[56:59], v[156:159]
    ds_read_b128 a[152:155], v198 offset:61440
    v_fma_f32 v146, v146, s28, -v194
    v_mfma_f32_16x16x32_bf16 v[156:159], a[156:159], a[60:63], v[156:159]
    s_waitcnt lgkmcnt(7)
    ds_read_b128 a[156:159], v199 offset:61440
    v_fma_f32 v147, v147, s28, -v194
    v_mfma_f32_16x16x32_bf16 v[0:3], a[160:163], v[160:163], v[0:3]
    v_exp_f32 v143, v143
    s_nop 0
    v_cvt_pk_bf16_f32 v167, v142, v143
    s_nop 1
    v_mfma_f32_16x16x32_bf16 v[32:35], a[160:163], v[164:167], v[32:35]
    s_add_u32 m0, s34, 0x18000
    v_exp_f32 v144, v144
    v_mfma_f32_16x16x32_bf16 v[4:7], a[164:167], v[160:163], v[4:7]
    buffer_load_dwordx4 v210, s[16:19], 0 offen nt lds
    buffer_load_dwordx4 v211, s[16:19], 0 offen offset:1024 nt lds
    v_mfma_f32_16x16x32_bf16 v[36:39], a[164:167], v[164:167], v[36:39]
    s_add_u32 s16, s16, 0x2000
    v_exp_f32 v145, v145
    v_mfma_f32_16x16x32_bf16 v[176:179], v[220:223], v[160:163], v[176:179]
    s_addc_u32 s17, s17, 0
    v_exp_f32 v146, v146
    v_mfma_f32_16x16x32_bf16 v[8:11], a[168:171], v[160:163], v[8:11]
    v_fma_f32 v148, v148, s28, -v195
    v_cvt_pk_bf16_f32 v168, v144, v145
    v_mfma_f32_16x16x32_bf16 v[180:183], v[220:223], v[164:167], v[180:183]
    s_add_u32 m0, s34, 0xa000
    v_exp_f32 v147, v147
    v_mfma_f32_16x16x32_bf16 v[40:43], a[168:171], v[164:167], v[40:43]
    buffer_load_dwordx4 v208, s[12:15], 0 offen nt lds
    buffer_load_dwordx4 v209, s[12:15], 0 offen offset:1024 nt lds
    v_mfma_f32_16x16x32_bf16 v[12:15], a[172:175], v[160:163], v[12:15]
    s_add_u32 s12, s12, 0x2000
    v_fma_f32 v149, v149, s28, -v195
    v_fma_f32 v150, v150, s28, -v195
    v_mfma_f32_16x16x32_bf16 v[44:47], a[172:175], v[164:167], v[44:47]
    s_addc_u32 s13, s13, 0
    v_exp_f32 v148, v148
    v_mfma_f32_16x16x32_bf16 v[16:19], a[176:179], v[160:163], v[16:19]
    v_exp_f32 v149, v149
    v_mfma_f32_16x16x32_bf16 v[48:51], a[176:179], v[164:167], v[48:51]
    v_cvt_pk_bf16_f32 v169, v146, v147
    v_fma_f32 v151, v151, s28, -v195
    v_mfma_f32_16x16x32_bf16 v[20:23], a[180:183], v[160:163], v[20:23]
    v_exp_f32 v150, v150
    v_mfma_f32_16x16x32_bf16 v[52:55], a[180:183], v[164:167], v[52:55]
    v_fma_f32 v152, v152, s28, -v194
    v_cvt_pk_bf16_f32 v172, v148, v149
    v_mfma_f32_16x16x32_bf16 v[24:27], a[184:187], v[160:163], v[24:27]
    v_exp_f32 v151, v151
    v_mfma_f32_16x16x32_bf16 v[56:59], a[184:187], v[164:167], v[56:59]
    v_fma_f32 v153, v153, s28, -v194
    v_fma_f32 v154, v154, s28, -v194
    v_mfma_f32_16x16x32_bf16 v[28:31], a[188:191], v[160:163], v[28:31]
    v_exp_f32 v152, v152
    v_mfma_f32_16x16x32_bf16 v[60:63], a[188:191], v[164:167], v[60:63]
    s_waitcnt lgkmcnt(0)
    v_exp_f32 v153, v153
    v_mfma_f32_16x16x32_bf16 v[128:131], a[128:131], a[0:3], 0
    v_cvt_pk_bf16_f32 v173, v150, v151
    v_fma_f32 v155, v155, s28, -v194
    v_mfma_f32_16x16x32_bf16 v[128:131], a[132:135], a[4:7], v[128:131]
    s_add_u32 s38, s32, 0
    v_exp_f32 v154, v154
    v_mfma_f32_16x16x32_bf16 v[128:131], a[136:139], a[8:11], v[128:131]
    buffer_store_dwordx4 a[200:203], v214, s[20:23], s38 offen offset:2048 sc1
    v_fma_f32 v156, v156, s28, -v195
    v_exp_f32 v155, v155
    v_mfma_f32_16x16x32_bf16 v[128:131], a[140:143], a[12:15], v[128:131]
    v_cvt_pk_bf16_f32 v170, v152, v153
    v_fma_f32 v157, v157, s28, -v195
    v_mfma_f32_16x16x32_bf16 v[132:135], a[128:131], a[16:19], 0
    v_exp_f32 v156, v156
    v_mfma_f32_16x16x32_bf16 v[132:135], a[132:135], a[20:23], v[132:135]
    v_fma_f32 v158, v158, s28, -v195
    v_cvt_pk_bf16_f32 v171, v154, v155
    v_mfma_f32_16x16x32_bf16 v[132:135], a[136:139], a[24:27], v[132:135]
    v_exp_f32 v157, v157
    v_mfma_f32_16x16x32_bf16 v[132:135], a[140:143], a[28:31], v[132:135]
    v_fma_f32 v159, v159, s28, -v195
    v_cvt_pk_bf16_f32 v174, v156, v157
    v_mfma_f32_16x16x32_bf16 v[136:139], a[144:147], a[0:3], 0
    v_exp_f32 v158, v158
    v_mfma_f32_16x16x32_bf16 v[136:139], a[148:151], a[4:7], v[136:139]
    v_exp_f32 v159, v159
    v_mfma_f32_16x16x32_bf16 v[136:139], a[152:155], a[8:11], v[136:139]
    v_cvt_pk_bf16_f32 v175, v158, v159
    v_fma_f32 v128, v128, s28, -v192
    v_mfma_f32_16x16x32_bf16 v[136:139], a[156:159], a[12:15], v[136:139]
    v_fma_f32 v129, v129, s28, -v192
    v_fma_f32 v130, v130, s28, -v192
    v_mfma_f32_16x16x32_bf16 v[140:143], a[144:147], a[16:19], 0
    v_exp_f32 v128, v128
    v_mfma_f32_16x16x32_bf16 v[140:143], a[148:151], a[20:23], v[140:143]
    v_exp_f32 v129, v129
    v_mfma_f32_16x16x32_bf16 v[140:143], a[152:155], a[24:27], v[140:143]
    v_fma_f32 v131, v131, s28, -v192
    v_fma_f32 v132, v132, s28, -v193
    v_mfma_f32_16x16x32_bf16 v[140:143], a[156:159], a[28:31], v[140:143]
    v_exp_f32 v130, v130
    v_mfma_f32_16x16x32_bf16 v[64:67], a[160:163], v[168:171], v[64:67]
    v_exp_f32 v131, v131
    v_mfma_f32_16x16x32_bf16 v[96:99], a[160:163], v[172:175], v[96:99]
    ds_read_b64_tr_b16 a[160:161], v200 offset:57344
    v_cvt_pk_bf16_f32 v160, v128, v129
    v_mfma_f32_16x16x32_bf16 v[68:71], a[164:167], v[168:171], v[68:71]
    ds_read_b64_tr_b16 a[162:163], v200 offset:61440
    v_fma_f32 v133, v133, s28, -v193
    v_mfma_f32_16x16x32_bf16 v[100:103], a[164:167], v[172:175], v[100:103]
    ds_read_b64_tr_b16 a[164:165], v201 offset:57344
    v_fma_f32 v134, v134, s28, -v193
    v_mfma_f32_16x16x32_bf16 v[184:187], v[220:223], v[168:171], v[184:187]
    ds_read_b64_tr_b16 a[166:167], v201 offset:61440
    v_cvt_pk_bf16_f32 v161, v130, v131
    v_mfma_f32_16x16x32_bf16 v[72:75], a[168:171], v[168:171], v[72:75]
    v_exp_f32 v132, v132
    v_mfma_f32_16x16x32_bf16 v[188:191], v[220:223], v[172:175], v[188:191]
    v_exp_f32 v133, v133
    v_mfma_f32_16x16x32_bf16 v[104:107], a[168:171], v[172:175], v[104:107]
    ds_read_b64_tr_b16 a[168:169], v202 offset:57344
    v_fma_f32 v135, v135, s28, -v193
    v_mfma_f32_16x16x32_bf16 v[76:79], a[172:175], v[168:171], v[76:79]
    ds_read_b64_tr_b16 a[170:171], v202 offset:61440
    v_fma_f32 v136, v136, s28, -v192
    v_mfma_f32_16x16x32_bf16 v[108:111], a[172:175], v[172:175], v[108:111]
    ds_read_b64_tr_b16 a[172:173], v203 offset:57344
    v_cvt_pk_bf16_f32 v164, v132, v133
    v_mfma_f32_16x16x32_bf16 v[80:83], a[176:179], v[168:171], v[80:83]
    ds_read_b64_tr_b16 a[174:175], v203 offset:61440
    v_fma_f32 v137, v137, s28, -v192
    v_mfma_f32_16x16x32_bf16 v[112:115], a[176:179], v[172:175], v[112:115]
    ds_read_b64_tr_b16 a[176:177], v204 offset:57344
    v_fma_f32 v138, v138, s28, -v192
    v_mfma_f32_16x16x32_bf16 v[84:87], a[180:183], v[168:171], v[84:87]
    ds_read_b64_tr_b16 a[178:179], v204 offset:61440
    v_fma_f32 v139, v139, s28, -v192
    v_mfma_f32_16x16x32_bf16 v[116:119], a[180:183], v[172:175], v[116:119]
    ds_read_b64_tr_b16 a[180:181], v205 offset:57344
    v_exp_f32 v134, v134
    v_mfma_f32_16x16x32_bf16 v[88:91], a[184:187], v[168:171], v[88:91]
    ds_read_b64_tr_b16 a[182:183], v205 offset:61440
    v_fma_f32 v140, v140, s28, -v193
    v_mfma_f32_16x16x32_bf16 v[120:123], a[184:187], v[172:175], v[120:123]
    ds_read_b64_tr_b16 a[184:185], v206 offset:57344
    v_exp_f32 v135, v135
    v_mfma_f32_16x16x32_bf16 v[92:95], a[188:191], v[168:171], v[92:95]
    ds_read_b64_tr_b16 a[186:187], v206 offset:61440
    v_cvt_pk_bf16_f32 v165, v134, v135
    v_mfma_f32_16x16x32_bf16 v[124:127], a[188:191], v[172:175], v[124:127]
    ds_read_b64_tr_b16 a[188:189], v207 offset:57344
    v_fma_f32 v141, v141, s28, -v193
    v_mfma_f32_16x16x32_bf16 v[144:147], a[128:131], a[32:35], 0
    ds_read_b64_tr_b16 a[190:191], v207 offset:61440
    v_exp_f32 v136, v136
    v_mfma_f32_16x16x32_bf16 v[144:147], a[132:135], a[36:39], v[144:147]
    s_add_u32 m0, s35, 0x1000
    v_exp_f32 v137, v137
    v_mfma_f32_16x16x32_bf16 v[144:147], a[136:139], a[40:43], v[144:147]
    buffer_load_dwordx4 v215, s[8:11], 0 offen nt lds
    buffer_load_dwordx4 v216, s[8:11], 0 offen offset:1024 nt lds
    v_mfma_f32_16x16x32_bf16 v[144:147], a[140:143], a[44:47], v[144:147]
    buffer_load_dwordx4 v217, s[8:11], 0 offen offset:2048 nt lds
    buffer_load_dwordx4 v218, s[8:11], 0 offen offset:3072 nt lds
    v_mfma_f32_16x16x32_bf16 v[148:151], a[128:131], a[48:51], 0
    ds_read_b128 a[128:131], v196 offset:0
    v_cvt_pk_bf16_f32 v162, v136, v137
    v_mfma_f32_16x16x32_bf16 v[148:151], a[132:135], a[52:55], v[148:151]
    ds_read_b128 a[132:135], v197 offset:0
    v_fma_f32 v142, v142, s28, -v193
    v_mfma_f32_16x16x32_bf16 v[148:151], a[136:139], a[56:59], v[148:151]
    ds_read_b128 a[136:139], v198 offset:0
    v_fma_f32 v143, v143, s28, -v193
    v_mfma_f32_16x16x32_bf16 v[148:151], a[140:143], a[60:63], v[148:151]
    ds_read_b128 a[140:143], v199 offset:0
    v_exp_f32 v138, v138
    v_mfma_f32_16x16x32_bf16 v[152:155], a[144:147], a[32:35], 0
    s_add_u32 s8, s8, 0x1000
    s_addc_u32 s9, s9, 0
    v_exp_f32 v139, v139
    v_mfma_f32_16x16x32_bf16 v[152:155], a[148:151], a[36:39], v[152:155]
    v_exp_f32 v140, v140
    v_mfma_f32_16x16x32_bf16 v[152:155], a[152:155], a[40:43], v[152:155]
    v_exp_f32 v141, v141
    v_mfma_f32_16x16x32_bf16 v[152:155], a[156:159], a[44:47], v[152:155]
    v_cvt_pk_bf16_f32 v163, v138, v139
    v_cvt_pk_bf16_f32 v166, v140, v141
    v_mfma_f32_16x16x32_bf16 v[156:159], a[144:147], a[48:51], 0
    ds_read_b128 a[144:147], v196 offset:4096
    v_fma_f32 v144, v144, s28, -v194
    v_mfma_f32_16x16x32_bf16 v[156:159], a[148:151], a[52:55], v[156:159]
    ds_read_b128 a[148:151], v197 offset:4096
    v_fma_f32 v145, v145, s28, -v194
    v_mfma_f32_16x16x32_bf16 v[156:159], a[152:155], a[56:59], v[156:159]
    ds_read_b128 a[152:155], v198 offset:4096
    v_fma_f32 v146, v146, s28, -v194
    v_mfma_f32_16x16x32_bf16 v[156:159], a[156:159], a[60:63], v[156:159]
    s_waitcnt lgkmcnt(7)
    ds_read_b128 a[156:159], v199 offset:4096
    v_fma_f32 v147, v147, s28, -v194
    v_mfma_f32_16x16x32_bf16 v[0:3], a[160:163], v[160:163], v[0:3]
    v_exp_f32 v142, v142
    v_exp_f32 v143, v143
    s_nop 0
    v_cvt_pk_bf16_f32 v167, v142, v143
    s_nop 1
    v_mfma_f32_16x16x32_bf16 v[32:35], a[160:163], v[164:167], v[32:35]
    s_add_u32 m0, s34, 0x1a000
    v_exp_f32 v144, v144
    v_mfma_f32_16x16x32_bf16 v[4:7], a[164:167], v[160:163], v[4:7]
    buffer_load_dwordx4 v210, s[16:19], 0 offen nt lds
    buffer_load_dwordx4 v211, s[16:19], 0 offen offset:1024 nt lds
    v_mfma_f32_16x16x32_bf16 v[36:39], a[164:167], v[164:167], v[36:39]
    s_add_u32 s16, s16, 0x2000
    v_exp_f32 v145, v145
    v_mfma_f32_16x16x32_bf16 v[176:179], v[220:223], v[160:163], v[176:179]
    s_addc_u32 s17, s17, 0
    v_exp_f32 v146, v146
    v_mfma_f32_16x16x32_bf16 v[8:11], a[168:171], v[160:163], v[8:11]
    v_fma_f32 v148, v148, s28, -v195
    v_cvt_pk_bf16_f32 v168, v144, v145
    v_mfma_f32_16x16x32_bf16 v[180:183], v[220:223], v[164:167], v[180:183]
    s_add_u32 m0, s34, 0xc000
    v_exp_f32 v147, v147
    v_mfma_f32_16x16x32_bf16 v[40:43], a[168:171], v[164:167], v[40:43]
    buffer_load_dwordx4 v208, s[12:15], 0 offen nt lds
    buffer_load_dwordx4 v209, s[12:15], 0 offen offset:1024 nt lds
    v_mfma_f32_16x16x32_bf16 v[12:15], a[172:175], v[160:163], v[12:15]
    s_add_u32 s12, s12, 0x2000
    v_fma_f32 v149, v149, s28, -v195
    v_fma_f32 v150, v150, s28, -v195
    v_mfma_f32_16x16x32_bf16 v[44:47], a[172:175], v[164:167], v[44:47]
    s_addc_u32 s13, s13, 0
    v_exp_f32 v148, v148
    v_mfma_f32_16x16x32_bf16 v[16:19], a[176:179], v[160:163], v[16:19]
    v_exp_f32 v149, v149
    v_mfma_f32_16x16x32_bf16 v[48:51], a[176:179], v[164:167], v[48:51]
    v_cvt_pk_bf16_f32 v169, v146, v147
    v_fma_f32 v151, v151, s28, -v195
    v_mfma_f32_16x16x32_bf16 v[20:23], a[180:183], v[160:163], v[20:23]
    v_exp_f32 v150, v150
    v_mfma_f32_16x16x32_bf16 v[52:55], a[180:183], v[164:167], v[52:55]
    v_fma_f32 v152, v152, s28, -v194
    v_cvt_pk_bf16_f32 v172, v148, v149
    v_mfma_f32_16x16x32_bf16 v[24:27], a[184:187], v[160:163], v[24:27]
    v_exp_f32 v151, v151
    v_mfma_f32_16x16x32_bf16 v[56:59], a[184:187], v[164:167], v[56:59]
    v_fma_f32 v153, v153, s28, -v194
    v_fma_f32 v154, v154, s28, -v194
    v_mfma_f32_16x16x32_bf16 v[28:31], a[188:191], v[160:163], v[28:31]
    v_exp_f32 v152, v152
    v_mfma_f32_16x16x32_bf16 v[60:63], a[188:191], v[164:167], v[60:63]
    s_waitcnt lgkmcnt(0)
    v_exp_f32 v153, v153
    v_mfma_f32_16x16x32_bf16 v[128:131], a[128:131], a[0:3], 0
    v_cvt_pk_bf16_f32 v173, v150, v151
    v_fma_f32 v155, v155, s28, -v194
    v_mfma_f32_16x16x32_bf16 v[128:131], a[132:135], a[4:7], v[128:131]
    s_add_u32 s38, s32, 0
    v_exp_f32 v154, v154
    v_mfma_f32_16x16x32_bf16 v[128:131], a[136:139], a[8:11], v[128:131]
    buffer_store_dwordx4 a[204:207], v214, s[20:23], s38 offen offset:3072 sc1
    v_fma_f32 v156, v156, s28, -v195
    v_exp_f32 v155, v155
    v_mfma_f32_16x16x32_bf16 v[128:131], a[140:143], a[12:15], v[128:131]
    v_cvt_pk_bf16_f32 v170, v152, v153
    v_fma_f32 v157, v157, s28, -v195
    v_mfma_f32_16x16x32_bf16 v[132:135], a[128:131], a[16:19], 0
    v_exp_f32 v156, v156
    v_mfma_f32_16x16x32_bf16 v[132:135], a[132:135], a[20:23], v[132:135]
    v_fma_f32 v158, v158, s28, -v195
    v_cvt_pk_bf16_f32 v171, v154, v155
    v_mfma_f32_16x16x32_bf16 v[132:135], a[136:139], a[24:27], v[132:135]
    v_exp_f32 v157, v157
    v_mfma_f32_16x16x32_bf16 v[132:135], a[140:143], a[28:31], v[132:135]
    v_fma_f32 v159, v159, s28, -v195
    v_cvt_pk_bf16_f32 v174, v156, v157
    v_mfma_f32_16x16x32_bf16 v[136:139], a[144:147], a[0:3], 0
    v_exp_f32 v158, v158
    v_mfma_f32_16x16x32_bf16 v[136:139], a[148:151], a[4:7], v[136:139]
    v_exp_f32 v159, v159
    v_mfma_f32_16x16x32_bf16 v[136:139], a[152:155], a[8:11], v[136:139]
    v_cvt_pk_bf16_f32 v175, v158, v159
    v_fma_f32 v128, v128, s28, -v192
    v_mfma_f32_16x16x32_bf16 v[136:139], a[156:159], a[12:15], v[136:139]
    v_fma_f32 v129, v129, s28, -v192
    v_fma_f32 v130, v130, s28, -v192
    v_mfma_f32_16x16x32_bf16 v[140:143], a[144:147], a[16:19], 0
    v_exp_f32 v128, v128
    v_mfma_f32_16x16x32_bf16 v[140:143], a[148:151], a[20:23], v[140:143]
    v_exp_f32 v129, v129
    v_mfma_f32_16x16x32_bf16 v[140:143], a[152:155], a[24:27], v[140:143]
    s_waitcnt vmcnt(27)
    s_barrier
    v_fma_f32 v131, v131, s28, -v192
    v_mfma_f32_16x16x32_bf16 v[140:143], a[156:159], a[28:31], v[140:143]
    v_exp_f32 v130, v130
    v_mfma_f32_16x16x32_bf16 v[64:67], a[160:163], v[168:171], v[64:67]
    v_fma_f32 v132, v132, s28, -v193
    v_cvt_pk_bf16_f32 v160, v128, v129
    v_mfma_f32_16x16x32_bf16 v[96:99], a[160:163], v[172:175], v[96:99]
    ds_read_b64_tr_b16 a[160:161], v200 offset:0
    v_fma_f32 v133, v133, s28, -v193
    v_mfma_f32_16x16x32_bf16 v[68:71], a[164:167], v[168:171], v[68:71]
    ds_read_b64_tr_b16 a[162:163], v200 offset:4096
    v_fma_f32 v134, v134, s28, -v193
    v_mfma_f32_16x16x32_bf16 v[100:103], a[164:167], v[172:175], v[100:103]
    ds_read_b64_tr_b16 a[164:165], v201 offset:0
    v_fma_f32 v135, v135, s28, -v193
    v_mfma_f32_16x16x32_bf16 v[184:187], v[220:223], v[168:171], v[184:187]
    ds_read_b64_tr_b16 a[166:167], v201 offset:4096
    v_fma_f32 v136, v136, s28, -v192
    v_mfma_f32_16x16x32_bf16 v[72:75], a[168:171], v[168:171], v[72:75]
    v_exp_f32 v131, v131
    v_mfma_f32_16x16x32_bf16 v[188:191], v[220:223], v[172:175], v[188:191]
    v_exp_f32 v132, v132
    v_mfma_f32_16x16x32_bf16 v[104:107], a[168:171], v[172:175], v[104:107]
    ds_read_b64_tr_b16 a[168:169], v202 offset:0
    v_cvt_pk_bf16_f32 v161, v130, v131
    v_mfma_f32_16x16x32_bf16 v[76:79], a[172:175], v[168:171], v[76:79]
    ds_read_b64_tr_b16 a[170:171], v202 offset:4096
    v_fma_f32 v137, v137, s28, -v192
    v_mfma_f32_16x16x32_bf16 v[108:111], a[172:175], v[172:175], v[108:111]
    ds_read_b64_tr_b16 a[172:173], v203 offset:0
    v_fma_f32 v138, v138, s28, -v192
    v_mfma_f32_16x16x32_bf16 v[80:83], a[176:179], v[168:171], v[80:83]
    ds_read_b64_tr_b16 a[174:175], v203 offset:4096
    v_exp_f32 v133, v133
    v_mfma_f32_16x16x32_bf16 v[112:115], a[176:179], v[172:175], v[112:115]
    ds_read_b64_tr_b16 a[176:177], v204 offset:0
    v_cvt_pk_bf16_f32 v164, v132, v133
    v_mfma_f32_16x16x32_bf16 v[84:87], a[180:183], v[168:171], v[84:87]
    ds_read_b64_tr_b16 a[178:179], v204 offset:4096
    v_fma_f32 v139, v139, s28, -v192
    v_mfma_f32_16x16x32_bf16 v[116:119], a[180:183], v[172:175], v[116:119]
    ds_read_b64_tr_b16 a[180:181], v205 offset:0
    v_exp_f32 v134, v134
    v_mfma_f32_16x16x32_bf16 v[88:91], a[184:187], v[168:171], v[88:91]
    ds_read_b64_tr_b16 a[182:183], v205 offset:4096
    v_fma_f32 v140, v140, s28, -v193
    v_mfma_f32_16x16x32_bf16 v[120:123], a[184:187], v[172:175], v[120:123]
    ds_read_b64_tr_b16 a[184:185], v206 offset:0
    v_exp_f32 v135, v135
    v_mfma_f32_16x16x32_bf16 v[92:95], a[188:191], v[168:171], v[92:95]
    ds_read_b64_tr_b16 a[186:187], v206 offset:4096
    v_cvt_pk_bf16_f32 v165, v134, v135
    v_mfma_f32_16x16x32_bf16 v[124:127], a[188:191], v[172:175], v[124:127]
    ds_read_b64_tr_b16 a[188:189], v207 offset:0
    v_fma_f32 v141, v141, s28, -v193
    v_mfma_f32_16x16x32_bf16 v[144:147], a[128:131], a[32:35], 0
    ds_read_b64_tr_b16 a[190:191], v207 offset:4096
    v_exp_f32 v136, v136
    v_mfma_f32_16x16x32_bf16 v[144:147], a[132:135], a[36:39], v[144:147]
    v_exp_f32 v137, v137
    v_mfma_f32_16x16x32_bf16 v[144:147], a[136:139], a[40:43], v[144:147]
    v_exp_f32 v138, v138
    v_mfma_f32_16x16x32_bf16 v[144:147], a[140:143], a[44:47], v[144:147]
    v_exp_f32 v139, v139
    v_mfma_f32_16x16x32_bf16 v[148:151], a[128:131], a[48:51], 0
    ds_read_b128 a[128:131], v196 offset:8192
    v_cvt_pk_bf16_f32 v162, v136, v137
    v_mfma_f32_16x16x32_bf16 v[148:151], a[132:135], a[52:55], v[148:151]
    ds_read_b128 a[132:135], v197 offset:8192
    v_fma_f32 v142, v142, s28, -v193
    v_mfma_f32_16x16x32_bf16 v[148:151], a[136:139], a[56:59], v[148:151]
    ds_read_b128 a[136:139], v198 offset:8192
    v_cvt_pk_bf16_f32 v163, v138, v139
    v_mfma_f32_16x16x32_bf16 v[148:151], a[140:143], a[60:63], v[148:151]
    ds_read_b128 a[140:143], v199 offset:8192
    v_fma_f32 v143, v143, s28, -v193
    v_mfma_f32_16x16x32_bf16 v[152:155], a[144:147], a[32:35], 0
    v_exp_f32 v140, v140
    v_mfma_f32_16x16x32_bf16 v[152:155], a[148:151], a[36:39], v[152:155]
    v_exp_f32 v141, v141
    v_mfma_f32_16x16x32_bf16 v[152:155], a[152:155], a[40:43], v[152:155]
    v_exp_f32 v142, v142
    v_mfma_f32_16x16x32_bf16 v[152:155], a[156:159], a[44:47], v[152:155]
    v_exp_f32 v143, v143
    v_mfma_f32_16x16x32_bf16 v[156:159], a[144:147], a[48:51], 0
    ds_read_b128 a[144:147], v196 offset:12288
    v_cvt_pk_bf16_f32 v166, v140, v141
    v_mfma_f32_16x16x32_bf16 v[156:159], a[148:151], a[52:55], v[156:159]
    ds_read_b128 a[148:151], v197 offset:12288
    v_cvt_pk_bf16_f32 v167, v142, v143
    v_mfma_f32_16x16x32_bf16 v[156:159], a[152:155], a[56:59], v[156:159]
    ds_read_b128 a[152:155], v198 offset:12288
    v_fma_f32 v144, v144, s28, -v194
    v_mfma_f32_16x16x32_bf16 v[156:159], a[156:159], a[60:63], v[156:159]
    s_waitcnt lgkmcnt(7)
    ds_read_b128 a[156:159], v199 offset:12288
    v_fma_f32 v145, v145, s28, -v194
    v_mfma_f32_16x16x32_bf16 v[0:3], a[160:163], v[160:163], v[0:3]
    v_exp_f32 v144, v144
    v_mfma_f32_16x16x32_bf16 v[32:35], a[160:163], v[164:167], v[32:35]
    s_add_u32 m0, s34, 0x1c000
    v_fma_f32 v146, v146, s28, -v194
    v_fma_f32 v147, v147, s28, -v194
    v_mfma_f32_16x16x32_bf16 v[4:7], a[164:167], v[160:163], v[4:7]
    buffer_load_dwordx4 v210, s[16:19], 0 offen nt lds
    buffer_load_dwordx4 v211, s[16:19], 0 offen offset:1024 nt lds
    v_mfma_f32_16x16x32_bf16 v[36:39], a[164:167], v[164:167], v[36:39]
    s_add_u32 s16, s16, 0x2000
    v_exp_f32 v145, v145
    v_mfma_f32_16x16x32_bf16 v[176:179], v[220:223], v[160:163], v[176:179]
    s_addc_u32 s17, s17, 0
    v_exp_f32 v146, v146
    v_mfma_f32_16x16x32_bf16 v[8:11], a[168:171], v[160:163], v[8:11]
    v_fma_f32 v148, v148, s28, -v195
    v_cvt_pk_bf16_f32 v168, v144, v145
    v_mfma_f32_16x16x32_bf16 v[180:183], v[220:223], v[164:167], v[180:183]
    s_add_u32 m0, s34, 0xe000
    v_exp_f32 v147, v147
    v_mfma_f32_16x16x32_bf16 v[40:43], a[168:171], v[164:167], v[40:43]
    buffer_load_dwordx4 v208, s[12:15], 0 offen nt lds
    buffer_load_dwordx4 v209, s[12:15], 0 offen offset:1024 nt lds
    v_mfma_f32_16x16x32_bf16 v[12:15], a[172:175], v[160:163], v[12:15]
    s_add_u32 s12, s12, 0xfe2000
    v_fma_f32 v149, v149, s28, -v195
    v_fma_f32 v150, v150, s28, -v195
    v_mfma_f32_16x16x32_bf16 v[44:47], a[172:175], v[164:167], v[44:47]
    s_addc_u32 s13, s13, 0
    v_exp_f32 v148, v148
    v_mfma_f32_16x16x32_bf16 v[16:19], a[176:179], v[160:163], v[16:19]
    v_exp_f32 v149, v149
    v_mfma_f32_16x16x32_bf16 v[48:51], a[176:179], v[164:167], v[48:51]
    v_cvt_pk_bf16_f32 v169, v146, v147
    v_fma_f32 v151, v151, s28, -v195
    v_mfma_f32_16x16x32_bf16 v[20:23], a[180:183], v[160:163], v[20:23]
    v_exp_f32 v150, v150
    v_mfma_f32_16x16x32_bf16 v[52:55], a[180:183], v[164:167], v[52:55]
    v_fma_f32 v152, v152, s28, -v194
    v_cvt_pk_bf16_f32 v172, v148, v149
    v_mfma_f32_16x16x32_bf16 v[24:27], a[184:187], v[160:163], v[24:27]
    v_exp_f32 v151, v151
    v_mfma_f32_16x16x32_bf16 v[56:59], a[184:187], v[164:167], v[56:59]
    v_fma_f32 v153, v153, s28, -v194
    v_fma_f32 v154, v154, s28, -v194
    v_mfma_f32_16x16x32_bf16 v[28:31], a[188:191], v[160:163], v[28:31]
    v_exp_f32 v152, v152
    v_mfma_f32_16x16x32_bf16 v[60:63], a[188:191], v[164:167], v[60:63]
    s_waitcnt lgkmcnt(0)
    v_exp_f32 v153, v153
    v_mfma_f32_16x16x32_bf16 v[128:131], a[128:131], a[0:3], 0
    v_cvt_pk_bf16_f32 v173, v150, v151
    v_fma_f32 v155, v155, s28, -v194
    v_mfma_f32_16x16x32_bf16 v[128:131], a[132:135], a[4:7], v[128:131]
    v_exp_f32 v154, v154
    v_mfma_f32_16x16x32_bf16 v[128:131], a[136:139], a[8:11], v[128:131]
    v_fma_f32 v156, v156, s28, -v195
    v_cvt_pk_bf16_f32 v170, v152, v153
    v_mfma_f32_16x16x32_bf16 v[128:131], a[140:143], a[12:15], v[128:131]
    v_exp_f32 v155, v155
    v_mfma_f32_16x16x32_bf16 v[132:135], a[128:131], a[16:19], 0
    v_fma_f32 v157, v157, s28, -v195
    v_fma_f32 v158, v158, s28, -v195
    v_mfma_f32_16x16x32_bf16 v[132:135], a[132:135], a[20:23], v[132:135]
    v_exp_f32 v156, v156
    v_mfma_f32_16x16x32_bf16 v[132:135], a[136:139], a[24:27], v[132:135]
    v_exp_f32 v157, v157
    v_mfma_f32_16x16x32_bf16 v[132:135], a[140:143], a[28:31], v[132:135]
    v_cvt_pk_bf16_f32 v171, v154, v155
    v_fma_f32 v159, v159, s28, -v195
    v_mfma_f32_16x16x32_bf16 v[136:139], a[144:147], a[0:3], 0
    v_exp_f32 v158, v158
    v_mfma_f32_16x16x32_bf16 v[136:139], a[148:151], a[4:7], v[136:139]
    v_exp_f32 v159, v159
    v_mfma_f32_16x16x32_bf16 v[136:139], a[152:155], a[8:11], v[136:139]
    v_cvt_pk_bf16_f32 v174, v156, v157
    v_cvt_pk_bf16_f32 v175, v158, v159
    v_mfma_f32_16x16x32_bf16 v[136:139], a[156:159], a[12:15], v[136:139]
    v_fma_f32 v128, v128, s28, -v192
    v_fma_f32 v129, v129, s28, -v192
    v_mfma_f32_16x16x32_bf16 v[140:143], a[144:147], a[16:19], 0
    v_exp_f32 v128, v128
    v_mfma_f32_16x16x32_bf16 v[140:143], a[148:151], a[20:23], v[140:143]
    v_fma_f32 v130, v130, s28, -v192
    v_fma_f32 v131, v131, s28, -v192
    v_mfma_f32_16x16x32_bf16 v[140:143], a[152:155], a[24:27], v[140:143]
    v_exp_f32 v129, v129
    v_mfma_f32_16x16x32_bf16 v[140:143], a[156:159], a[28:31], v[140:143]
    v_exp_f32 v130, v130
    v_mfma_f32_16x16x32_bf16 v[64:67], a[160:163], v[168:171], v[64:67]
    v_fma_f32 v132, v132, s28, -v193
    v_cvt_pk_bf16_f32 v160, v128, v129
    v_mfma_f32_16x16x32_bf16 v[96:99], a[160:163], v[172:175], v[96:99]
    ds_read_b64_tr_b16 a[160:161], v200 offset:8192
    v_fma_f32 v133, v133, s28, -v193
    v_mfma_f32_16x16x32_bf16 v[68:71], a[164:167], v[168:171], v[68:71]
    ds_read_b64_tr_b16 a[162:163], v200 offset:12288
    v_fma_f32 v134, v134, s28, -v193
    v_mfma_f32_16x16x32_bf16 v[100:103], a[164:167], v[172:175], v[100:103]
    ds_read_b64_tr_b16 a[164:165], v201 offset:8192
    v_fma_f32 v135, v135, s28, -v193
    v_mfma_f32_16x16x32_bf16 v[184:187], v[220:223], v[168:171], v[184:187]
    ds_read_b64_tr_b16 a[166:167], v201 offset:12288
    v_fma_f32 v136, v136, s28, -v192
    v_mfma_f32_16x16x32_bf16 v[72:75], a[168:171], v[168:171], v[72:75]
    v_exp_f32 v131, v131
    v_mfma_f32_16x16x32_bf16 v[188:191], v[220:223], v[172:175], v[188:191]
    v_exp_f32 v132, v132
    v_mfma_f32_16x16x32_bf16 v[104:107], a[168:171], v[172:175], v[104:107]
    ds_read_b64_tr_b16 a[168:169], v202 offset:8192
    v_cvt_pk_bf16_f32 v161, v130, v131
    v_mfma_f32_16x16x32_bf16 v[76:79], a[172:175], v[168:171], v[76:79]
    ds_read_b64_tr_b16 a[170:171], v202 offset:12288
    v_fma_f32 v137, v137, s28, -v192
    v_mfma_f32_16x16x32_bf16 v[108:111], a[172:175], v[172:175], v[108:111]
    ds_read_b64_tr_b16 a[172:173], v203 offset:8192
    v_fma_f32 v138, v138, s28, -v192
    v_mfma_f32_16x16x32_bf16 v[80:83], a[176:179], v[168:171], v[80:83]
    ds_read_b64_tr_b16 a[174:175], v203 offset:12288
    v_exp_f32 v133, v133
    v_mfma_f32_16x16x32_bf16 v[112:115], a[176:179], v[172:175], v[112:115]
    ds_read_b64_tr_b16 a[176:177], v204 offset:8192
    v_cvt_pk_bf16_f32 v164, v132, v133
    v_mfma_f32_16x16x32_bf16 v[84:87], a[180:183], v[168:171], v[84:87]
    ds_read_b64_tr_b16 a[178:179], v204 offset:12288
    v_fma_f32 v139, v139, s28, -v192
    v_mfma_f32_16x16x32_bf16 v[116:119], a[180:183], v[172:175], v[116:119]
    ds_read_b64_tr_b16 a[180:181], v205 offset:8192
    v_exp_f32 v134, v134
    v_mfma_f32_16x16x32_bf16 v[88:91], a[184:187], v[168:171], v[88:91]
    ds_read_b64_tr_b16 a[182:183], v205 offset:12288
    v_fma_f32 v140, v140, s28, -v193
    v_mfma_f32_16x16x32_bf16 v[120:123], a[184:187], v[172:175], v[120:123]
    ds_read_b64_tr_b16 a[184:185], v206 offset:8192
    v_exp_f32 v135, v135
    v_mfma_f32_16x16x32_bf16 v[92:95], a[188:191], v[168:171], v[92:95]
    ds_read_b64_tr_b16 a[186:187], v206 offset:12288
    v_cvt_pk_bf16_f32 v165, v134, v135
    v_mfma_f32_16x16x32_bf16 v[124:127], a[188:191], v[172:175], v[124:127]
    ds_read_b64_tr_b16 a[188:189], v207 offset:8192
    v_fma_f32 v141, v141, s28, -v193
    v_mfma_f32_16x16x32_bf16 v[144:147], a[128:131], a[32:35], 0
    ds_read_b64_tr_b16 a[190:191], v207 offset:12288
    v_exp_f32 v136, v136
    v_mfma_f32_16x16x32_bf16 v[144:147], a[132:135], a[36:39], v[144:147]
    v_exp_f32 v137, v137
    v_mfma_f32_16x16x32_bf16 v[144:147], a[136:139], a[40:43], v[144:147]
    v_exp_f32 v138, v138
    v_mfma_f32_16x16x32_bf16 v[144:147], a[140:143], a[44:47], v[144:147]
    v_exp_f32 v139, v139
    v_mfma_f32_16x16x32_bf16 v[148:151], a[128:131], a[48:51], 0
    ds_read_b128 a[128:131], v196 offset:16384
    v_cvt_pk_bf16_f32 v162, v136, v137
    v_mfma_f32_16x16x32_bf16 v[148:151], a[132:135], a[52:55], v[148:151]
    ds_read_b128 a[132:135], v197 offset:16384
    v_fma_f32 v142, v142, s28, -v193
    v_mfma_f32_16x16x32_bf16 v[148:151], a[136:139], a[56:59], v[148:151]
    ds_read_b128 a[136:139], v198 offset:16384
    v_cvt_pk_bf16_f32 v163, v138, v139
    v_mfma_f32_16x16x32_bf16 v[148:151], a[140:143], a[60:63], v[148:151]
    ds_read_b128 a[140:143], v199 offset:16384
    v_fma_f32 v143, v143, s28, -v193
    v_mfma_f32_16x16x32_bf16 v[152:155], a[144:147], a[32:35], 0
    v_exp_f32 v140, v140
    v_mfma_f32_16x16x32_bf16 v[152:155], a[148:151], a[36:39], v[152:155]
    v_exp_f32 v141, v141
    v_mfma_f32_16x16x32_bf16 v[152:155], a[152:155], a[40:43], v[152:155]
    v_exp_f32 v142, v142
    v_mfma_f32_16x16x32_bf16 v[152:155], a[156:159], a[44:47], v[152:155]
    v_exp_f32 v143, v143
    v_mfma_f32_16x16x32_bf16 v[156:159], a[144:147], a[48:51], 0
    ds_read_b128 a[144:147], v196 offset:20480
    v_cvt_pk_bf16_f32 v166, v140, v141
    v_mfma_f32_16x16x32_bf16 v[156:159], a[148:151], a[52:55], v[156:159]
    ds_read_b128 a[148:151], v197 offset:20480
    v_cvt_pk_bf16_f32 v167, v142, v143
    v_mfma_f32_16x16x32_bf16 v[156:159], a[152:155], a[56:59], v[156:159]
    ds_read_b128 a[152:155], v198 offset:20480
    v_fma_f32 v144, v144, s28, -v194
    v_mfma_f32_16x16x32_bf16 v[156:159], a[156:159], a[60:63], v[156:159]
    s_waitcnt lgkmcnt(7)
    ds_read_b128 a[156:159], v199 offset:20480
    v_fma_f32 v145, v145, s28, -v194
    v_mfma_f32_16x16x32_bf16 v[0:3], a[160:163], v[160:163], v[0:3]
    v_exp_f32 v144, v144
    v_mfma_f32_16x16x32_bf16 v[32:35], a[160:163], v[164:167], v[32:35]
    s_add_u32 m0, s34, 0x1e000
    v_fma_f32 v146, v146, s28, -v194
    v_fma_f32 v147, v147, s28, -v194
    v_mfma_f32_16x16x32_bf16 v[4:7], a[164:167], v[160:163], v[4:7]
    buffer_load_dwordx4 v210, s[16:19], 0 offen nt lds
    buffer_load_dwordx4 v211, s[16:19], 0 offen offset:1024 nt lds
    v_mfma_f32_16x16x32_bf16 v[36:39], a[164:167], v[164:167], v[36:39]
    s_add_u32 s16, s16, 0xfe2000
    v_exp_f32 v145, v145
    v_mfma_f32_16x16x32_bf16 v[176:179], v[220:223], v[160:163], v[176:179]
    s_addc_u32 s17, s17, 0
    v_exp_f32 v146, v146
    v_mfma_f32_16x16x32_bf16 v[8:11], a[168:171], v[160:163], v[8:11]
    v_fma_f32 v148, v148, s28, -v195
    v_cvt_pk_bf16_f32 v168, v144, v145
    v_mfma_f32_16x16x32_bf16 v[180:183], v[220:223], v[164:167], v[180:183]
    s_add_u32 m0, s34, 0
    v_exp_f32 v147, v147
    v_mfma_f32_16x16x32_bf16 v[40:43], a[168:171], v[164:167], v[40:43]
    buffer_load_dwordx4 v208, s[12:15], 0 offen nt lds
    buffer_load_dwordx4 v209, s[12:15], 0 offen offset:1024 nt lds
    v_mfma_f32_16x16x32_bf16 v[12:15], a[172:175], v[160:163], v[12:15]
    s_add_u32 s12, s12, 0x2000
    v_fma_f32 v149, v149, s28, -v195
    v_fma_f32 v150, v150, s28, -v195
    v_mfma_f32_16x16x32_bf16 v[44:47], a[172:175], v[164:167], v[44:47]
    s_addc_u32 s13, s13, 0
    v_exp_f32 v148, v148
    v_mfma_f32_16x16x32_bf16 v[16:19], a[176:179], v[160:163], v[16:19]
    v_exp_f32 v149, v149
    v_mfma_f32_16x16x32_bf16 v[48:51], a[176:179], v[164:167], v[48:51]
    v_cvt_pk_bf16_f32 v169, v146, v147
    v_fma_f32 v151, v151, s28, -v195
    v_mfma_f32_16x16x32_bf16 v[20:23], a[180:183], v[160:163], v[20:23]
    v_exp_f32 v150, v150
    v_mfma_f32_16x16x32_bf16 v[52:55], a[180:183], v[164:167], v[52:55]
    v_fma_f32 v152, v152, s28, -v194
    v_cvt_pk_bf16_f32 v172, v148, v149
    v_mfma_f32_16x16x32_bf16 v[24:27], a[184:187], v[160:163], v[24:27]
    v_exp_f32 v151, v151
    v_mfma_f32_16x16x32_bf16 v[56:59], a[184:187], v[164:167], v[56:59]
    v_fma_f32 v153, v153, s28, -v194
    v_fma_f32 v154, v154, s28, -v194
    v_mfma_f32_16x16x32_bf16 v[28:31], a[188:191], v[160:163], v[28:31]
    v_exp_f32 v152, v152
    v_mfma_f32_16x16x32_bf16 v[60:63], a[188:191], v[164:167], v[60:63]
    s_waitcnt lgkmcnt(0)
    v_exp_f32 v153, v153
    v_mfma_f32_16x16x32_bf16 v[128:131], a[128:131], a[0:3], 0
    v_cvt_pk_bf16_f32 v173, v150, v151
    v_fma_f32 v155, v155, s28, -v194
    v_mfma_f32_16x16x32_bf16 v[128:131], a[132:135], a[4:7], v[128:131]
    s_add_u32 s38, s32, 0x1000
    v_exp_f32 v154, v154
    v_mfma_f32_16x16x32_bf16 v[128:131], a[136:139], a[8:11], v[128:131]
    buffer_store_dwordx4 a[208:211], v214, s[20:23], s38 offen sc1
    v_fma_f32 v156, v156, s28, -v195
    v_exp_f32 v155, v155
    v_mfma_f32_16x16x32_bf16 v[128:131], a[140:143], a[12:15], v[128:131]
    v_cvt_pk_bf16_f32 v170, v152, v153
    v_fma_f32 v157, v157, s28, -v195
    v_mfma_f32_16x16x32_bf16 v[132:135], a[128:131], a[16:19], 0
    s_waitcnt vmcnt(14)
    v_exp_f32 v156, v156
    v_mfma_f32_16x16x32_bf16 v[132:135], a[132:135], a[20:23], v[132:135]
    ds_read_b128 a[64:67], v244 offset:0
    v_fma_f32 v158, v158, s28, -v195
    v_mfma_f32_16x16x32_bf16 v[132:135], a[136:139], a[24:27], v[132:135]
    ds_read_b128 a[68:71], v245 offset:0
    v_cvt_pk_bf16_f32 v171, v154, v155
    v_mfma_f32_16x16x32_bf16 v[132:135], a[140:143], a[28:31], v[132:135]
    ds_read_b128 a[72:75], v246 offset:0
    v_fma_f32 v159, v159, s28, -v195
    v_mfma_f32_16x16x32_bf16 v[136:139], a[144:147], a[0:3], 0
    ds_read_b128 a[76:79], v247 offset:0
    v_fma_f32 v128, v128, s28, -v192
    v_mfma_f32_16x16x32_bf16 v[136:139], a[148:151], a[4:7], v[136:139]
    ds_read_b128 a[80:83], v244 offset:4096
    v_fma_f32 v129, v129, s28, -v192
    v_mfma_f32_16x16x32_bf16 v[136:139], a[152:155], a[8:11], v[136:139]
    ds_read_b128 a[84:87], v245 offset:4096
    v_exp_f32 v157, v157
    v_mfma_f32_16x16x32_bf16 v[136:139], a[156:159], a[12:15], v[136:139]
    ds_read_b128 a[88:91], v246 offset:4096
    v_cvt_pk_bf16_f32 v174, v156, v157
    v_mfma_f32_16x16x32_bf16 v[140:143], a[144:147], a[16:19], 0
    ds_read_b128 a[92:95], v247 offset:4096
    v_fma_f32 v130, v130, s28, -v192
    v_mfma_f32_16x16x32_bf16 v[140:143], a[148:151], a[20:23], v[140:143]
    v_exp_f32 v158, v158
    v_mfma_f32_16x16x32_bf16 v[140:143], a[152:155], a[24:27], v[140:143]
    s_waitcnt vmcnt(23)
    s_barrier
    v_exp_f32 v159, v159
    v_mfma_f32_16x16x32_bf16 v[140:143], a[156:159], a[28:31], v[140:143]
    v_cvt_pk_bf16_f32 v175, v158, v159
    v_fma_f32 v131, v131, s28, -v192
    v_mfma_f32_16x16x32_bf16 v[64:67], a[160:163], v[168:171], v[64:67]
    v_exp_f32 v128, v128
    v_mfma_f32_16x16x32_bf16 v[96:99], a[160:163], v[172:175], v[96:99]
    ds_read_b64_tr_b16 a[160:161], v200 offset:16384
    v_fma_f32 v132, v132, s28, -v193
    v_mfma_f32_16x16x32_bf16 v[68:71], a[164:167], v[168:171], v[68:71]
    ds_read_b64_tr_b16 a[162:163], v200 offset:20480
    v_fma_f32 v133, v133, s28, -v193
    v_mfma_f32_16x16x32_bf16 v[100:103], a[164:167], v[172:175], v[100:103]
    ds_read_b64_tr_b16 a[164:165], v201 offset:16384
    v_fma_f32 v134, v134, s28, -v193
    v_mfma_f32_16x16x32_bf16 v[184:187], v[220:223], v[168:171], v[184:187]
    ds_read_b64_tr_b16 a[166:167], v201 offset:20480
    v_exp_f32 v129, v129
    v_mfma_f32_16x16x32_bf16 v[72:75], a[168:171], v[168:171], v[72:75]
    v_exp_f32 v130, v130
    v_mfma_f32_16x16x32_bf16 v[188:191], v[220:223], v[172:175], v[188:191]
    v_exp_f32 v131, v131
    v_mfma_f32_16x16x32_bf16 v[104:107], a[168:171], v[172:175], v[104:107]
    ds_read_b64_tr_b16 a[168:169], v202 offset:16384
    v_cvt_pk_bf16_f32 v160, v128, v129
    v_mfma_f32_16x16x32_bf16 v[76:79], a[172:175], v[168:171], v[76:79]
    ds_read_b64_tr_b16 a[170:171], v202 offset:20480
    v_cvt_pk_bf16_f32 v161, v130, v131
    v_mfma_f32_16x16x32_bf16 v[108:111], a[172:175], v[172:175], v[108:111]
    ds_read_b64_tr_b16 a[172:173], v203 offset:16384
    v_fma_f32 v135, v135, s28, -v193
    v_mfma_f32_16x16x32_bf16 v[80:83], a[176:179], v[168:171], v[80:83]
    ds_read_b64_tr_b16 a[174:175], v203 offset:20480
    v_fma_f32 v136, v136, s28, -v192
    v_mfma_f32_16x16x32_bf16 v[112:115], a[176:179], v[172:175], v[112:115]
    ds_read_b64_tr_b16 a[176:177], v204 offset:16384
    v_fma_f32 v137, v137, s28, -v192
    v_mfma_f32_16x16x32_bf16 v[84:87], a[180:183], v[168:171], v[84:87]
    ds_read_b64_tr_b16 a[178:179], v204 offset:20480
    v_exp_f32 v132, v132
    v_mfma_f32_16x16x32_bf16 v[116:119], a[180:183], v[172:175], v[116:119]
    ds_read_b64_tr_b16 a[180:181], v205 offset:16384
    v_fma_f32 v138, v138, s28, -v192
    v_mfma_f32_16x16x32_bf16 v[88:91], a[184:187], v[168:171], v[88:91]
    ds_read_b64_tr_b16 a[182:183], v205 offset:20480
    v_exp_f32 v133, v133
    v_mfma_f32_16x16x32_bf16 v[120:123], a[184:187], v[172:175], v[120:123]
    ds_read_b64_tr_b16 a[184:185], v206 offset:16384
    v_cvt_pk_bf16_f32 v164, v132, v133
    v_mfma_f32_16x16x32_bf16 v[92:95], a[188:191], v[168:171], v[92:95]
    ds_read_b64_tr_b16 a[186:187], v206 offset:20480
    v_fma_f32 v139, v139, s28, -v192
    v_mfma_f32_16x16x32_bf16 v[124:127], a[188:191], v[172:175], v[124:127]
    ds_read_b64_tr_b16 a[188:189], v207 offset:16384
    v_exp_f32 v134, v134
    v_mfma_f32_16x16x32_bf16 v[144:147], a[128:131], a[32:35], 0
    ds_read_b64_tr_b16 a[190:191], v207 offset:20480
    v_fma_f32 v140, v140, s28, -v193
    v_mfma_f32_16x16x32_bf16 v[144:147], a[132:135], a[36:39], v[144:147]
    s_waitcnt lgkmcnt(15)
    v_exp_f32 v135, v135
    v_mfma_f32_16x16x32_bf16 v[144:147], a[136:139], a[40:43], v[144:147]
    s_add_u32 m0, s35, 0
    v_exp_f32 v136, v136
    v_mfma_f32_16x16x32_bf16 v[144:147], a[140:143], a[44:47], v[144:147]
    buffer_load_dwordx4 v215, s[8:11], 0 offen nt lds
    buffer_load_dwordx4 v216, s[8:11], 0 offen offset:1024 nt lds
    v_mfma_f32_16x16x32_bf16 v[148:151], a[128:131], a[48:51], 0
    ds_read_b128 a[128:131], v196 offset:24576
    v_cvt_pk_bf16_f32 v165, v134, v135
    v_mfma_f32_16x16x32_bf16 v[148:151], a[132:135], a[52:55], v[148:151]
    ds_read_b128 a[132:135], v197 offset:24576
    v_fma_f32 v141, v141, s28, -v193
    v_mfma_f32_16x16x32_bf16 v[148:151], a[136:139], a[56:59], v[148:151]
    ds_read_b128 a[136:139], v198 offset:24576
    v_fma_f32 v142, v142, s28, -v193
    v_mfma_f32_16x16x32_bf16 v[148:151], a[140:143], a[60:63], v[148:151]
    ds_read_b128 a[140:143], v199 offset:24576
    v_exp_f32 v137, v137
    v_mfma_f32_16x16x32_bf16 v[152:155], a[144:147], a[32:35], 0
    buffer_load_dwordx4 v217, s[8:11], 0 offen offset:2048 nt lds
    buffer_load_dwordx4 v218, s[8:11], 0 offen offset:3072 nt lds
    v_mfma_f32_16x16x32_bf16 v[152:155], a[148:151], a[36:39], v[152:155]
    s_add_u32 s8, s8, 0x1000
    s_addc_u32 s9, s9, 0
    v_cvt_pk_bf16_f32 v162, v136, v137
    v_mfma_f32_16x16x32_bf16 v[152:155], a[152:155], a[40:43], v[152:155]
    v_exp_f32 v138, v138
    v_mfma_f32_16x16x32_bf16 v[152:155], a[156:159], a[44:47], v[152:155]
    v_exp_f32 v139, v139
    v_mfma_f32_16x16x32_bf16 v[156:159], a[144:147], a[48:51], 0
    ds_read_b128 a[144:147], v196 offset:28672
    v_cvt_pk_bf16_f32 v163, v138, v139
    v_mfma_f32_16x16x32_bf16 v[156:159], a[148:151], a[52:55], v[156:159]
    ds_read_b128 a[148:151], v197 offset:28672
    v_fma_f32 v143, v143, s28, -v193
    v_mfma_f32_16x16x32_bf16 v[156:159], a[152:155], a[56:59], v[156:159]
    ds_read_b128 a[152:155], v198 offset:28672
    v_exp_f32 v140, v140
    v_mfma_f32_16x16x32_bf16 v[156:159], a[156:159], a[60:63], v[156:159]
    s_waitcnt lgkmcnt(7)
    ds_read_b128 a[156:159], v199 offset:28672
    v_fma_f32 v144, v144, s28, -v194
    v_mfma_f32_16x16x32_bf16 v[0:3], a[160:163], v[160:163], v[0:3]
    v_exp_f32 v141, v141
    v_exp_f32 v142, v142
    v_exp_f32 v143, v143
    v_cvt_pk_bf16_f32 v166, v140, v141
    v_cvt_pk_bf16_f32 v167, v142, v143
    s_nop 1
    v_mfma_f32_16x16x32_bf16 v[32:35], a[160:163], v[164:167], v[32:35]
    s_add_u32 m0, s34, 0x10000
    v_fma_f32 v145, v145, s28, -v194
    v_fma_f32 v146, v146, s28, -v194
    v_mfma_f32_16x16x32_bf16 v[4:7], a[164:167], v[160:163], v[4:7]
    buffer_load_dwordx4 v210, s[16:19], 0 offen nt lds
    buffer_load_dwordx4 v211, s[16:19], 0 offen offset:1024 nt lds
    v_mfma_f32_16x16x32_bf16 v[36:39], a[164:167], v[164:167], v[36:39]
    s_add_u32 s16, s16, 0x2000
    v_exp_f32 v144, v144
    v_mfma_f32_16x16x32_bf16 v[176:179], v[220:223], v[160:163], v[176:179]
    s_addc_u32 s17, s17, 0
    v_exp_f32 v145, v145
    v_mfma_f32_16x16x32_bf16 v[8:11], a[168:171], v[160:163], v[8:11]
    v_fma_f32 v147, v147, s28, -v194
    v_fma_f32 v148, v148, s28, -v195
    v_mfma_f32_16x16x32_bf16 v[180:183], v[220:223], v[164:167], v[180:183]
    s_add_u32 m0, s34, 0x2000
    v_exp_f32 v146, v146
    v_mfma_f32_16x16x32_bf16 v[40:43], a[168:171], v[164:167], v[40:43]
    buffer_load_dwordx4 v208, s[12:15], 0 offen nt lds
    buffer_load_dwordx4 v209, s[12:15], 0 offen offset:1024 nt lds
    v_mfma_f32_16x16x32_bf16 v[12:15], a[172:175], v[160:163], v[12:15]
    s_add_u32 s12, s12, 0x2000
    v_exp_f32 v147, v147
    v_mfma_f32_16x16x32_bf16 v[44:47], a[172:175], v[164:167], v[44:47]
    s_addc_u32 s13, s13, 0
    v_cvt_pk_bf16_f32 v168, v144, v145
    v_fma_f32 v149, v149, s28, -v195
    v_mfma_f32_16x16x32_bf16 v[16:19], a[176:179], v[160:163], v[16:19]
    v_exp_f32 v148, v148
    v_mfma_f32_16x16x32_bf16 v[48:51], a[176:179], v[164:167], v[48:51]
    v_fma_f32 v150, v150, s28, -v195
    v_cvt_pk_bf16_f32 v169, v146, v147
    v_mfma_f32_16x16x32_bf16 v[20:23], a[180:183], v[160:163], v[20:23]
    v_exp_f32 v149, v149
    v_mfma_f32_16x16x32_bf16 v[52:55], a[180:183], v[164:167], v[52:55]
    v_fma_f32 v151, v151, s28, -v195
    v_fma_f32 v152, v152, s28, -v194
    v_mfma_f32_16x16x32_bf16 v[24:27], a[184:187], v[160:163], v[24:27]
    v_exp_f32 v150, v150
    v_mfma_f32_16x16x32_bf16 v[56:59], a[184:187], v[164:167], v[56:59]
    v_exp_f32 v151, v151
    v_mfma_f32_16x16x32_bf16 v[28:31], a[188:191], v[160:163], v[28:31]
    v_cvt_pk_bf16_f32 v172, v148, v149
    v_fma_f32 v153, v153, s28, -v194
    v_mfma_f32_16x16x32_bf16 v[60:63], a[188:191], v[164:167], v[60:63]
    s_waitcnt lgkmcnt(0)
    v_exp_f32 v152, v152
    v_mfma_f32_16x16x32_bf16 v[128:131], a[128:131], a[0:3], 0
    v_fma_f32 v154, v154, s28, -v194
    v_cvt_pk_bf16_f32 v173, v150, v151
    v_mfma_f32_16x16x32_bf16 v[128:131], a[132:135], a[4:7], v[128:131]
    v_exp_f32 v153, v153
    v_mfma_f32_16x16x32_bf16 v[128:131], a[136:139], a[8:11], v[128:131]
    v_fma_f32 v155, v155, s28, -v194
    v_fma_f32 v156, v156, s28, -v195
    v_mfma_f32_16x16x32_bf16 v[128:131], a[140:143], a[12:15], v[128:131]
    v_exp_f32 v154, v154
    v_mfma_f32_16x16x32_bf16 v[132:135], a[128:131], a[16:19], 0
    v_exp_f32 v155, v155
    v_mfma_f32_16x16x32_bf16 v[132:135], a[132:135], a[20:23], v[132:135]
    v_cvt_pk_bf16_f32 v170, v152, v153
    v_fma_f32 v157, v157, s28, -v195
    v_mfma_f32_16x16x32_bf16 v[132:135], a[136:139], a[24:27], v[132:135]
    v_exp_f32 v156, v156
    v_mfma_f32_16x16x32_bf16 v[132:135], a[140:143], a[28:31], v[132:135]
    v_fma_f32 v158, v158, s28, -v195
    v_cvt_pk_bf16_f32 v171, v154, v155
    v_mfma_f32_16x16x32_bf16 v[136:139], a[144:147], a[0:3], 0
    v_exp_f32 v157, v157
    v_mfma_f32_16x16x32_bf16 v[136:139], a[148:151], a[4:7], v[136:139]
    v_fma_f32 v159, v159, s28, -v195
    v_cvt_pk_bf16_f32 v174, v156, v157
    v_mfma_f32_16x16x32_bf16 v[136:139], a[152:155], a[8:11], v[136:139]
    v_exp_f32 v158, v158
    v_mfma_f32_16x16x32_bf16 v[136:139], a[156:159], a[12:15], v[136:139]
    v_exp_f32 v159, v159
    v_mfma_f32_16x16x32_bf16 v[140:143], a[144:147], a[16:19], 0
    v_cvt_pk_bf16_f32 v175, v158, v159
    v_fma_f32 v128, v128, s28, -v192
    v_mfma_f32_16x16x32_bf16 v[140:143], a[148:151], a[20:23], v[140:143]
    v_fma_f32 v129, v129, s28, -v192
    v_fma_f32 v130, v130, s28, -v192
    v_mfma_f32_16x16x32_bf16 v[140:143], a[152:155], a[24:27], v[140:143]
    v_exp_f32 v128, v128
    v_mfma_f32_16x16x32_bf16 v[140:143], a[156:159], a[28:31], v[140:143]
    v_exp_f32 v129, v129
    v_mfma_f32_16x16x32_bf16 v[64:67], a[160:163], v[168:171], v[64:67]
    v_fma_f32 v131, v131, s28, -v192
    v_fma_f32 v132, v132, s28, -v193
    v_mfma_f32_16x16x32_bf16 v[96:99], a[160:163], v[172:175], v[96:99]
    ds_read_b64_tr_b16 a[160:161], v200 offset:24576
    v_cvt_pk_bf16_f32 v160, v128, v129
    v_mfma_f32_16x16x32_bf16 v[68:71], a[164:167], v[168:171], v[68:71]
    ds_read_b64_tr_b16 a[162:163], v200 offset:28672
    v_fma_f32 v133, v133, s28, -v193
    v_mfma_f32_16x16x32_bf16 v[100:103], a[164:167], v[172:175], v[100:103]
    ds_read_b64_tr_b16 a[164:165], v201 offset:24576
    v_fma_f32 v134, v134, s28, -v193
    v_mfma_f32_16x16x32_bf16 v[184:187], v[220:223], v[168:171], v[184:187]
    ds_read_b64_tr_b16 a[166:167], v201 offset:28672
    v_fma_f32 v135, v135, s28, -v193
    v_mfma_f32_16x16x32_bf16 v[72:75], a[168:171], v[168:171], v[72:75]
    v_exp_f32 v130, v130
    v_mfma_f32_16x16x32_bf16 v[188:191], v[220:223], v[172:175], v[188:191]
    v_exp_f32 v131, v131
    v_mfma_f32_16x16x32_bf16 v[104:107], a[168:171], v[172:175], v[104:107]
    ds_read_b64_tr_b16 a[168:169], v202 offset:24576
    v_cvt_pk_bf16_f32 v161, v130, v131
    v_mfma_f32_16x16x32_bf16 v[76:79], a[172:175], v[168:171], v[76:79]
    ds_read_b64_tr_b16 a[170:171], v202 offset:28672
    v_fma_f32 v136, v136, s28, -v192
    v_mfma_f32_16x16x32_bf16 v[108:111], a[172:175], v[172:175], v[108:111]
    ds_read_b64_tr_b16 a[172:173], v203 offset:24576
    v_fma_f32 v137, v137, s28, -v192
    v_mfma_f32_16x16x32_bf16 v[80:83], a[176:179], v[168:171], v[80:83]
    ds_read_b64_tr_b16 a[174:175], v203 offset:28672
    v_exp_f32 v132, v132
    v_mfma_f32_16x16x32_bf16 v[112:115], a[176:179], v[172:175], v[112:115]
    ds_read_b64_tr_b16 a[176:177], v204 offset:24576
    v_fma_f32 v138, v138, s28, -v192
    v_mfma_f32_16x16x32_bf16 v[84:87], a[180:183], v[168:171], v[84:87]
    ds_read_b64_tr_b16 a[178:179], v204 offset:28672
    v_exp_f32 v133, v133
    v_mfma_f32_16x16x32_bf16 v[116:119], a[180:183], v[172:175], v[116:119]
    ds_read_b64_tr_b16 a[180:181], v205 offset:24576
    v_cvt_pk_bf16_f32 v164, v132, v133
    v_mfma_f32_16x16x32_bf16 v[88:91], a[184:187], v[168:171], v[88:91]
    ds_read_b64_tr_b16 a[182:183], v205 offset:28672
    v_fma_f32 v139, v139, s28, -v192
    v_mfma_f32_16x16x32_bf16 v[120:123], a[184:187], v[172:175], v[120:123]
    ds_read_b64_tr_b16 a[184:185], v206 offset:24576
    v_exp_f32 v134, v134
    v_mfma_f32_16x16x32_bf16 v[92:95], a[188:191], v[168:171], v[92:95]
    ds_read_b64_tr_b16 a[186:187], v206 offset:28672
    v_fma_f32 v140, v140, s28, -v193
    v_mfma_f32_16x16x32_bf16 v[124:127], a[188:191], v[172:175], v[124:127]
    ds_read_b64_tr_b16 a[188:189], v207 offset:24576
    v_exp_f32 v135, v135
    v_mfma_f32_16x16x32_bf16 v[144:147], a[128:131], a[32:35], 0
    ds_read_b64_tr_b16 a[190:191], v207 offset:28672
    v_cvt_pk_bf16_f32 v165, v134, v135
    v_mfma_f32_16x16x32_bf16 v[144:147], a[132:135], a[36:39], v[144:147]
    v_exp_f32 v136, v136
    v_mfma_f32_16x16x32_bf16 v[144:147], a[136:139], a[40:43], v[144:147]
    v_exp_f32 v137, v137
    v_mfma_f32_16x16x32_bf16 v[144:147], a[140:143], a[44:47], v[144:147]
    v_exp_f32 v138, v138
    v_mfma_f32_16x16x32_bf16 v[148:151], a[128:131], a[48:51], 0
    ds_read_b128 a[128:131], v196 offset:32768
    v_cvt_pk_bf16_f32 v162, v136, v137
    v_mfma_f32_16x16x32_bf16 v[148:151], a[132:135], a[52:55], v[148:151]
    ds_read_b128 a[132:135], v197 offset:32768
    v_fma_f32 v141, v141, s28, -v193
    v_mfma_f32_16x16x32_bf16 v[148:151], a[136:139], a[56:59], v[148:151]
    ds_read_b128 a[136:139], v198 offset:32768
    v_fma_f32 v142, v142, s28, -v193
    v_mfma_f32_16x16x32_bf16 v[148:151], a[140:143], a[60:63], v[148:151]
    ds_read_b128 a[140:143], v199 offset:32768
    v_fma_f32 v143, v143, s28, -v193
    v_mfma_f32_16x16x32_bf16 v[152:155], a[144:147], a[32:35], 0
    v_exp_f32 v139, v139
    v_mfma_f32_16x16x32_bf16 v[152:155], a[148:151], a[36:39], v[152:155]
    v_exp_f32 v140, v140
    v_mfma_f32_16x16x32_bf16 v[152:155], a[152:155], a[40:43], v[152:155]
    v_exp_f32 v141, v141
    v_mfma_f32_16x16x32_bf16 v[152:155], a[156:159], a[44:47], v[152:155]
    v_cvt_pk_bf16_f32 v163, v138, v139
    v_cvt_pk_bf16_f32 v166, v140, v141
    v_mfma_f32_16x16x32_bf16 v[156:159], a[144:147], a[48:51], 0
    ds_read_b128 a[144:147], v196 offset:36864
    v_fma_f32 v144, v144, s28, -v194
    v_mfma_f32_16x16x32_bf16 v[156:159], a[148:151], a[52:55], v[156:159]
    ds_read_b128 a[148:151], v197 offset:36864
    v_fma_f32 v145, v145, s28, -v194
    v_mfma_f32_16x16x32_bf16 v[156:159], a[152:155], a[56:59], v[156:159]
    ds_read_b128 a[152:155], v198 offset:36864
    v_fma_f32 v146, v146, s28, -v194
    v_mfma_f32_16x16x32_bf16 v[156:159], a[156:159], a[60:63], v[156:159]
    s_waitcnt lgkmcnt(7)
    ds_read_b128 a[156:159], v199 offset:36864
    v_fma_f32 v147, v147, s28, -v194
    v_mfma_f32_16x16x32_bf16 v[0:3], a[160:163], v[160:163], v[0:3]
    v_exp_f32 v142, v142
    v_exp_f32 v143, v143
    s_nop 0
    v_cvt_pk_bf16_f32 v167, v142, v143
    s_nop 1
    v_mfma_f32_16x16x32_bf16 v[32:35], a[160:163], v[164:167], v[32:35]
    s_add_u32 m0, s34, 0x12000
    v_exp_f32 v144, v144
    v_mfma_f32_16x16x32_bf16 v[4:7], a[164:167], v[160:163], v[4:7]
    buffer_load_dwordx4 v210, s[16:19], 0 offen nt lds
    buffer_load_dwordx4 v211, s[16:19], 0 offen offset:1024 nt lds
    v_mfma_f32_16x16x32_bf16 v[36:39], a[164:167], v[164:167], v[36:39]
    s_add_u32 s16, s16, 0x2000
    v_exp_f32 v145, v145
    v_mfma_f32_16x16x32_bf16 v[176:179], v[220:223], v[160:163], v[176:179]
    s_addc_u32 s17, s17, 0
    v_exp_f32 v146, v146
    v_mfma_f32_16x16x32_bf16 v[8:11], a[168:171], v[160:163], v[8:11]
    v_fma_f32 v148, v148, s28, -v195
    v_cvt_pk_bf16_f32 v168, v144, v145
    v_mfma_f32_16x16x32_bf16 v[180:183], v[220:223], v[164:167], v[180:183]
    s_add_u32 m0, s34, 0x4000
    v_exp_f32 v147, v147
    v_mfma_f32_16x16x32_bf16 v[40:43], a[168:171], v[164:167], v[40:43]
    buffer_load_dwordx4 v208, s[12:15], 0 offen nt lds
    buffer_load_dwordx4 v209, s[12:15], 0 offen offset:1024 nt lds
    v_mfma_f32_16x16x32_bf16 v[12:15], a[172:175], v[160:163], v[12:15]
    s_add_u32 s12, s12, 0x2000
    v_fma_f32 v149, v149, s28, -v195
    v_fma_f32 v150, v150, s28, -v195
    v_mfma_f32_16x16x32_bf16 v[44:47], a[172:175], v[164:167], v[44:47]
    s_addc_u32 s13, s13, 0
    v_exp_f32 v148, v148
    v_mfma_f32_16x16x32_bf16 v[16:19], a[176:179], v[160:163], v[16:19]
    v_exp_f32 v149, v149
    v_mfma_f32_16x16x32_bf16 v[48:51], a[176:179], v[164:167], v[48:51]
    v_cvt_pk_bf16_f32 v169, v146, v147
    v_fma_f32 v151, v151, s28, -v195
    v_mfma_f32_16x16x32_bf16 v[20:23], a[180:183], v[160:163], v[20:23]
    v_exp_f32 v150, v150
    v_mfma_f32_16x16x32_bf16 v[52:55], a[180:183], v[164:167], v[52:55]
    v_fma_f32 v152, v152, s28, -v194
    v_cvt_pk_bf16_f32 v172, v148, v149
    v_mfma_f32_16x16x32_bf16 v[24:27], a[184:187], v[160:163], v[24:27]
    v_exp_f32 v151, v151
    v_mfma_f32_16x16x32_bf16 v[56:59], a[184:187], v[164:167], v[56:59]
    v_fma_f32 v153, v153, s28, -v194
    v_fma_f32 v154, v154, s28, -v194
    v_mfma_f32_16x16x32_bf16 v[28:31], a[188:191], v[160:163], v[28:31]
    v_exp_f32 v152, v152
    v_mfma_f32_16x16x32_bf16 v[60:63], a[188:191], v[164:167], v[60:63]
    s_waitcnt lgkmcnt(0)
    v_exp_f32 v153, v153
    v_mfma_f32_16x16x32_bf16 v[128:131], a[128:131], a[0:3], 0
    v_cvt_pk_bf16_f32 v173, v150, v151
    v_fma_f32 v155, v155, s28, -v194
    v_mfma_f32_16x16x32_bf16 v[128:131], a[132:135], a[4:7], v[128:131]
    s_add_u32 s38, s32, 0x1000
    v_exp_f32 v154, v154
    v_mfma_f32_16x16x32_bf16 v[128:131], a[136:139], a[8:11], v[128:131]
    buffer_store_dwordx4 a[212:215], v214, s[20:23], s38 offen offset:1024 sc1
    v_fma_f32 v156, v156, s28, -v195
    v_exp_f32 v155, v155
    v_mfma_f32_16x16x32_bf16 v[128:131], a[140:143], a[12:15], v[128:131]
    v_cvt_pk_bf16_f32 v170, v152, v153
    v_fma_f32 v157, v157, s28, -v195
    v_mfma_f32_16x16x32_bf16 v[132:135], a[128:131], a[16:19], 0
    v_exp_f32 v156, v156
    v_mfma_f32_16x16x32_bf16 v[132:135], a[132:135], a[20:23], v[132:135]
    v_fma_f32 v158, v158, s28, -v195
    v_cvt_pk_bf16_f32 v171, v154, v155
    v_mfma_f32_16x16x32_bf16 v[132:135], a[136:139], a[24:27], v[132:135]
    v_exp_f32 v157, v157
    v_mfma_f32_16x16x32_bf16 v[132:135], a[140:143], a[28:31], v[132:135]
    v_fma_f32 v159, v159, s28, -v195
    v_cvt_pk_bf16_f32 v174, v156, v157
    v_mfma_f32_16x16x32_bf16 v[136:139], a[144:147], a[0:3], 0
    v_exp_f32 v158, v158
    v_mfma_f32_16x16x32_bf16 v[136:139], a[148:151], a[4:7], v[136:139]
    v_exp_f32 v159, v159
    v_mfma_f32_16x16x32_bf16 v[136:139], a[152:155], a[8:11], v[136:139]
    v_cvt_pk_bf16_f32 v175, v158, v159
    v_fma_f32 v128, v128, s28, -v192
    v_mfma_f32_16x16x32_bf16 v[136:139], a[156:159], a[12:15], v[136:139]
    v_fma_f32 v129, v129, s28, -v192
    v_fma_f32 v130, v130, s28, -v192
    v_mfma_f32_16x16x32_bf16 v[140:143], a[144:147], a[16:19], 0
    v_exp_f32 v128, v128
    v_mfma_f32_16x16x32_bf16 v[140:143], a[148:151], a[20:23], v[140:143]
    v_exp_f32 v129, v129
    v_mfma_f32_16x16x32_bf16 v[140:143], a[152:155], a[24:27], v[140:143]
    s_waitcnt vmcnt(23)
    s_barrier
    v_fma_f32 v131, v131, s28, -v192
    v_mfma_f32_16x16x32_bf16 v[140:143], a[156:159], a[28:31], v[140:143]
    v_exp_f32 v130, v130
    v_mfma_f32_16x16x32_bf16 v[64:67], a[160:163], v[168:171], v[64:67]
    v_fma_f32 v132, v132, s28, -v193
    v_cvt_pk_bf16_f32 v160, v128, v129
    v_mfma_f32_16x16x32_bf16 v[96:99], a[160:163], v[172:175], v[96:99]
    ds_read_b64_tr_b16 a[160:161], v200 offset:32768
    v_fma_f32 v133, v133, s28, -v193
    v_mfma_f32_16x16x32_bf16 v[68:71], a[164:167], v[168:171], v[68:71]
    ds_read_b64_tr_b16 a[162:163], v200 offset:36864
    v_fma_f32 v134, v134, s28, -v193
    v_mfma_f32_16x16x32_bf16 v[100:103], a[164:167], v[172:175], v[100:103]
    ds_read_b64_tr_b16 a[164:165], v201 offset:32768
    v_fma_f32 v135, v135, s28, -v193
    v_mfma_f32_16x16x32_bf16 v[184:187], v[220:223], v[168:171], v[184:187]
    ds_read_b64_tr_b16 a[166:167], v201 offset:36864
    v_fma_f32 v136, v136, s28, -v192
    v_mfma_f32_16x16x32_bf16 v[72:75], a[168:171], v[168:171], v[72:75]
    v_exp_f32 v131, v131
    v_mfma_f32_16x16x32_bf16 v[188:191], v[220:223], v[172:175], v[188:191]
    v_exp_f32 v132, v132
    v_mfma_f32_16x16x32_bf16 v[104:107], a[168:171], v[172:175], v[104:107]
    ds_read_b64_tr_b16 a[168:169], v202 offset:32768
    v_cvt_pk_bf16_f32 v161, v130, v131
    v_mfma_f32_16x16x32_bf16 v[76:79], a[172:175], v[168:171], v[76:79]
    ds_read_b64_tr_b16 a[170:171], v202 offset:36864
    v_fma_f32 v137, v137, s28, -v192
    v_mfma_f32_16x16x32_bf16 v[108:111], a[172:175], v[172:175], v[108:111]
    ds_read_b64_tr_b16 a[172:173], v203 offset:32768
    v_fma_f32 v138, v138, s28, -v192
    v_mfma_f32_16x16x32_bf16 v[80:83], a[176:179], v[168:171], v[80:83]
    ds_read_b64_tr_b16 a[174:175], v203 offset:36864
    v_exp_f32 v133, v133
    v_mfma_f32_16x16x32_bf16 v[112:115], a[176:179], v[172:175], v[112:115]
    ds_read_b64_tr_b16 a[176:177], v204 offset:32768
    v_cvt_pk_bf16_f32 v164, v132, v133
    v_mfma_f32_16x16x32_bf16 v[84:87], a[180:183], v[168:171], v[84:87]
    ds_read_b64_tr_b16 a[178:179], v204 offset:36864
    v_fma_f32 v139, v139, s28, -v192
    v_mfma_f32_16x16x32_bf16 v[116:119], a[180:183], v[172:175], v[116:119]
    ds_read_b64_tr_b16 a[180:181], v205 offset:32768
    v_exp_f32 v134, v134
    v_mfma_f32_16x16x32_bf16 v[88:91], a[184:187], v[168:171], v[88:91]
    ds_read_b64_tr_b16 a[182:183], v205 offset:36864
    v_fma_f32 v140, v140, s28, -v193
    v_mfma_f32_16x16x32_bf16 v[120:123], a[184:187], v[172:175], v[120:123]
    ds_read_b64_tr_b16 a[184:185], v206 offset:32768
    v_exp_f32 v135, v135
    v_mfma_f32_16x16x32_bf16 v[92:95], a[188:191], v[168:171], v[92:95]
    ds_read_b64_tr_b16 a[186:187], v206 offset:36864
    v_cvt_pk_bf16_f32 v165, v134, v135
    v_mfma_f32_16x16x32_bf16 v[124:127], a[188:191], v[172:175], v[124:127]
    ds_read_b64_tr_b16 a[188:189], v207 offset:32768
    v_fma_f32 v141, v141, s28, -v193
    v_mfma_f32_16x16x32_bf16 v[144:147], a[128:131], a[32:35], 0
    ds_read_b64_tr_b16 a[190:191], v207 offset:36864
    v_exp_f32 v136, v136
    v_mfma_f32_16x16x32_bf16 v[144:147], a[132:135], a[36:39], v[144:147]
    s_add_u32 m0, s35, 0x1000
    v_exp_f32 v137, v137
    v_mfma_f32_16x16x32_bf16 v[144:147], a[136:139], a[40:43], v[144:147]
    buffer_load_dwordx4 v215, s[8:11], 0 offen nt lds
    buffer_load_dwordx4 v216, s[8:11], 0 offen offset:1024 nt lds
    v_mfma_f32_16x16x32_bf16 v[144:147], a[140:143], a[44:47], v[144:147]
    buffer_load_dwordx4 v217, s[8:11], 0 offen offset:2048 nt lds
    buffer_load_dwordx4 v218, s[8:11], 0 offen offset:3072 nt lds
    v_mfma_f32_16x16x32_bf16 v[148:151], a[128:131], a[48:51], 0
    ds_read_b128 a[128:131], v196 offset:40960
    v_cvt_pk_bf16_f32 v162, v136, v137
    v_mfma_f32_16x16x32_bf16 v[148:151], a[132:135], a[52:55], v[148:151]
    ds_read_b128 a[132:135], v197 offset:40960
    v_fma_f32 v142, v142, s28, -v193
    v_mfma_f32_16x16x32_bf16 v[148:151], a[136:139], a[56:59], v[148:151]
    ds_read_b128 a[136:139], v198 offset:40960
    v_fma_f32 v143, v143, s28, -v193
    v_mfma_f32_16x16x32_bf16 v[148:151], a[140:143], a[60:63], v[148:151]
    ds_read_b128 a[140:143], v199 offset:40960
    v_exp_f32 v138, v138
    v_mfma_f32_16x16x32_bf16 v[152:155], a[144:147], a[32:35], 0
    s_add_u32 s8, s8, 0xffd000
    s_addc_u32 s9, s9, 0
    v_exp_f32 v139, v139
    v_mfma_f32_16x16x32_bf16 v[152:155], a[148:151], a[36:39], v[152:155]
    v_exp_f32 v140, v140
    v_mfma_f32_16x16x32_bf16 v[152:155], a[152:155], a[40:43], v[152:155]
    v_exp_f32 v141, v141
    v_mfma_f32_16x16x32_bf16 v[152:155], a[156:159], a[44:47], v[152:155]
    v_cvt_pk_bf16_f32 v163, v138, v139
    v_cvt_pk_bf16_f32 v166, v140, v141
    v_mfma_f32_16x16x32_bf16 v[156:159], a[144:147], a[48:51], 0
    ds_read_b128 a[144:147], v196 offset:45056
    v_fma_f32 v144, v144, s28, -v194
    v_mfma_f32_16x16x32_bf16 v[156:159], a[148:151], a[52:55], v[156:159]
    ds_read_b128 a[148:151], v197 offset:45056
    v_fma_f32 v145, v145, s28, -v194
    v_mfma_f32_16x16x32_bf16 v[156:159], a[152:155], a[56:59], v[156:159]
    ds_read_b128 a[152:155], v198 offset:45056
    v_fma_f32 v146, v146, s28, -v194
    v_mfma_f32_16x16x32_bf16 v[156:159], a[156:159], a[60:63], v[156:159]
    s_waitcnt lgkmcnt(7)
    ds_read_b128 a[156:159], v199 offset:45056
    v_fma_f32 v147, v147, s28, -v194
    v_mfma_f32_16x16x32_bf16 v[0:3], a[160:163], v[160:163], v[0:3]
    v_exp_f32 v142, v142
    v_exp_f32 v143, v143
    s_nop 0
    v_cvt_pk_bf16_f32 v167, v142, v143
    s_nop 1
    v_mfma_f32_16x16x32_bf16 v[32:35], a[160:163], v[164:167], v[32:35]
    s_add_u32 m0, s34, 0x14000
    v_exp_f32 v144, v144
    v_mfma_f32_16x16x32_bf16 v[4:7], a[164:167], v[160:163], v[4:7]
    buffer_load_dwordx4 v210, s[16:19], 0 offen nt lds
    buffer_load_dwordx4 v211, s[16:19], 0 offen offset:1024 nt lds
    v_mfma_f32_16x16x32_bf16 v[36:39], a[164:167], v[164:167], v[36:39]
    s_add_u32 s16, s16, 0x2000
    v_exp_f32 v145, v145
    v_mfma_f32_16x16x32_bf16 v[176:179], v[220:223], v[160:163], v[176:179]
    s_addc_u32 s17, s17, 0
    v_exp_f32 v146, v146
    v_mfma_f32_16x16x32_bf16 v[8:11], a[168:171], v[160:163], v[8:11]
    v_fma_f32 v148, v148, s28, -v195
    v_cvt_pk_bf16_f32 v168, v144, v145
    v_mfma_f32_16x16x32_bf16 v[180:183], v[220:223], v[164:167], v[180:183]
    s_add_u32 m0, s34, 0x6000
    v_exp_f32 v147, v147
    v_mfma_f32_16x16x32_bf16 v[40:43], a[168:171], v[164:167], v[40:43]
    buffer_load_dwordx4 v208, s[12:15], 0 offen nt lds
    buffer_load_dwordx4 v209, s[12:15], 0 offen offset:1024 nt lds
    v_mfma_f32_16x16x32_bf16 v[12:15], a[172:175], v[160:163], v[12:15]
    s_add_u32 s12, s12, 0x2000
    v_fma_f32 v149, v149, s28, -v195
    v_fma_f32 v150, v150, s28, -v195
    v_mfma_f32_16x16x32_bf16 v[44:47], a[172:175], v[164:167], v[44:47]
    s_addc_u32 s13, s13, 0
    v_exp_f32 v148, v148
    v_mfma_f32_16x16x32_bf16 v[16:19], a[176:179], v[160:163], v[16:19]
    v_exp_f32 v149, v149
    v_mfma_f32_16x16x32_bf16 v[48:51], a[176:179], v[164:167], v[48:51]
    v_cvt_pk_bf16_f32 v169, v146, v147
    v_fma_f32 v151, v151, s28, -v195
    v_mfma_f32_16x16x32_bf16 v[20:23], a[180:183], v[160:163], v[20:23]
    v_exp_f32 v150, v150
    v_mfma_f32_16x16x32_bf16 v[52:55], a[180:183], v[164:167], v[52:55]
    v_fma_f32 v152, v152, s28, -v194
    v_cvt_pk_bf16_f32 v172, v148, v149
    v_mfma_f32_16x16x32_bf16 v[24:27], a[184:187], v[160:163], v[24:27]
    v_exp_f32 v151, v151
    v_mfma_f32_16x16x32_bf16 v[56:59], a[184:187], v[164:167], v[56:59]
    v_fma_f32 v153, v153, s28, -v194
    v_fma_f32 v154, v154, s28, -v194
    v_mfma_f32_16x16x32_bf16 v[28:31], a[188:191], v[160:163], v[28:31]
    v_exp_f32 v152, v152
    v_mfma_f32_16x16x32_bf16 v[60:63], a[188:191], v[164:167], v[60:63]
    s_waitcnt lgkmcnt(0)
    v_exp_f32 v153, v153
    v_mfma_f32_16x16x32_bf16 v[128:131], a[128:131], a[0:3], 0
    v_cvt_pk_bf16_f32 v173, v150, v151
    v_fma_f32 v155, v155, s28, -v194
    v_mfma_f32_16x16x32_bf16 v[128:131], a[132:135], a[4:7], v[128:131]
    v_exp_f32 v154, v154
    v_mfma_f32_16x16x32_bf16 v[128:131], a[136:139], a[8:11], v[128:131]
    v_fma_f32 v156, v156, s28, -v195
    v_cvt_pk_bf16_f32 v170, v152, v153
    v_mfma_f32_16x16x32_bf16 v[128:131], a[140:143], a[12:15], v[128:131]
    v_exp_f32 v155, v155
    v_mfma_f32_16x16x32_bf16 v[132:135], a[128:131], a[16:19], 0
    v_fma_f32 v157, v157, s28, -v195
    v_fma_f32 v158, v158, s28, -v195
    v_mfma_f32_16x16x32_bf16 v[132:135], a[132:135], a[20:23], v[132:135]
    v_exp_f32 v156, v156
    v_mfma_f32_16x16x32_bf16 v[132:135], a[136:139], a[24:27], v[132:135]
    v_exp_f32 v157, v157
    v_mfma_f32_16x16x32_bf16 v[132:135], a[140:143], a[28:31], v[132:135]
    v_cvt_pk_bf16_f32 v171, v154, v155
    v_fma_f32 v159, v159, s28, -v195
    v_mfma_f32_16x16x32_bf16 v[136:139], a[144:147], a[0:3], 0
    v_exp_f32 v158, v158
    v_mfma_f32_16x16x32_bf16 v[136:139], a[148:151], a[4:7], v[136:139]
    v_exp_f32 v159, v159
    v_mfma_f32_16x16x32_bf16 v[136:139], a[152:155], a[8:11], v[136:139]
    v_cvt_pk_bf16_f32 v174, v156, v157
    v_cvt_pk_bf16_f32 v175, v158, v159
    v_mfma_f32_16x16x32_bf16 v[136:139], a[156:159], a[12:15], v[136:139]
    v_fma_f32 v128, v128, s28, -v192
    v_fma_f32 v129, v129, s28, -v192
    v_mfma_f32_16x16x32_bf16 v[140:143], a[144:147], a[16:19], 0
    v_exp_f32 v128, v128
    v_mfma_f32_16x16x32_bf16 v[140:143], a[148:151], a[20:23], v[140:143]
    v_fma_f32 v130, v130, s28, -v192
    v_fma_f32 v131, v131, s28, -v192
    v_mfma_f32_16x16x32_bf16 v[140:143], a[152:155], a[24:27], v[140:143]
    v_exp_f32 v129, v129
    v_mfma_f32_16x16x32_bf16 v[140:143], a[156:159], a[28:31], v[140:143]
    v_exp_f32 v130, v130
    v_mfma_f32_16x16x32_bf16 v[64:67], a[160:163], v[168:171], v[64:67]
    v_fma_f32 v132, v132, s28, -v193
    v_cvt_pk_bf16_f32 v160, v128, v129
    v_mfma_f32_16x16x32_bf16 v[96:99], a[160:163], v[172:175], v[96:99]
    ds_read_b64_tr_b16 a[160:161], v200 offset:40960
    v_fma_f32 v133, v133, s28, -v193
    v_mfma_f32_16x16x32_bf16 v[68:71], a[164:167], v[168:171], v[68:71]
    ds_read_b64_tr_b16 a[162:163], v200 offset:45056
    v_fma_f32 v134, v134, s28, -v193
    v_mfma_f32_16x16x32_bf16 v[100:103], a[164:167], v[172:175], v[100:103]
    ds_read_b64_tr_b16 a[164:165], v201 offset:40960
    v_fma_f32 v135, v135, s28, -v193
    v_mfma_f32_16x16x32_bf16 v[184:187], v[220:223], v[168:171], v[184:187]
    ds_read_b64_tr_b16 a[166:167], v201 offset:45056
    v_fma_f32 v136, v136, s28, -v192
    v_mfma_f32_16x16x32_bf16 v[72:75], a[168:171], v[168:171], v[72:75]
    v_exp_f32 v131, v131
    v_mfma_f32_16x16x32_bf16 v[188:191], v[220:223], v[172:175], v[188:191]
    v_exp_f32 v132, v132
    v_mfma_f32_16x16x32_bf16 v[104:107], a[168:171], v[172:175], v[104:107]
    ds_read_b64_tr_b16 a[168:169], v202 offset:40960
    v_cvt_pk_bf16_f32 v161, v130, v131
    v_mfma_f32_16x16x32_bf16 v[76:79], a[172:175], v[168:171], v[76:79]
    ds_read_b64_tr_b16 a[170:171], v202 offset:45056
    v_fma_f32 v137, v137, s28, -v192
    v_mfma_f32_16x16x32_bf16 v[108:111], a[172:175], v[172:175], v[108:111]
    ds_read_b64_tr_b16 a[172:173], v203 offset:40960
    v_fma_f32 v138, v138, s28, -v192
    v_mfma_f32_16x16x32_bf16 v[80:83], a[176:179], v[168:171], v[80:83]
    ds_read_b64_tr_b16 a[174:175], v203 offset:45056
    v_exp_f32 v133, v133
    v_mfma_f32_16x16x32_bf16 v[112:115], a[176:179], v[172:175], v[112:115]
    ds_read_b64_tr_b16 a[176:177], v204 offset:40960
    v_cvt_pk_bf16_f32 v164, v132, v133
    v_mfma_f32_16x16x32_bf16 v[84:87], a[180:183], v[168:171], v[84:87]
    ds_read_b64_tr_b16 a[178:179], v204 offset:45056
    v_fma_f32 v139, v139, s28, -v192
    v_mfma_f32_16x16x32_bf16 v[116:119], a[180:183], v[172:175], v[116:119]
    ds_read_b64_tr_b16 a[180:181], v205 offset:40960
    v_exp_f32 v134, v134
    v_mfma_f32_16x16x32_bf16 v[88:91], a[184:187], v[168:171], v[88:91]
    ds_read_b64_tr_b16 a[182:183], v205 offset:45056
    v_fma_f32 v140, v140, s28, -v193
    v_mfma_f32_16x16x32_bf16 v[120:123], a[184:187], v[172:175], v[120:123]
    ds_read_b64_tr_b16 a[184:185], v206 offset:40960
    v_exp_f32 v135, v135
    v_mfma_f32_16x16x32_bf16 v[92:95], a[188:191], v[168:171], v[92:95]
    ds_read_b64_tr_b16 a[186:187], v206 offset:45056
    v_cvt_pk_bf16_f32 v165, v134, v135
    v_mfma_f32_16x16x32_bf16 v[124:127], a[188:191], v[172:175], v[124:127]
    ds_read_b64_tr_b16 a[188:189], v207 offset:40960
    v_fma_f32 v141, v141, s28, -v193
    v_mfma_f32_16x16x32_bf16 v[144:147], a[128:131], a[32:35], 0
    ds_read_b64_tr_b16 a[190:191], v207 offset:45056
    v_exp_f32 v136, v136
    v_mfma_f32_16x16x32_bf16 v[144:147], a[132:135], a[36:39], v[144:147]
    v_exp_f32 v137, v137
    v_mfma_f32_16x16x32_bf16 v[144:147], a[136:139], a[40:43], v[144:147]
    v_exp_f32 v138, v138
    v_mfma_f32_16x16x32_bf16 v[144:147], a[140:143], a[44:47], v[144:147]
    v_exp_f32 v139, v139
    v_mfma_f32_16x16x32_bf16 v[148:151], a[128:131], a[48:51], 0
    ds_read_b128 a[128:131], v196 offset:49152
    v_cvt_pk_bf16_f32 v162, v136, v137
    v_mfma_f32_16x16x32_bf16 v[148:151], a[132:135], a[52:55], v[148:151]
    ds_read_b128 a[132:135], v197 offset:49152
    v_fma_f32 v142, v142, s28, -v193
    v_mfma_f32_16x16x32_bf16 v[148:151], a[136:139], a[56:59], v[148:151]
    ds_read_b128 a[136:139], v198 offset:49152
    v_cvt_pk_bf16_f32 v163, v138, v139
    v_mfma_f32_16x16x32_bf16 v[148:151], a[140:143], a[60:63], v[148:151]
    ds_read_b128 a[140:143], v199 offset:49152
    v_fma_f32 v143, v143, s28, -v193
    v_mfma_f32_16x16x32_bf16 v[152:155], a[144:147], a[32:35], 0
    v_exp_f32 v140, v140
    v_mfma_f32_16x16x32_bf16 v[152:155], a[148:151], a[36:39], v[152:155]
    v_exp_f32 v141, v141
    v_mfma_f32_16x16x32_bf16 v[152:155], a[152:155], a[40:43], v[152:155]
    v_exp_f32 v142, v142
    v_mfma_f32_16x16x32_bf16 v[152:155], a[156:159], a[44:47], v[152:155]
    v_exp_f32 v143, v143
    v_mfma_f32_16x16x32_bf16 v[156:159], a[144:147], a[48:51], 0
    ds_read_b128 a[144:147], v196 offset:53248
    v_cvt_pk_bf16_f32 v166, v140, v141
    v_mfma_f32_16x16x32_bf16 v[156:159], a[148:151], a[52:55], v[156:159]
    ds_read_b128 a[148:151], v197 offset:53248
    v_cvt_pk_bf16_f32 v167, v142, v143
    v_mfma_f32_16x16x32_bf16 v[156:159], a[152:155], a[56:59], v[156:159]
    ds_read_b128 a[152:155], v198 offset:53248
    v_fma_f32 v144, v144, s28, -v194
    v_mfma_f32_16x16x32_bf16 v[156:159], a[156:159], a[60:63], v[156:159]
    s_waitcnt lgkmcnt(7)
    ds_read_b128 a[156:159], v199 offset:53248
    v_fma_f32 v145, v145, s28, -v194
    v_mfma_f32_16x16x32_bf16 v[0:3], a[160:163], v[160:163], v[0:3]
    v_exp_f32 v144, v144
    v_mfma_f32_16x16x32_bf16 v[32:35], a[160:163], v[164:167], v[32:35]
    s_add_u32 m0, s34, 0x16000
    v_fma_f32 v146, v146, s28, -v194
    v_fma_f32 v147, v147, s28, -v194
    v_mfma_f32_16x16x32_bf16 v[4:7], a[164:167], v[160:163], v[4:7]
    buffer_load_dwordx4 v210, s[16:19], 0 offen nt lds
    buffer_load_dwordx4 v211, s[16:19], 0 offen offset:1024 nt lds
    v_mfma_f32_16x16x32_bf16 v[36:39], a[164:167], v[164:167], v[36:39]
    s_add_u32 s16, s16, 0x2000
    v_exp_f32 v145, v145
    v_mfma_f32_16x16x32_bf16 v[176:179], v[220:223], v[160:163], v[176:179]
    s_addc_u32 s17, s17, 0
    v_exp_f32 v146, v146
    v_mfma_f32_16x16x32_bf16 v[8:11], a[168:171], v[160:163], v[8:11]
    v_fma_f32 v148, v148, s28, -v195
    v_cvt_pk_bf16_f32 v168, v144, v145
    v_mfma_f32_16x16x32_bf16 v[180:183], v[220:223], v[164:167], v[180:183]
    s_add_u32 m0, s34, 0x8000
    v_exp_f32 v147, v147
    v_mfma_f32_16x16x32_bf16 v[40:43], a[168:171], v[164:167], v[40:43]
    buffer_load_dwordx4 v208, s[12:15], 0 offen nt lds
    buffer_load_dwordx4 v209, s[12:15], 0 offen offset:1024 nt lds
    v_mfma_f32_16x16x32_bf16 v[12:15], a[172:175], v[160:163], v[12:15]
    s_add_u32 s12, s12, 0x2000
    v_fma_f32 v149, v149, s28, -v195
    v_fma_f32 v150, v150, s28, -v195
    v_mfma_f32_16x16x32_bf16 v[44:47], a[172:175], v[164:167], v[44:47]
    s_addc_u32 s13, s13, 0
    v_exp_f32 v148, v148
    v_mfma_f32_16x16x32_bf16 v[16:19], a[176:179], v[160:163], v[16:19]
    v_exp_f32 v149, v149
    v_mfma_f32_16x16x32_bf16 v[48:51], a[176:179], v[164:167], v[48:51]
    v_cvt_pk_bf16_f32 v169, v146, v147
    v_fma_f32 v151, v151, s28, -v195
    v_mfma_f32_16x16x32_bf16 v[20:23], a[180:183], v[160:163], v[20:23]
    v_exp_f32 v150, v150
    v_mfma_f32_16x16x32_bf16 v[52:55], a[180:183], v[164:167], v[52:55]
    v_fma_f32 v152, v152, s28, -v194
    v_cvt_pk_bf16_f32 v172, v148, v149
    v_mfma_f32_16x16x32_bf16 v[24:27], a[184:187], v[160:163], v[24:27]
    v_exp_f32 v151, v151
    v_mfma_f32_16x16x32_bf16 v[56:59], a[184:187], v[164:167], v[56:59]
    v_fma_f32 v153, v153, s28, -v194
    v_fma_f32 v154, v154, s28, -v194
    v_mfma_f32_16x16x32_bf16 v[28:31], a[188:191], v[160:163], v[28:31]
    v_exp_f32 v152, v152
    v_mfma_f32_16x16x32_bf16 v[60:63], a[188:191], v[164:167], v[60:63]
    s_waitcnt lgkmcnt(0)
    v_exp_f32 v153, v153
    v_mfma_f32_16x16x32_bf16 v[128:131], a[128:131], a[0:3], 0
    v_cvt_pk_bf16_f32 v173, v150, v151
    v_fma_f32 v155, v155, s28, -v194
    v_mfma_f32_16x16x32_bf16 v[128:131], a[132:135], a[4:7], v[128:131]
    s_add_u32 s38, s32, 0x1000
    v_exp_f32 v154, v154
    v_mfma_f32_16x16x32_bf16 v[128:131], a[136:139], a[8:11], v[128:131]
    buffer_store_dwordx4 a[216:219], v214, s[20:23], s38 offen offset:2048 sc1
    v_fma_f32 v156, v156, s28, -v195
    v_exp_f32 v155, v155
    v_mfma_f32_16x16x32_bf16 v[128:131], a[140:143], a[12:15], v[128:131]
    v_cvt_pk_bf16_f32 v170, v152, v153
    v_fma_f32 v157, v157, s28, -v195
    v_mfma_f32_16x16x32_bf16 v[132:135], a[128:131], a[16:19], 0
    v_exp_f32 v156, v156
    v_mfma_f32_16x16x32_bf16 v[132:135], a[132:135], a[20:23], v[132:135]
    v_fma_f32 v158, v158, s28, -v195
    v_cvt_pk_bf16_f32 v171, v154, v155
    v_mfma_f32_16x16x32_bf16 v[132:135], a[136:139], a[24:27], v[132:135]
    v_exp_f32 v157, v157
    v_mfma_f32_16x16x32_bf16 v[132:135], a[140:143], a[28:31], v[132:135]
    v_fma_f32 v159, v159, s28, -v195
    v_cvt_pk_bf16_f32 v174, v156, v157
    v_mfma_f32_16x16x32_bf16 v[136:139], a[144:147], a[0:3], 0
    v_exp_f32 v158, v158
    v_mfma_f32_16x16x32_bf16 v[136:139], a[148:151], a[4:7], v[136:139]
    v_exp_f32 v159, v159
    v_mfma_f32_16x16x32_bf16 v[136:139], a[152:155], a[8:11], v[136:139]
    v_cvt_pk_bf16_f32 v175, v158, v159
    v_fma_f32 v128, v128, s28, -v192
    v_mfma_f32_16x16x32_bf16 v[136:139], a[156:159], a[12:15], v[136:139]
    v_fma_f32 v129, v129, s28, -v192
    v_fma_f32 v130, v130, s28, -v192
    v_mfma_f32_16x16x32_bf16 v[140:143], a[144:147], a[16:19], 0
    v_exp_f32 v128, v128
    v_mfma_f32_16x16x32_bf16 v[140:143], a[148:151], a[20:23], v[140:143]
    v_exp_f32 v129, v129
    v_mfma_f32_16x16x32_bf16 v[140:143], a[152:155], a[24:27], v[140:143]
    s_waitcnt vmcnt(27)
    s_barrier
    v_fma_f32 v131, v131, s28, -v192
    v_mfma_f32_16x16x32_bf16 v[140:143], a[156:159], a[28:31], v[140:143]
    v_exp_f32 v130, v130
    v_mfma_f32_16x16x32_bf16 v[64:67], a[160:163], v[168:171], v[64:67]
    v_fma_f32 v132, v132, s28, -v193
    v_cvt_pk_bf16_f32 v160, v128, v129
    v_mfma_f32_16x16x32_bf16 v[96:99], a[160:163], v[172:175], v[96:99]
    ds_read_b64_tr_b16 a[160:161], v200 offset:49152
    v_fma_f32 v133, v133, s28, -v193
    v_mfma_f32_16x16x32_bf16 v[68:71], a[164:167], v[168:171], v[68:71]
    ds_read_b64_tr_b16 a[162:163], v200 offset:53248
    v_fma_f32 v134, v134, s28, -v193
    v_mfma_f32_16x16x32_bf16 v[100:103], a[164:167], v[172:175], v[100:103]
    ds_read_b64_tr_b16 a[164:165], v201 offset:49152
    v_fma_f32 v135, v135, s28, -v193
    v_mfma_f32_16x16x32_bf16 v[184:187], v[220:223], v[168:171], v[184:187]
    ds_read_b64_tr_b16 a[166:167], v201 offset:53248
    v_fma_f32 v136, v136, s28, -v192
    v_mfma_f32_16x16x32_bf16 v[72:75], a[168:171], v[168:171], v[72:75]
    v_exp_f32 v131, v131
    v_mfma_f32_16x16x32_bf16 v[188:191], v[220:223], v[172:175], v[188:191]
    v_exp_f32 v132, v132
    v_mfma_f32_16x16x32_bf16 v[104:107], a[168:171], v[172:175], v[104:107]
    ds_read_b64_tr_b16 a[168:169], v202 offset:49152
    v_cvt_pk_bf16_f32 v161, v130, v131
    v_mfma_f32_16x16x32_bf16 v[76:79], a[172:175], v[168:171], v[76:79]
    ds_read_b64_tr_b16 a[170:171], v202 offset:53248
    v_fma_f32 v137, v137, s28, -v192
    v_mfma_f32_16x16x32_bf16 v[108:111], a[172:175], v[172:175], v[108:111]
    ds_read_b64_tr_b16 a[172:173], v203 offset:49152
    v_fma_f32 v138, v138, s28, -v192
    v_mfma_f32_16x16x32_bf16 v[80:83], a[176:179], v[168:171], v[80:83]
    ds_read_b64_tr_b16 a[174:175], v203 offset:53248
    v_exp_f32 v133, v133
    v_mfma_f32_16x16x32_bf16 v[112:115], a[176:179], v[172:175], v[112:115]
    ds_read_b64_tr_b16 a[176:177], v204 offset:49152
    v_cvt_pk_bf16_f32 v164, v132, v133
    v_mfma_f32_16x16x32_bf16 v[84:87], a[180:183], v[168:171], v[84:87]
    ds_read_b64_tr_b16 a[178:179], v204 offset:53248
    v_fma_f32 v139, v139, s28, -v192
    v_mfma_f32_16x16x32_bf16 v[116:119], a[180:183], v[172:175], v[116:119]
    ds_read_b64_tr_b16 a[180:181], v205 offset:49152
    v_exp_f32 v134, v134
    v_mfma_f32_16x16x32_bf16 v[88:91], a[184:187], v[168:171], v[88:91]
    ds_read_b64_tr_b16 a[182:183], v205 offset:53248
    v_fma_f32 v140, v140, s28, -v193
    v_mfma_f32_16x16x32_bf16 v[120:123], a[184:187], v[172:175], v[120:123]
    ds_read_b64_tr_b16 a[184:185], v206 offset:49152
    v_exp_f32 v135, v135
    v_mfma_f32_16x16x32_bf16 v[92:95], a[188:191], v[168:171], v[92:95]
    ds_read_b64_tr_b16 a[186:187], v206 offset:53248
    v_cvt_pk_bf16_f32 v165, v134, v135
    v_mfma_f32_16x16x32_bf16 v[124:127], a[188:191], v[172:175], v[124:127]
    ds_read_b64_tr_b16 a[188:189], v207 offset:49152
    v_fma_f32 v141, v141, s28, -v193
    v_mfma_f32_16x16x32_bf16 v[144:147], a[128:131], a[32:35], 0
    ds_read_b64_tr_b16 a[190:191], v207 offset:53248
    v_exp_f32 v136, v136
    v_mfma_f32_16x16x32_bf16 v[144:147], a[132:135], a[36:39], v[144:147]
    v_exp_f32 v137, v137
    v_mfma_f32_16x16x32_bf16 v[144:147], a[136:139], a[40:43], v[144:147]
    v_exp_f32 v138, v138
    v_mfma_f32_16x16x32_bf16 v[144:147], a[140:143], a[44:47], v[144:147]
    v_exp_f32 v139, v139
    v_mfma_f32_16x16x32_bf16 v[148:151], a[128:131], a[48:51], 0
    ds_read_b128 a[128:131], v196 offset:57344
    v_cvt_pk_bf16_f32 v162, v136, v137
    v_mfma_f32_16x16x32_bf16 v[148:151], a[132:135], a[52:55], v[148:151]
    ds_read_b128 a[132:135], v197 offset:57344
    v_fma_f32 v142, v142, s28, -v193
    v_mfma_f32_16x16x32_bf16 v[148:151], a[136:139], a[56:59], v[148:151]
    ds_read_b128 a[136:139], v198 offset:57344
    v_cvt_pk_bf16_f32 v163, v138, v139
    v_mfma_f32_16x16x32_bf16 v[148:151], a[140:143], a[60:63], v[148:151]
    ds_read_b128 a[140:143], v199 offset:57344
    v_fma_f32 v143, v143, s28, -v193
    v_mfma_f32_16x16x32_bf16 v[152:155], a[144:147], a[32:35], 0
    v_exp_f32 v140, v140
    v_mfma_f32_16x16x32_bf16 v[152:155], a[148:151], a[36:39], v[152:155]
    v_exp_f32 v141, v141
    v_mfma_f32_16x16x32_bf16 v[152:155], a[152:155], a[40:43], v[152:155]
    v_exp_f32 v142, v142
    v_mfma_f32_16x16x32_bf16 v[152:155], a[156:159], a[44:47], v[152:155]
    v_exp_f32 v143, v143
    v_mfma_f32_16x16x32_bf16 v[156:159], a[144:147], a[48:51], 0
    ds_read_b128 a[144:147], v196 offset:61440
    v_cvt_pk_bf16_f32 v166, v140, v141
    v_mfma_f32_16x16x32_bf16 v[156:159], a[148:151], a[52:55], v[156:159]
    ds_read_b128 a[148:151], v197 offset:61440
    v_cvt_pk_bf16_f32 v167, v142, v143
    v_mfma_f32_16x16x32_bf16 v[156:159], a[152:155], a[56:59], v[156:159]
    ds_read_b128 a[152:155], v198 offset:61440
    v_fma_f32 v144, v144, s28, -v194
    v_mfma_f32_16x16x32_bf16 v[156:159], a[156:159], a[60:63], v[156:159]
    s_waitcnt lgkmcnt(7)
    ds_read_b128 a[156:159], v199 offset:61440
    v_fma_f32 v145, v145, s28, -v194
    v_mfma_f32_16x16x32_bf16 v[0:3], a[160:163], v[160:163], v[0:3]
    v_exp_f32 v144, v144
    v_mfma_f32_16x16x32_bf16 v[32:35], a[160:163], v[164:167], v[32:35]
    s_add_u32 m0, s34, 0x18000
    v_fma_f32 v146, v146, s28, -v194
    v_fma_f32 v147, v147, s28, -v194
    v_mfma_f32_16x16x32_bf16 v[4:7], a[164:167], v[160:163], v[4:7]
    buffer_load_dwordx4 v210, s[16:19], 0 offen nt lds
    buffer_load_dwordx4 v211, s[16:19], 0 offen offset:1024 nt lds
    v_mfma_f32_16x16x32_bf16 v[36:39], a[164:167], v[164:167], v[36:39]
    s_add_u32 s16, s16, 0x2000
    v_exp_f32 v145, v145
    v_mfma_f32_16x16x32_bf16 v[176:179], v[220:223], v[160:163], v[176:179]
    s_addc_u32 s17, s17, 0
    v_exp_f32 v146, v146
    v_mfma_f32_16x16x32_bf16 v[8:11], a[168:171], v[160:163], v[8:11]
    v_fma_f32 v148, v148, s28, -v195
    v_cvt_pk_bf16_f32 v168, v144, v145
    v_mfma_f32_16x16x32_bf16 v[180:183], v[220:223], v[164:167], v[180:183]
    s_add_u32 m0, s34, 0xa000
    v_exp_f32 v147, v147
    v_mfma_f32_16x16x32_bf16 v[40:43], a[168:171], v[164:167], v[40:43]
    buffer_load_dwordx4 v208, s[12:15], 0 offen nt lds
    buffer_load_dwordx4 v209, s[12:15], 0 offen offset:1024 nt lds
    v_mfma_f32_16x16x32_bf16 v[12:15], a[172:175], v[160:163], v[12:15]
    s_add_u32 s12, s12, 0x2000
    v_fma_f32 v149, v149, s28, -v195
    v_fma_f32 v150, v150, s28, -v195
    v_mfma_f32_16x16x32_bf16 v[44:47], a[172:175], v[164:167], v[44:47]
    s_addc_u32 s13, s13, 0
    v_exp_f32 v148, v148
    v_mfma_f32_16x16x32_bf16 v[16:19], a[176:179], v[160:163], v[16:19]
    v_exp_f32 v149, v149
    v_mfma_f32_16x16x32_bf16 v[48:51], a[176:179], v[164:167], v[48:51]
    v_cvt_pk_bf16_f32 v169, v146, v147
    v_fma_f32 v151, v151, s28, -v195
    v_mfma_f32_16x16x32_bf16 v[20:23], a[180:183], v[160:163], v[20:23]
    v_exp_f32 v150, v150
    v_mfma_f32_16x16x32_bf16 v[52:55], a[180:183], v[164:167], v[52:55]
    v_fma_f32 v152, v152, s28, -v194
    v_cvt_pk_bf16_f32 v172, v148, v149
    v_mfma_f32_16x16x32_bf16 v[24:27], a[184:187], v[160:163], v[24:27]
    v_exp_f32 v151, v151
    v_mfma_f32_16x16x32_bf16 v[56:59], a[184:187], v[164:167], v[56:59]
    v_fma_f32 v153, v153, s28, -v194
    v_fma_f32 v154, v154, s28, -v194
    v_mfma_f32_16x16x32_bf16 v[28:31], a[188:191], v[160:163], v[28:31]
    v_exp_f32 v152, v152
    v_mfma_f32_16x16x32_bf16 v[60:63], a[188:191], v[164:167], v[60:63]
    s_waitcnt lgkmcnt(0)
    v_exp_f32 v153, v153
    v_mfma_f32_16x16x32_bf16 v[128:131], a[128:131], a[0:3], 0
    v_cvt_pk_bf16_f32 v173, v150, v151
    v_fma_f32 v155, v155, s28, -v194
    v_mfma_f32_16x16x32_bf16 v[128:131], a[132:135], a[4:7], v[128:131]
    s_add_u32 s38, s32, 0x1000
    v_exp_f32 v154, v154
    v_mfma_f32_16x16x32_bf16 v[128:131], a[136:139], a[8:11], v[128:131]
    buffer_store_dwordx4 a[220:223], v214, s[20:23], s38 offen offset:3072 sc1
    v_fma_f32 v156, v156, s28, -v195
    v_exp_f32 v155, v155
    v_mfma_f32_16x16x32_bf16 v[128:131], a[140:143], a[12:15], v[128:131]
    v_cvt_pk_bf16_f32 v170, v152, v153
    v_fma_f32 v157, v157, s28, -v195
    v_mfma_f32_16x16x32_bf16 v[132:135], a[128:131], a[16:19], 0
    v_exp_f32 v156, v156
    v_mfma_f32_16x16x32_bf16 v[132:135], a[132:135], a[20:23], v[132:135]
    v_fma_f32 v158, v158, s28, -v195
    v_cvt_pk_bf16_f32 v171, v154, v155
    v_mfma_f32_16x16x32_bf16 v[132:135], a[136:139], a[24:27], v[132:135]
    v_exp_f32 v157, v157
    v_mfma_f32_16x16x32_bf16 v[132:135], a[140:143], a[28:31], v[132:135]
    v_fma_f32 v159, v159, s28, -v195
    v_cvt_pk_bf16_f32 v174, v156, v157
    v_mfma_f32_16x16x32_bf16 v[136:139], a[144:147], a[0:3], 0
    v_exp_f32 v158, v158
    v_mfma_f32_16x16x32_bf16 v[136:139], a[148:151], a[4:7], v[136:139]
    v_exp_f32 v159, v159
    v_mfma_f32_16x16x32_bf16 v[136:139], a[152:155], a[8:11], v[136:139]
    v_cvt_pk_bf16_f32 v175, v158, v159
    v_fma_f32 v128, v128, s28, -v192
    v_mfma_f32_16x16x32_bf16 v[136:139], a[156:159], a[12:15], v[136:139]
    v_fma_f32 v129, v129, s28, -v192
    v_fma_f32 v130, v130, s28, -v192
    v_mfma_f32_16x16x32_bf16 v[140:143], a[144:147], a[16:19], 0
    v_exp_f32 v128, v128
    v_mfma_f32_16x16x32_bf16 v[140:143], a[148:151], a[20:23], v[140:143]
    v_exp_f32 v129, v129
    v_mfma_f32_16x16x32_bf16 v[140:143], a[152:155], a[24:27], v[140:143]
    v_fma_f32 v131, v131, s28, -v192
    v_fma_f32 v132, v132, s28, -v193
    v_mfma_f32_16x16x32_bf16 v[140:143], a[156:159], a[28:31], v[140:143]
    v_exp_f32 v130, v130
    v_mfma_f32_16x16x32_bf16 v[64:67], a[160:163], v[168:171], v[64:67]
    v_exp_f32 v131, v131
    v_mfma_f32_16x16x32_bf16 v[96:99], a[160:163], v[172:175], v[96:99]
    ds_read_b64_tr_b16 a[160:161], v200 offset:57344
    v_cvt_pk_bf16_f32 v160, v128, v129
    v_mfma_f32_16x16x32_bf16 v[68:71], a[164:167], v[168:171], v[68:71]
    ds_read_b64_tr_b16 a[162:163], v200 offset:61440
    v_fma_f32 v133, v133, s28, -v193
    v_mfma_f32_16x16x32_bf16 v[100:103], a[164:167], v[172:175], v[100:103]
    ds_read_b64_tr_b16 a[164:165], v201 offset:57344
    v_fma_f32 v134, v134, s28, -v193
    v_mfma_f32_16x16x32_bf16 v[184:187], v[220:223], v[168:171], v[184:187]
    ds_read_b64_tr_b16 a[166:167], v201 offset:61440
    v_cvt_pk_bf16_f32 v161, v130, v131
    v_mfma_f32_16x16x32_bf16 v[72:75], a[168:171], v[168:171], v[72:75]
    v_exp_f32 v132, v132
    v_mfma_f32_16x16x32_bf16 v[188:191], v[220:223], v[172:175], v[188:191]
    v_exp_f32 v133, v133
    v_mfma_f32_16x16x32_bf16 v[104:107], a[168:171], v[172:175], v[104:107]
    ds_read_b64_tr_b16 a[168:169], v202 offset:57344
    v_fma_f32 v135, v135, s28, -v193
    v_mfma_f32_16x16x32_bf16 v[76:79], a[172:175], v[168:171], v[76:79]
    ds_read_b64_tr_b16 a[170:171], v202 offset:61440
    v_fma_f32 v136, v136, s28, -v192
    v_mfma_f32_16x16x32_bf16 v[108:111], a[172:175], v[172:175], v[108:111]
    ds_read_b64_tr_b16 a[172:173], v203 offset:57344
    v_cvt_pk_bf16_f32 v164, v132, v133
    v_mfma_f32_16x16x32_bf16 v[80:83], a[176:179], v[168:171], v[80:83]
    ds_read_b64_tr_b16 a[174:175], v203 offset:61440
    v_fma_f32 v137, v137, s28, -v192
    v_mfma_f32_16x16x32_bf16 v[112:115], a[176:179], v[172:175], v[112:115]
    ds_read_b64_tr_b16 a[176:177], v204 offset:57344
    v_fma_f32 v138, v138, s28, -v192
    v_mfma_f32_16x16x32_bf16 v[84:87], a[180:183], v[168:171], v[84:87]
    ds_read_b64_tr_b16 a[178:179], v204 offset:61440
    v_fma_f32 v139, v139, s28, -v192
    v_mfma_f32_16x16x32_bf16 v[116:119], a[180:183], v[172:175], v[116:119]
    ds_read_b64_tr_b16 a[180:181], v205 offset:57344
    v_exp_f32 v134, v134
    v_mfma_f32_16x16x32_bf16 v[88:91], a[184:187], v[168:171], v[88:91]
    ds_read_b64_tr_b16 a[182:183], v205 offset:61440
    v_fma_f32 v140, v140, s28, -v193
    v_mfma_f32_16x16x32_bf16 v[120:123], a[184:187], v[172:175], v[120:123]
    ds_read_b64_tr_b16 a[184:185], v206 offset:57344
    v_exp_f32 v135, v135
    v_mfma_f32_16x16x32_bf16 v[92:95], a[188:191], v[168:171], v[92:95]
    ds_read_b64_tr_b16 a[186:187], v206 offset:61440
    v_cvt_pk_bf16_f32 v165, v134, v135
    v_mfma_f32_16x16x32_bf16 v[124:127], a[188:191], v[172:175], v[124:127]
    ds_read_b64_tr_b16 a[188:189], v207 offset:57344
    v_fma_f32 v141, v141, s28, -v193
    v_mfma_f32_16x16x32_bf16 v[144:147], a[128:131], a[32:35], 0
    ds_read_b64_tr_b16 a[190:191], v207 offset:61440
    v_exp_f32 v136, v136
    v_mfma_f32_16x16x32_bf16 v[144:147], a[132:135], a[36:39], v[144:147]
    s_lshl_b32 s56, s56, 1
    v_exp_f32 v137, v137
    v_mfma_f32_16x16x32_bf16 v[144:147], a[136:139], a[40:43], v[144:147]
    s_max_u32 s56, s56, 1
    v_exp_f32 v138, v138
    v_mfma_f32_16x16x32_bf16 v[144:147], a[140:143], a[44:47], v[144:147]
    s_add_u32 s33, s33, 1
    v_exp_f32 v139, v139
    v_mfma_f32_16x16x32_bf16 v[148:151], a[128:131], a[48:51], 0
    ds_read_b128 a[128:131], v196 offset:0
    v_cvt_pk_bf16_f32 v162, v136, v137
    v_mfma_f32_16x16x32_bf16 v[148:151], a[132:135], a[52:55], v[148:151]
    ds_read_b128 a[132:135], v197 offset:0
    v_fma_f32 v142, v142, s28, -v193
    v_mfma_f32_16x16x32_bf16 v[148:151], a[136:139], a[56:59], v[148:151]
    ds_read_b128 a[136:139], v198 offset:0
    v_cvt_pk_bf16_f32 v163, v138, v139
    v_mfma_f32_16x16x32_bf16 v[148:151], a[140:143], a[60:63], v[148:151]
    ds_read_b128 a[140:143], v199 offset:0
    v_fma_f32 v143, v143, s28, -v193
    v_mfma_f32_16x16x32_bf16 v[152:155], a[144:147], a[32:35], 0
    v_exp_f32 v140, v140
    v_mfma_f32_16x16x32_bf16 v[152:155], a[148:151], a[36:39], v[152:155]
    v_exp_f32 v141, v141
    v_mfma_f32_16x16x32_bf16 v[152:155], a[152:155], a[40:43], v[152:155]
    v_exp_f32 v142, v142
    v_mfma_f32_16x16x32_bf16 v[152:155], a[156:159], a[44:47], v[152:155]
    v_exp_f32 v143, v143
    v_mfma_f32_16x16x32_bf16 v[156:159], a[144:147], a[48:51], 0
    ds_read_b128 a[144:147], v196 offset:4096
    v_cvt_pk_bf16_f32 v166, v140, v141
    v_mfma_f32_16x16x32_bf16 v[156:159], a[148:151], a[52:55], v[156:159]
    ds_read_b128 a[148:151], v197 offset:4096
    v_cvt_pk_bf16_f32 v167, v142, v143
    v_mfma_f32_16x16x32_bf16 v[156:159], a[152:155], a[56:59], v[156:159]
    ds_read_b128 a[152:155], v198 offset:4096
    v_accvgpr_mov_b32 a0, a64
    v_mfma_f32_16x16x32_bf16 v[156:159], a[156:159], a[60:63], v[156:159]
    s_waitcnt lgkmcnt(7)
    ds_read_b128 a[156:159], v199 offset:4096
    v_accvgpr_mov_b32 a1, a65
    v_mfma_f32_16x16x32_bf16 v[0:3], a[160:163], v[160:163], v[0:3]
    s_waitcnt vmcnt(14)
    v_accvgpr_mov_b32 a2, a66
    v_accvgpr_mov_b32 a3, a67
    v_mfma_f32_16x16x32_bf16 v[32:35], a[160:163], v[164:167], v[32:35]
    s_add_u32 m0, s34, 0x1a000
    v_accvgpr_mov_b32 a4, a68
    v_accvgpr_mov_b32 a5, a69
    v_mfma_f32_16x16x32_bf16 v[4:7], a[164:167], v[160:163], v[4:7]
    buffer_load_dwordx4 v210, s[16:19], 0 offen nt lds
    buffer_load_dwordx4 v211, s[16:19], 0 offen offset:1024 nt lds
    v_mfma_f32_16x16x32_bf16 v[36:39], a[164:167], v[164:167], v[36:39]
    s_add_u32 s16, s16, 0x2000
    s_addc_u32 s17, s17, 0
    v_accvgpr_mov_b32 a6, a70
    v_mfma_f32_16x16x32_bf16 v[176:179], v[220:223], v[160:163], v[176:179]
    ds_read_b128 a[32:35], v244 offset:0
    v_accvgpr_mov_b32 a7, a71
    v_mfma_f32_16x16x32_bf16 v[8:11], a[168:171], v[160:163], v[8:11]
    ds_read_b128 a[36:39], v245 offset:0
    v_accvgpr_mov_b32 a8, a72
    v_mfma_f32_16x16x32_bf16 v[180:183], v[220:223], v[164:167], v[180:183]
    s_add_u32 m0, s34, 0xc000
    v_accvgpr_mov_b32 a9, a73
    v_accvgpr_mov_b32 a10, a74
    v_mfma_f32_16x16x32_bf16 v[40:43], a[168:171], v[164:167], v[40:43]
    buffer_load_dwordx4 v208, s[12:15], 0 offen nt lds
    buffer_load_dwordx4 v209, s[12:15], 0 offen offset:1024 nt lds
    v_mfma_f32_16x16x32_bf16 v[12:15], a[172:175], v[160:163], v[12:15]
    s_add_u32 s12, s12, 0x2000
    s_addc_u32 s13, s13, 0
    v_accvgpr_mov_b32 a11, a75
    v_mfma_f32_16x16x32_bf16 v[44:47], a[172:175], v[164:167], v[44:47]
    ds_read_b128 a[40:43], v246 offset:0
    v_accvgpr_mov_b32 a12, a76
    v_mfma_f32_16x16x32_bf16 v[16:19], a[176:179], v[160:163], v[16:19]
    ds_read_b128 a[44:47], v247 offset:0
    v_accvgpr_mov_b32 a13, a77
    v_mfma_f32_16x16x32_bf16 v[48:51], a[176:179], v[164:167], v[48:51]
    ds_read_b128 a[48:51], v244 offset:4096
    v_accvgpr_mov_b32 a14, a78
    v_mfma_f32_16x16x32_bf16 v[20:23], a[180:183], v[160:163], v[20:23]
    ds_read_b128 a[52:55], v245 offset:4096
    v_accvgpr_mov_b32 a15, a79
    v_mfma_f32_16x16x32_bf16 v[52:55], a[180:183], v[164:167], v[52:55]
    ds_read_b128 a[56:59], v246 offset:4096
    v_accvgpr_mov_b32 a16, a80
    v_mfma_f32_16x16x32_bf16 v[24:27], a[184:187], v[160:163], v[24:27]
    ds_read_b128 a[60:63], v247 offset:4096
    v_accvgpr_mov_b32 a17, a81
    v_mfma_f32_16x16x32_bf16 v[56:59], a[184:187], v[164:167], v[56:59]
    s_add_u32 s32, s32, s31
    v_accvgpr_mov_b32 a18, a82
    v_accvgpr_mov_b32 a19, a83
    v_mfma_f32_16x16x32_bf16 v[28:31], a[188:191], v[160:163], v[28:31]
    s_mov_b32 s31, 0x1000000
    v_accvgpr_mov_b32 a20, a84
    v_accvgpr_mov_b32 a21, a85
    v_accvgpr_mov_b32 a22, a86
    v_accvgpr_mov_b32 a23, a87
    v_accvgpr_mov_b32 a24, a88
    v_accvgpr_mov_b32 a25, a89
    v_accvgpr_mov_b32 a26, a90
    v_accvgpr_mov_b32 a27, a91
    v_accvgpr_mov_b32 a28, a92
    v_accvgpr_mov_b32 a29, a93
    v_accvgpr_mov_b32 a30, a94
    v_accvgpr_mov_b32 a31, a95
    v_mfma_f32_16x16x32_bf16 v[60:63], a[188:191], v[164:167], v[60:63]
    s_mov_b32 s22, 0x4000000
    v_rcp_f32 v232, v176
    v_rcp_f32 v234, v180
    v_pk_mul_f32 v[0:1], v[0:1], v[232:233] op_sel_hi:[1,0]
    v_pk_mul_f32 v[2:3], v[2:3], v[232:233] op_sel_hi:[1,0]
    v_pk_mul_f32 v[4:5], v[4:5], v[232:233] op_sel_hi:[1,0]
    v_pk_mul_f32 v[6:7], v[6:7], v[232:233] op_sel_hi:[1,0]
    v_pk_mul_f32 v[8:9], v[8:9], v[232:233] op_sel_hi:[1,0]
    v_pk_mul_f32 v[10:11], v[10:11], v[232:233] op_sel_hi:[1,0]
    v_pk_mul_f32 v[12:13], v[12:13], v[232:233] op_sel_hi:[1,0]
    v_pk_mul_f32 v[14:15], v[14:15], v[232:233] op_sel_hi:[1,0]
    v_pk_mul_f32 v[16:17], v[16:17], v[232:233] op_sel_hi:[1,0]
    v_pk_mul_f32 v[18:19], v[18:19], v[232:233] op_sel_hi:[1,0]
    v_pk_mul_f32 v[20:21], v[20:21], v[232:233] op_sel_hi:[1,0]
    v_pk_mul_f32 v[22:23], v[22:23], v[232:233] op_sel_hi:[1,0]
    v_pk_mul_f32 v[24:25], v[24:25], v[232:233] op_sel_hi:[1,0]
    v_pk_mul_f32 v[26:27], v[26:27], v[232:233] op_sel_hi:[1,0]
    v_pk_mul_f32 v[28:29], v[28:29], v[232:233] op_sel_hi:[1,0]
    v_pk_mul_f32 v[30:31], v[30:31], v[232:233] op_sel_hi:[1,0]
    v_cvt_pk_bf16_f32 v0, v0, v1
    v_cvt_pk_bf16_f32 v1, v2, v3
    v_cvt_pk_bf16_f32 v4, v4, v5
    v_cvt_pk_bf16_f32 v5, v6, v7
    v_cvt_pk_bf16_f32 v8, v8, v9
    v_cvt_pk_bf16_f32 v9, v10, v11
    v_cvt_pk_bf16_f32 v12, v12, v13
    v_cvt_pk_bf16_f32 v13, v14, v15
    v_cvt_pk_bf16_f32 v16, v16, v17
    v_cvt_pk_bf16_f32 v17, v18, v19
    v_cvt_pk_bf16_f32 v20, v20, v21
    v_cvt_pk_bf16_f32 v21, v22, v23
    v_cvt_pk_bf16_f32 v24, v24, v25
    v_cvt_pk_bf16_f32 v25, v26, v27
    v_cvt_pk_bf16_f32 v28, v28, v29
    v_cvt_pk_bf16_f32 v29, v30, v31
    v_pk_mul_f32 v[32:33], v[32:33], v[234:235] op_sel_hi:[1,0]
    v_pk_mul_f32 v[34:35], v[34:35], v[234:235] op_sel_hi:[1,0]
    v_pk_mul_f32 v[36:37], v[36:37], v[234:235] op_sel_hi:[1,0]
    v_pk_mul_f32 v[38:39], v[38:39], v[234:235] op_sel_hi:[1,0]
    v_pk_mul_f32 v[40:41], v[40:41], v[234:235] op_sel_hi:[1,0]
    v_pk_mul_f32 v[42:43], v[42:43], v[234:235] op_sel_hi:[1,0]
    v_pk_mul_f32 v[44:45], v[44:45], v[234:235] op_sel_hi:[1,0]
    v_pk_mul_f32 v[46:47], v[46:47], v[234:235] op_sel_hi:[1,0]
    v_pk_mul_f32 v[48:49], v[48:49], v[234:235] op_sel_hi:[1,0]
    v_pk_mul_f32 v[50:51], v[50:51], v[234:235] op_sel_hi:[1,0]
    v_pk_mul_f32 v[52:53], v[52:53], v[234:235] op_sel_hi:[1,0]
    v_pk_mul_f32 v[54:55], v[54:55], v[234:235] op_sel_hi:[1,0]
    v_pk_mul_f32 v[56:57], v[56:57], v[234:235] op_sel_hi:[1,0]
    v_pk_mul_f32 v[58:59], v[58:59], v[234:235] op_sel_hi:[1,0]
    v_pk_mul_f32 v[60:61], v[60:61], v[234:235] op_sel_hi:[1,0]
    v_pk_mul_f32 v[62:63], v[62:63], v[234:235] op_sel_hi:[1,0]
    v_cvt_pk_bf16_f32 v32, v32, v33
    v_cvt_pk_bf16_f32 v33, v34, v35
    v_cvt_pk_bf16_f32 v36, v36, v37
    v_cvt_pk_bf16_f32 v37, v38, v39
    v_cvt_pk_bf16_f32 v40, v40, v41
    v_cvt_pk_bf16_f32 v41, v42, v43
    v_cvt_pk_bf16_f32 v44, v44, v45
    v_cvt_pk_bf16_f32 v45, v46, v47
    v_cvt_pk_bf16_f32 v48, v48, v49
    v_cvt_pk_bf16_f32 v49, v50, v51
    v_cvt_pk_bf16_f32 v52, v52, v53
    v_cvt_pk_bf16_f32 v53, v54, v55
    v_cvt_pk_bf16_f32 v56, v56, v57
    v_cvt_pk_bf16_f32 v57, v58, v59
    v_cvt_pk_bf16_f32 v60, v60, v61
    v_cvt_pk_bf16_f32 v61, v62, v63
    s_cmp_lt_u32 s33, 3
    s_cbranch_scc1 L_loop
    s_waitcnt lgkmcnt(8)
    v_mfma_f32_16x16x32_bf16 v[128:131], a[128:131], a[0:3], 0
    v_fma_f32 v144, v144, s28, -v194
    v_fma_f32 v145, v145, s28, -v194
    v_mfma_f32_16x16x32_bf16 v[128:131], a[132:135], a[4:7], v[128:131]
    v_exp_f32 v144, v144
    v_mfma_f32_16x16x32_bf16 v[128:131], a[136:139], a[8:11], v[128:131]
    s_waitcnt lgkmcnt(0)
    v_fma_f32 v146, v146, s28, -v194
    v_fma_f32 v147, v147, s28, -v194
    v_mfma_f32_16x16x32_bf16 v[128:131], a[140:143], a[12:15], v[128:131]
    s_add_u32 s38, s58, 0x2000
    v_exp_f32 v145, v145
    v_mfma_f32_16x16x32_bf16 v[132:135], a[128:131], a[16:19], 0
    buffer_store_dwordx4 a[96:99], v214, s[20:23], s38 offen sc1
    ds_write_b64 v248, v[0:1] offset:0
    v_mfma_f32_16x16x32_bf16 v[132:135], a[132:135], a[20:23], v[132:135]
    v_exp_f32 v146, v146
    v_mfma_f32_16x16x32_bf16 v[132:135], a[136:139], a[24:27], v[132:135]
    ds_write_b64 v249, v[4:5] offset:0
    v_mfma_f32_16x16x32_bf16 v[132:135], a[140:143], a[28:31], v[132:135]
    v_fma_f32 v148, v148, s28, -v195
    v_cvt_pk_bf16_f32 v168, v144, v145
    v_mfma_f32_16x16x32_bf16 v[136:139], a[144:147], a[0:3], 0
    ds_write_b64 v250, v[8:9] offset:0
    v_mfma_f32_16x16x32_bf16 v[136:139], a[148:151], a[4:7], v[136:139]
    v_exp_f32 v147, v147
    v_mfma_f32_16x16x32_bf16 v[136:139], a[152:155], a[8:11], v[136:139]
    ds_write_b64 v251, v[12:13] offset:0
    v_mfma_f32_16x16x32_bf16 v[136:139], a[156:159], a[12:15], v[136:139]
    v_fma_f32 v149, v149, s28, -v195
    v_fma_f32 v150, v150, s28, -v195
    v_mfma_f32_16x16x32_bf16 v[140:143], a[144:147], a[16:19], 0
    ds_write_b64 v248, v[16:17] offset:128
    v_mfma_f32_16x16x32_bf16 v[140:143], a[148:151], a[20:23], v[140:143]
    v_exp_f32 v148, v148
    v_mfma_f32_16x16x32_bf16 v[140:143], a[152:155], a[24:27], v[140:143]
    s_waitcnt vmcnt(24)
    s_barrier
    ds_write_b64 v249, v[20:21] offset:128
    v_mfma_f32_16x16x32_bf16 v[140:143], a[156:159], a[28:31], v[140:143]
    v_exp_f32 v149, v149
    v_cvt_pk_bf16_f32 v169, v146, v147
    v_fma_f32 v152, v152, s28, -v194
    v_fma_f32 v153, v153, s28, -v194
    v_exp_f32 v152, v152
    v_fma_f32 v154, v154, s28, -v194
    v_exp_f32 v153, v153
    v_fma_f32 v155, v155, s28, -v194
    v_exp_f32 v154, v154
    v_exp_f32 v155, v155
    v_cvt_pk_bf16_f32 v170, v152, v153
    v_cvt_pk_bf16_f32 v171, v154, v155
    s_nop 1
    v_mfma_f32_16x16x32_bf16 v[64:67], a[160:163], v[168:171], v[64:67]
    ds_write_b64 v250, v[24:25] offset:128
    v_fma_f32 v151, v151, s28, -v195
    v_exp_f32 v150, v150
    v_exp_f32 v151, v151
    v_cvt_pk_bf16_f32 v172, v148, v149
    v_cvt_pk_bf16_f32 v173, v150, v151
    v_fma_f32 v156, v156, s28, -v195
    v_fma_f32 v157, v157, s28, -v195
    v_exp_f32 v156, v156
    v_fma_f32 v158, v158, s28, -v195
    v_exp_f32 v157, v157
    v_fma_f32 v159, v159, s28, -v195
    v_exp_f32 v158, v158
    v_exp_f32 v159, v159
    v_cvt_pk_bf16_f32 v174, v156, v157
    v_cvt_pk_bf16_f32 v175, v158, v159
    s_nop 1
    v_mfma_f32_16x16x32_bf16 v[96:99], a[160:163], v[172:175], v[96:99]
    ds_read_b64_tr_b16 a[160:161], v200 offset:0
    v_cmp_nlt_f32 vcc, v176, v219
    v_mfma_f32_16x16x32_bf16 v[68:71], a[164:167], v[168:171], v[68:71]
    ds_read_b64_tr_b16 a[162:163], v200 offset:4096
    ds_write_b64 v251, v[28:29] offset:128
    v_mfma_f32_16x16x32_bf16 v[100:103], a[164:167], v[172:175], v[100:103]
    ds_read_b64_tr_b16 a[164:165], v201 offset:0
    s_mov_b64 s[54:55], vcc
    v_mfma_f32_16x16x32_bf16 v[184:187], v[220:223], v[168:171], v[184:187]
    ds_read_b64_tr_b16 a[166:167], v201 offset:4096
    ds_write_b64 v248, v[32:33] offset:4096
    v_mfma_f32_16x16x32_bf16 v[72:75], a[168:171], v[168:171], v[72:75]
    v_cmp_nlt_f32 vcc, v180, v219
    v_max3_f32 v224, v128, v129, v130
    v_mfma_f32_16x16x32_bf16 v[188:191], v[220:223], v[172:175], v[188:191]
    ds_write_b64 v249, v[36:37] offset:4096
    v_mfma_f32_16x16x32_bf16 v[104:107], a[168:171], v[172:175], v[104:107]
    ds_read_b64_tr_b16 a[168:169], v202 offset:0
    v_rcp_f32 v232, v184
    v_mfma_f32_16x16x32_bf16 v[76:79], a[172:175], v[168:171], v[76:79]
    ds_read_b64_tr_b16 a[170:171], v202 offset:4096
    ds_write_b64 v250, v[40:41] offset:4096
    v_mfma_f32_16x16x32_bf16 v[108:111], a[172:175], v[172:175], v[108:111]
    ds_read_b64_tr_b16 a[172:173], v203 offset:0
    v_rcp_f32 v234, v188
    v_mfma_f32_16x16x32_bf16 v[80:83], a[176:179], v[168:171], v[80:83]
    ds_read_b64_tr_b16 a[174:175], v203 offset:4096
    ds_write_b64 v251, v[44:45] offset:4096
    v_mfma_f32_16x16x32_bf16 v[112:115], a[176:179], v[172:175], v[112:115]
    ds_read_b64_tr_b16 a[176:177], v204 offset:0
    s_or_b64 s[54:55], s[54:55], vcc
    v_mfma_f32_16x16x32_bf16 v[84:87], a[180:183], v[168:171], v[84:87]
    ds_read_b64_tr_b16 a[178:179], v204 offset:4096
    ds_write_b64 v248, v[48:49] offset:4224
    v_mfma_f32_16x16x32_bf16 v[116:119], a[180:183], v[172:175], v[116:119]
    ds_read_b64_tr_b16 a[180:181], v205 offset:0
    v_max_f32 v224, v224, v131
    v_mfma_f32_16x16x32_bf16 v[88:91], a[184:187], v[168:171], v[88:91]
    ds_read_b64_tr_b16 a[182:183], v205 offset:4096
    ds_write_b64 v249, v[52:53] offset:4224
    v_mfma_f32_16x16x32_bf16 v[120:123], a[184:187], v[172:175], v[120:123]
    ds_read_b64_tr_b16 a[184:185], v206 offset:0
    v_mul_f32 v192, s28, v224
    v_mfma_f32_16x16x32_bf16 v[92:95], a[188:191], v[168:171], v[92:95]
    ds_read_b64_tr_b16 a[186:187], v206 offset:4096
    ds_write_b64 v250, v[56:57] offset:4224
    v_mfma_f32_16x16x32_bf16 v[124:127], a[188:191], v[172:175], v[124:127]
    ds_read_b64_tr_b16 a[188:189], v207 offset:0
    v_max3_f32 v226, v132, v133, v134
    s_waitcnt lgkmcnt(15)
    v_mfma_f32_16x16x32_bf16 v[144:147], a[128:131], a[32:35], 0
    ds_read_b64_tr_b16 a[190:191], v207 offset:4096
    ds_write_b64 v251, v[60:61] offset:4224
    v_pk_mul_f32 v[64:65], v[64:65], v[232:233] op_sel_hi:[1,0]
    v_pk_mul_f32 v[66:67], v[66:67], v[232:233] op_sel_hi:[1,0]
    v_pk_mul_f32 v[68:69], v[68:69], v[232:233] op_sel_hi:[1,0]
    v_pk_mul_f32 v[70:71], v[70:71], v[232:233] op_sel_hi:[1,0]
    v_pk_mul_f32 v[72:73], v[72:73], v[232:233] op_sel_hi:[1,0]
    v_pk_mul_f32 v[74:75], v[74:75], v[232:233] op_sel_hi:[1,0]
    v_pk_mul_f32 v[76:77], v[76:77], v[232:233] op_sel_hi:[1,0]
    v_pk_mul_f32 v[78:79], v[78:79], v[232:233] op_sel_hi:[1,0]
    v_pk_mul_f32 v[80:81], v[80:81], v[232:233] op_sel_hi:[1,0]
    v_pk_mul_f32 v[82:83], v[82:83], v[232:233] op_sel_hi:[1,0]
    v_pk_mul_f32 v[84:85], v[84:85], v[232:233] op_sel_hi:[1,0]
    v_pk_mul_f32 v[86:87], v[86:87], v[232:233] op_sel_hi:[1,0]
    v_pk_mul_f32 v[88:89], v[88:89], v[232:233] op_sel_hi:[1,0]
    v_pk_mul_f32 v[90:91], v[90:91], v[232:233] op_sel_hi:[1,0]
    v_pk_mul_f32 v[92:93], v[92:93], v[232:233] op_sel_hi:[1,0]
    v_pk_mul_f32 v[94:95], v[94:95], v[232:233] op_sel_hi:[1,0]
    v_cvt_pk_bf16_f32 v64, v64, v65
    v_cvt_pk_bf16_f32 v65, v66, v67
    v_cvt_pk_bf16_f32 v68, v68, v69
    v_cvt_pk_bf16_f32 v69, v70, v71
    v_cvt_pk_bf16_f32 v72, v72, v73
    v_cvt_pk_bf16_f32 v73, v74, v75
    v_cvt_pk_bf16_f32 v76, v76, v77
    v_cvt_pk_bf16_f32 v77, v78, v79
    v_cvt_pk_bf16_f32 v80, v80, v81
    v_cvt_pk_bf16_f32 v81, v82, v83
    v_cvt_pk_bf16_f32 v84, v84, v85
    v_cvt_pk_bf16_f32 v85, v86, v87
    v_cvt_pk_bf16_f32 v88, v88, v89
    v_cvt_pk_bf16_f32 v89, v90, v91
    v_cvt_pk_bf16_f32 v92, v92, v93
    v_cvt_pk_bf16_f32 v93, v94, v95
    v_pk_mul_f32 v[96:97], v[96:97], v[234:235] op_sel_hi:[1,0]
    v_pk_mul_f32 v[98:99], v[98:99], v[234:235] op_sel_hi:[1,0]
    v_pk_mul_f32 v[100:101], v[100:101], v[234:235] op_sel_hi:[1,0]
    v_pk_mul_f32 v[102:103], v[102:103], v[234:235] op_sel_hi:[1,0]
    v_pk_mul_f32 v[104:105], v[104:105], v[234:235] op_sel_hi:[1,0]
    v_pk_mul_f32 v[106:107], v[106:107], v[234:235] op_sel_hi:[1,0]
    v_pk_mul_f32 v[108:109], v[108:109], v[234:235] op_sel_hi:[1,0]
    v_pk_mul_f32 v[110:111], v[110:111], v[234:235] op_sel_hi:[1,0]
    v_pk_mul_f32 v[112:113], v[112:113], v[234:235] op_sel_hi:[1,0]
    v_pk_mul_f32 v[114:115], v[114:115], v[234:235] op_sel_hi:[1,0]
    v_pk_mul_f32 v[116:117], v[116:117], v[234:235] op_sel_hi:[1,0]
    v_pk_mul_f32 v[118:119], v[118:119], v[234:235] op_sel_hi:[1,0]
    v_pk_mul_f32 v[120:121], v[120:121], v[234:235] op_sel_hi:[1,0]
    v_pk_mul_f32 v[122:123], v[122:123], v[234:235] op_sel_hi:[1,0]
    v_pk_mul_f32 v[124:125], v[124:125], v[234:235] op_sel_hi:[1,0]
    v_pk_mul_f32 v[126:127], v[126:127], v[234:235] op_sel_hi:[1,0]
    v_cvt_pk_bf16_f32 v96, v96, v97
    v_cvt_pk_bf16_f32 v97, v98, v99
    v_cvt_pk_bf16_f32 v100, v100, v101
    v_cvt_pk_bf16_f32 v101, v102, v103
    v_cvt_pk_bf16_f32 v104, v104, v105
    v_cvt_pk_bf16_f32 v105, v106, v107
    v_cvt_pk_bf16_f32 v108, v108, v109
    v_cvt_pk_bf16_f32 v109, v110, v111
    v_cvt_pk_bf16_f32 v112, v112, v113
    v_cvt_pk_bf16_f32 v113, v114, v115
    v_cvt_pk_bf16_f32 v116, v116, v117
    v_cvt_pk_bf16_f32 v117, v118, v119
    v_cvt_pk_bf16_f32 v120, v120, v121
    v_cvt_pk_bf16_f32 v121, v122, v123
    v_cvt_pk_bf16_f32 v124, v124, v125
    v_cvt_pk_bf16_f32 v125, v126, v127
    v_mfma_f32_16x16x32_bf16 v[144:147], a[132:135], a[36:39], v[144:147]
    v_max_f32 v226, v226, v135
    v_mul_f32 v193, s28, v226
    v_mfma_f32_16x16x32_bf16 v[144:147], a[136:139], a[40:43], v[144:147]
    v_mov_b32 v225, v192
    v_mov_b32 v227, v193
    v_mfma_f32_16x16x32_bf16 v[144:147], a[140:143], a[44:47], v[144:147]
    s_waitcnt lgkmcnt(0)
    ds_read_b128 a[192:195], v212 offset:0
    v_permlane16_swap_b32 v192, v225
    v_mfma_f32_16x16x32_bf16 v[148:151], a[128:131], a[48:51], 0
    ds_read_b128 a[128:131], v196 offset:8192
    ds_read_b128 a[196:199], v213 offset:1024
    v_mfma_f32_16x16x32_bf16 v[148:151], a[132:135], a[52:55], v[148:151]
    ds_read_b128 a[132:135], v197 offset:8192
    ds_read_b128 a[200:203], v212 offset:2048
    v_mfma_f32_16x16x32_bf16 v[148:151], a[136:139], a[56:59], v[148:151]
    ds_read_b128 a[136:139], v198 offset:8192
    ds_read_b128 a[204:207], v213 offset:3072
    v_mfma_f32_16x16x32_bf16 v[148:151], a[140:143], a[60:63], v[148:151]
    ds_read_b128 a[140:143], v199 offset:8192
    ds_read_b128 a[208:211], v212 offset:4096
    v_mfma_f32_16x16x32_bf16 v[152:155], a[144:147], a[32:35], 0
    ds_read_b128 a[212:215], v213 offset:5120
    v_mov_b32 v225, v192
    v_mfma_f32_16x16x32_bf16 v[152:155], a[148:151], a[36:39], v[152:155]
    ds_read_b128 a[216:219], v212 offset:6144
    v_permlane16_swap_b32 v193, v227
    v_mfma_f32_16x16x32_bf16 v[152:155], a[152:155], a[40:43], v[152:155]
    ds_read_b128 a[220:223], v213 offset:7168
    v_mov_b32 v227, v193
    v_mfma_f32_16x16x32_bf16 v[152:155], a[156:159], a[44:47], v[152:155]
    v_permlane32_swap_b32 v192, v225
    v_mfma_f32_16x16x32_bf16 v[156:159], a[144:147], a[48:51], 0
    ds_read_b128 a[144:147], v196 offset:12288
    v_fma_f32 v128, v128, s28, -v192
    v_mfma_f32_16x16x32_bf16 v[156:159], a[148:151], a[52:55], v[156:159]
    ds_read_b128 a[148:151], v197 offset:12288
    v_fma_f32 v129, v129, s28, -v192
    v_mfma_f32_16x16x32_bf16 v[156:159], a[152:155], a[56:59], v[156:159]
    ds_read_b128 a[152:155], v198 offset:12288
    s_waitcnt lgkmcnt(3)
    v_mfma_f32_16x16x32_bf16 v[156:159], a[156:159], a[60:63], v[156:159]
    s_waitcnt lgkmcnt(15)
    ds_read_b128 a[156:159], v199 offset:12288
    v_fma_f32 v130, v130, s28, -v192
    v_exp_f32 v128, v128
    v_exp_f32 v129, v129
    v_fma_f32 v131, v131, s28, -v192
    v_exp_f32 v130, v130
    v_exp_f32 v131, v131
    v_cvt_pk_bf16_f32 v160, v128, v129
    v_cvt_pk_bf16_f32 v161, v130, v131
    v_fma_f32 v136, v136, s28, -v192
    v_fma_f32 v137, v137, s28, -v192
    v_exp_f32 v136, v136
    v_fma_f32 v138, v138, s28, -v192
    v_exp_f32 v137, v137
    v_fma_f32 v139, v139, s28, -v192
    v_exp_f32 v138, v138
    v_exp_f32 v139, v139
    v_cvt_pk_bf16_f32 v162, v136, v137
    v_cvt_pk_bf16_f32 v163, v138, v139
    s_nop 1
    v_mfma_f32_16x16x32_bf16 v[0:3], a[160:163], v[160:163], 0
    ds_write_b64 v248, v[64:65] offset:0
    v_permlane32_swap_b32 v193, v227
    v_fma_f32 v132, v132, s28, -v193
    v_fma_f32 v133, v133, s28, -v193
    v_exp_f32 v132, v132
    v_fma_f32 v134, v134, s28, -v193
    v_exp_f32 v133, v133
    v_fma_f32 v135, v135, s28, -v193
    v_exp_f32 v134, v134
    v_exp_f32 v135, v135
    v_cvt_pk_bf16_f32 v164, v132, v133
    v_cvt_pk_bf16_f32 v165, v134, v135
    v_fma_f32 v140, v140, s28, -v193
    v_fma_f32 v141, v141, s28, -v193
    v_exp_f32 v140, v140
    v_fma_f32 v142, v142, s28, -v193
    v_exp_f32 v141, v141
    v_fma_f32 v143, v143, s28, -v193
    v_exp_f32 v142, v142
    v_exp_f32 v143, v143
    v_cvt_pk_bf16_f32 v166, v140, v141
    v_cvt_pk_bf16_f32 v167, v142, v143
    s_nop 1
    v_mfma_f32_16x16x32_bf16 v[32:35], a[160:163], v[164:167], 0
    s_add_u32 m0, s34, 0x1c000
    v_cmp_nlt_f32 vcc, v184, v219
    v_max3_f32 v228, v144, v145, v146
    v_mfma_f32_16x16x32_bf16 v[4:7], a[164:167], v[160:163], 0
    buffer_load_dwordx4 v210, s[16:19], 0 offen nt lds
    buffer_load_dwordx4 v211, s[16:19], 0 offen offset:1024 nt lds
    v_mfma_f32_16x16x32_bf16 v[36:39], a[164:167], v[164:167], 0
    s_add_u32 s16, s16, 0x2000
    s_addc_u32 s17, s17, 0
    ds_write_b64 v249, v[68:69] offset:0
    v_mfma_f32_16x16x32_bf16 v[176:179], v[220:223], v[160:163], 0
    s_or_b64 s[54:55], s[54:55], vcc
    v_cmp_nlt_f32 vcc, v188, v219
    v_mfma_f32_16x16x32_bf16 v[8:11], a[168:171], v[160:163], 0
    ds_write_b64 v250, v[72:73] offset:0
    v_mfma_f32_16x16x32_bf16 v[180:183], v[220:223], v[164:167], 0
    s_add_u32 m0, s34, 0xe000
    s_or_b64 s[54:55], s[54:55], vcc
    v_max_f32 v228, v228, v147
    v_mfma_f32_16x16x32_bf16 v[40:43], a[168:171], v[164:167], 0
    buffer_load_dwordx4 v208, s[12:15], 0 offen nt lds
    buffer_load_dwordx4 v209, s[12:15], 0 offen offset:1024 nt lds
    v_mfma_f32_16x16x32_bf16 v[12:15], a[172:175], v[160:163], 0
    s_add_u32 s12, s12, 0x2000
    s_addc_u32 s13, s13, 0
    ds_write_b64 v251, v[76:77] offset:0
    v_mfma_f32_16x16x32_bf16 v[44:47], a[172:175], v[164:167], 0
    v_mul_f32 v194, s28, v228
    v_max3_f32 v230, v148, v149, v150
    v_mfma_f32_16x16x32_bf16 v[16:19], a[176:179], v[160:163], 0
    ds_write_b64 v248, v[80:81] offset:128
    v_mfma_f32_16x16x32_bf16 v[48:51], a[176:179], v[164:167], 0
    s_add_u32 s38, s58, 0x2000
    v_max_f32 v230, v230, v151
    v_mul_f32 v195, s28, v230
    v_mfma_f32_16x16x32_bf16 v[20:23], a[180:183], v[160:163], 0
    buffer_store_dwordx4 a[100:103], v214, s[20:23], s38 offen offset:1024 sc1
    ds_write_b64 v249, v[84:85] offset:128
    v_mfma_f32_16x16x32_bf16 v[52:55], a[180:183], v[164:167], 0
    v_mov_b32 v229, v194
    v_mov_b32 v231, v195
    v_mfma_f32_16x16x32_bf16 v[24:27], a[184:187], v[160:163], 0
    ds_write_b64 v250, v[88:89] offset:128
    v_mfma_f32_16x16x32_bf16 v[56:59], a[184:187], v[164:167], 0
    v_permlane16_swap_b32 v194, v229
    v_mfma_f32_16x16x32_bf16 v[28:31], a[188:191], v[160:163], 0
    ds_write_b64 v251, v[92:93] offset:128
    v_mfma_f32_16x16x32_bf16 v[60:63], a[188:191], v[164:167], 0
    s_waitcnt lgkmcnt(8)
    v_permlane16_swap_b32 v195, v231
    v_mfma_f32_16x16x32_bf16 v[128:131], a[128:131], a[0:3], 0
    ds_write_b64 v248, v[96:97] offset:4096
    v_mfma_f32_16x16x32_bf16 v[128:131], a[132:135], a[4:7], v[128:131]
    v_mov_b32 v229, v194
    v_mov_b32 v231, v195
    v_mfma_f32_16x16x32_bf16 v[128:131], a[136:139], a[8:11], v[128:131]
    ds_write_b64 v249, v[100:101] offset:4096
    v_mfma_f32_16x16x32_bf16 v[128:131], a[140:143], a[12:15], v[128:131]
    s_add_u32 s38, s58, 0x2000
    v_permlane32_swap_b32 v194, v229
    v_mfma_f32_16x16x32_bf16 v[132:135], a[128:131], a[16:19], 0
    buffer_store_dwordx4 a[104:107], v214, s[20:23], s38 offen offset:2048 sc1
    ds_write_b64 v250, v[104:105] offset:4096
    v_mfma_f32_16x16x32_bf16 v[132:135], a[132:135], a[20:23], v[132:135]
    v_permlane32_swap_b32 v195, v231
    v_mfma_f32_16x16x32_bf16 v[132:135], a[136:139], a[24:27], v[132:135]
    ds_write_b64 v251, v[108:109] offset:4096
    v_mfma_f32_16x16x32_bf16 v[132:135], a[140:143], a[28:31], v[132:135]
    v_fma_f32 v144, v144, s28, -v194
    v_fma_f32 v145, v145, s28, -v194
    v_mfma_f32_16x16x32_bf16 v[136:139], a[144:147], a[0:3], 0
    ds_write_b64 v248, v[112:113] offset:4224
    v_mfma_f32_16x16x32_bf16 v[136:139], a[148:151], a[4:7], v[136:139]
    v_exp_f32 v144, v144
    v_mfma_f32_16x16x32_bf16 v[136:139], a[152:155], a[8:11], v[136:139]
    ds_write_b64 v249, v[116:117] offset:4224
    v_mfma_f32_16x16x32_bf16 v[136:139], a[156:159], a[12:15], v[136:139]
    v_fma_f32 v146, v146, s28, -v194
    v_fma_f32 v147, v147, s28, -v194
    v_mfma_f32_16x16x32_bf16 v[140:143], a[144:147], a[16:19], 0
    ds_write_b64 v250, v[120:121] offset:4224
    v_mfma_f32_16x16x32_bf16 v[140:143], a[148:151], a[20:23], v[140:143]
    v_exp_f32 v145, v145
    v_mfma_f32_16x16x32_bf16 v[140:143], a[152:155], a[24:27], v[140:143]
    ds_write_b64 v251, v[124:125] offset:4224
    v_mfma_f32_16x16x32_bf16 v[140:143], a[156:159], a[28:31], v[140:143]
    v_exp_f32 v146, v146
    v_exp_f32 v147, v147
    v_cvt_pk_bf16_f32 v168, v144, v145
    v_cvt_pk_bf16_f32 v169, v146, v147
    v_fma_f32 v152, v152, s28, -v194
    v_fma_f32 v153, v153, s28, -v194
    v_exp_f32 v152, v152
    v_fma_f32 v154, v154, s28, -v194
    v_exp_f32 v153, v153
    v_fma_f32 v155, v155, s28, -v194
    v_exp_f32 v154, v154
    v_exp_f32 v155, v155
    v_cvt_pk_bf16_f32 v170, v152, v153
    v_cvt_pk_bf16_f32 v171, v154, v155
    s_nop 1
    v_mfma_f32_16x16x32_bf16 v[64:67], a[160:163], v[168:171], 0
    v_fma_f32 v148, v148, s28, -v195
    v_fma_f32 v149, v149, s28, -v195
    v_exp_f32 v148, v148
    v_fma_f32 v150, v150, s28, -v195
    v_exp_f32 v149, v149
    v_fma_f32 v151, v151, s28, -v195
    v_exp_f32 v150, v150
    v_exp_f32 v151, v151
    v_cvt_pk_bf16_f32 v172, v148, v149
    v_cvt_pk_bf16_f32 v173, v150, v151
    v_fma_f32 v156, v156, s28, -v195
    v_fma_f32 v157, v157, s28, -v195
    v_exp_f32 v156, v156
    v_fma_f32 v158, v158, s28, -v195
    v_exp_f32 v157, v157
    v_fma_f32 v159, v159, s28, -v195
    v_exp_f32 v158, v158
    v_exp_f32 v159, v159
    v_cvt_pk_bf16_f32 v174, v156, v157
    v_cvt_pk_bf16_f32 v175, v158, v159
    s_nop 1
    v_mfma_f32_16x16x32_bf16 v[96:99], a[160:163], v[172:175], 0
    ds_read_b64_tr_b16 a[160:161], v200 offset:8192
    s_waitcnt lgkmcnt(1)
    v_mfma_f32_16x16x32_bf16 v[68:71], a[164:167], v[168:171], 0
    ds_read_b64_tr_b16 a[162:163], v200 offset:12288
    ds_read_b128 a[64:67], v212 offset:0
    v_mfma_f32_16x16x32_bf16 v[100:103], a[164:167], v[172:175], 0
    ds_read_b64_tr_b16 a[164:165], v201 offset:8192
    ds_read_b128 a[68:71], v213 offset:1024
    v_mfma_f32_16x16x32_bf16 v[184:187], v[220:223], v[168:171], 0
    ds_read_b64_tr_b16 a[166:167], v201 offset:12288
    ds_read_b128 a[72:75], v212 offset:2048
    v_mfma_f32_16x16x32_bf16 v[72:75], a[168:171], v[168:171], 0
    ds_read_b128 a[76:79], v213 offset:3072
    v_fma_f32 v128, v128, s28, -v192
    v_mfma_f32_16x16x32_bf16 v[188:191], v[220:223], v[172:175], 0
    ds_read_b128 a[80:83], v212 offset:4096
    v_fma_f32 v129, v129, s28, -v192
    v_mfma_f32_16x16x32_bf16 v[104:107], a[168:171], v[172:175], 0
    ds_read_b64_tr_b16 a[168:169], v202 offset:8192
    ds_read_b128 a[84:87], v213 offset:5120
    v_mfma_f32_16x16x32_bf16 v[76:79], a[172:175], v[168:171], 0
    ds_read_b64_tr_b16 a[170:171], v202 offset:12288
    ds_read_b128 a[88:91], v212 offset:6144
    v_mfma_f32_16x16x32_bf16 v[108:111], a[172:175], v[172:175], 0
    ds_read_b64_tr_b16 a[172:173], v203 offset:8192
    ds_read_b128 a[92:95], v213 offset:7168
    v_mfma_f32_16x16x32_bf16 v[80:83], a[176:179], v[168:171], 0
    ds_read_b64_tr_b16 a[174:175], v203 offset:12288
    v_fma_f32 v130, v130, s28, -v192
    v_mfma_f32_16x16x32_bf16 v[112:115], a[176:179], v[172:175], 0
    ds_read_b64_tr_b16 a[176:177], v204 offset:8192
    v_fma_f32 v131, v131, s28, -v192
    v_mfma_f32_16x16x32_bf16 v[84:87], a[180:183], v[168:171], 0
    ds_read_b64_tr_b16 a[178:179], v204 offset:12288
    v_fma_f32 v132, v132, s28, -v193
    v_mfma_f32_16x16x32_bf16 v[116:119], a[180:183], v[172:175], 0
    ds_read_b64_tr_b16 a[180:181], v205 offset:8192
    s_cmp_lg_u64 s[54:55], 0
    s_cselect_b32 s54, s56, 0
    s_or_b32 s39, s39, s54
    v_mfma_f32_16x16x32_bf16 v[88:91], a[184:187], v[168:171], 0
    ds_read_b64_tr_b16 a[182:183], v205 offset:12288
    v_fma_f32 v133, v133, s28, -v193
    v_mfma_f32_16x16x32_bf16 v[120:123], a[184:187], v[172:175], 0
    ds_read_b64_tr_b16 a[184:185], v206 offset:8192
    v_exp_f32 v128, v128
    v_mfma_f32_16x16x32_bf16 v[92:95], a[188:191], v[168:171], 0
    ds_read_b64_tr_b16 a[186:187], v206 offset:12288
    v_fma_f32 v134, v134, s28, -v193
    v_mfma_f32_16x16x32_bf16 v[124:127], a[188:191], v[172:175], 0
    ds_read_b64_tr_b16 a[188:189], v207 offset:8192
    v_exp_f32 v129, v129
    v_mfma_f32_16x16x32_bf16 v[144:147], a[128:131], a[32:35], 0
    ds_read_b64_tr_b16 a[190:191], v207 offset:12288
    v_cvt_pk_bf16_f32 v160, v128, v129
    v_mfma_f32_16x16x32_bf16 v[144:147], a[132:135], a[36:39], v[144:147]
    v_exp_f32 v130, v130
    v_mfma_f32_16x16x32_bf16 v[144:147], a[136:139], a[40:43], v[144:147]
    v_exp_f32 v131, v131
    v_mfma_f32_16x16x32_bf16 v[144:147], a[140:143], a[44:47], v[144:147]
    v_exp_f32 v132, v132
    v_mfma_f32_16x16x32_bf16 v[148:151], a[128:131], a[48:51], 0
    ds_read_b128 a[128:131], v196 offset:16384
    v_cvt_pk_bf16_f32 v161, v130, v131
    v_mfma_f32_16x16x32_bf16 v[148:151], a[132:135], a[52:55], v[148:151]
    ds_read_b128 a[132:135], v197 offset:16384
    v_fma_f32 v135, v135, s28, -v193
    v_mfma_f32_16x16x32_bf16 v[148:151], a[136:139], a[56:59], v[148:151]
    ds_read_b128 a[136:139], v198 offset:16384
    v_fma_f32 v136, v136, s28, -v192
    v_mfma_f32_16x16x32_bf16 v[148:151], a[140:143], a[60:63], v[148:151]
    ds_read_b128 a[140:143], v199 offset:16384
    v_fma_f32 v137, v137, s28, -v192
    v_mfma_f32_16x16x32_bf16 v[152:155], a[144:147], a[32:35], 0
    v_exp_f32 v133, v133
    v_mfma_f32_16x16x32_bf16 v[152:155], a[148:151], a[36:39], v[152:155]
    v_exp_f32 v134, v134
    v_mfma_f32_16x16x32_bf16 v[152:155], a[152:155], a[40:43], v[152:155]
    v_exp_f32 v135, v135
    v_mfma_f32_16x16x32_bf16 v[152:155], a[156:159], a[44:47], v[152:155]
    v_cvt_pk_bf16_f32 v164, v132, v133
    v_fma_f32 v138, v138, s28, -v192
    v_mfma_f32_16x16x32_bf16 v[156:159], a[144:147], a[48:51], 0
    ds_read_b128 a[144:147], v196 offset:20480
    v_cvt_pk_bf16_f32 v165, v134, v135
    v_mfma_f32_16x16x32_bf16 v[156:159], a[148:151], a[52:55], v[156:159]
    ds_read_b128 a[148:151], v197 offset:20480
    v_fma_f32 v139, v139, s28, -v192
    v_mfma_f32_16x16x32_bf16 v[156:159], a[152:155], a[56:59], v[156:159]
    ds_read_b128 a[152:155], v198 offset:20480
    v_fma_f32 v140, v140, s28, -v193
    v_mfma_f32_16x16x32_bf16 v[156:159], a[156:159], a[60:63], v[156:159]
    s_waitcnt lgkmcnt(7)
    ds_read_b128 a[156:159], v199 offset:20480
    v_fma_f32 v141, v141, s28, -v193
    v_exp_f32 v136, v136
    v_exp_f32 v137, v137
    v_exp_f32 v138, v138
    v_exp_f32 v139, v139
    v_cvt_pk_bf16_f32 v162, v136, v137
    v_cvt_pk_bf16_f32 v163, v138, v139
    s_nop 1
    v_mfma_f32_16x16x32_bf16 v[0:3], a[160:163], v[160:163], v[0:3]
    v_exp_f32 v140, v140
    v_fma_f32 v142, v142, s28, -v193
    v_exp_f32 v141, v141
    v_fma_f32 v143, v143, s28, -v193
    v_exp_f32 v142, v142
    v_exp_f32 v143, v143
    v_cvt_pk_bf16_f32 v166, v140, v141
    v_cvt_pk_bf16_f32 v167, v142, v143
    s_nop 1
    v_mfma_f32_16x16x32_bf16 v[32:35], a[160:163], v[164:167], v[32:35]
    s_add_u32 m0, s34, 0x1e000
    v_fma_f32 v144, v144, s28, -v194
    v_fma_f32 v145, v145, s28, -v194
    v_mfma_f32_16x16x32_bf16 v[4:7], a[164:167], v[160:163], v[4:7]
    buffer_load_dwordx4 v210, s[16:19], 0 offen nt lds
    buffer_load_dwordx4 v211, s[16:19], 0 offen offset:1024 nt lds
    v_mfma_f32_16x16x32_bf16 v[36:39], a[164:167], v[164:167], v[36:39]
    s_add_u32 s16, s16, 0x2000
    s_addc_u32 s17, s17, 0
    v_fma_f32 v146, v146, s28, -v194
    v_mfma_f32_16x16x32_bf16 v[176:179], v[220:223], v[160:163], v[176:179]
    v_exp_f32 v144, v144
    v_mfma_f32_16x16x32_bf16 v[8:11], a[168:171], v[160:163], v[8:11]
    v_exp_f32 v145, v145
    v_mfma_f32_16x16x32_bf16 v[180:183], v[220:223], v[164:167], v[180:183]
    s_add_u32 m0, s34, 0
    v_fma_f32 v147, v147, s28, -v194
    v_fma_f32 v148, v148, s28, -v195
    v_mfma_f32_16x16x32_bf16 v[40:43], a[168:171], v[164:167], v[40:43]
    buffer_load_dwordx4 v208, s[12:15], 0 offen nt lds
    buffer_load_dwordx4 v209, s[12:15], 0 offen offset:1024 nt lds
    v_mfma_f32_16x16x32_bf16 v[12:15], a[172:175], v[160:163], v[12:15]
    s_add_u32 s12, s12, 0x2000
    s_addc_u32 s13, s13, 0
    v_cvt_pk_bf16_f32 v168, v144, v145
    v_mfma_f32_16x16x32_bf16 v[44:47], a[172:175], v[164:167], v[44:47]
    v_exp_f32 v146, v146
    v_mfma_f32_16x16x32_bf16 v[16:19], a[176:179], v[160:163], v[16:19]
    v_exp_f32 v147, v147
    v_mfma_f32_16x16x32_bf16 v[48:51], a[176:179], v[164:167], v[48:51]
    s_add_u32 s38, s58, 0x2000
    v_fma_f32 v149, v149, s28, -v195
    v_fma_f32 v150, v150, s28, -v195
    v_mfma_f32_16x16x32_bf16 v[20:23], a[180:183], v[160:163], v[20:23]
    buffer_store_dwordx4 a[108:111], v214, s[20:23], s38 offen offset:3072 sc1
    v_exp_f32 v148, v148
    v_cvt_pk_bf16_f32 v169, v146, v147
    v_mfma_f32_16x16x32_bf16 v[52:55], a[180:183], v[164:167], v[52:55]
    v_exp_f32 v149, v149
    v_mfma_f32_16x16x32_bf16 v[24:27], a[184:187], v[160:163], v[24:27]
    v_fma_f32 v151, v151, s28, -v195
    v_fma_f32 v152, v152, s28, -v194
    v_mfma_f32_16x16x32_bf16 v[56:59], a[184:187], v[164:167], v[56:59]
    v_exp_f32 v150, v150
    v_mfma_f32_16x16x32_bf16 v[28:31], a[188:191], v[160:163], v[28:31]
    v_exp_f32 v151, v151
    v_mfma_f32_16x16x32_bf16 v[60:63], a[188:191], v[164:167], v[60:63]
    s_waitcnt lgkmcnt(0)
    v_cvt_pk_bf16_f32 v172, v148, v149
    v_fma_f32 v153, v153, s28, -v194
    v_mfma_f32_16x16x32_bf16 v[128:131], a[128:131], a[0:3], 0
    v_exp_f32 v152, v152
    v_mfma_f32_16x16x32_bf16 v[128:131], a[132:135], a[4:7], v[128:131]
    v_fma_f32 v154, v154, s28, -v194
    v_cvt_pk_bf16_f32 v173, v150, v151
    v_mfma_f32_16x16x32_bf16 v[128:131], a[136:139], a[8:11], v[128:131]
    v_exp_f32 v153, v153
    v_mfma_f32_16x16x32_bf16 v[128:131], a[140:143], a[12:15], v[128:131]
    s_add_u32 s38, s58, 0x3000
    v_fma_f32 v155, v155, s28, -v194
    v_fma_f32 v156, v156, s28, -v195
    v_mfma_f32_16x16x32_bf16 v[132:135], a[128:131], a[16:19], 0
    buffer_store_dwordx4 a[112:115], v214, s[20:23], s38 offen sc1
    v_exp_f32 v154, v154
    v_cvt_pk_bf16_f32 v170, v152, v153
    v_mfma_f32_16x16x32_bf16 v[132:135], a[132:135], a[20:23], v[132:135]
    v_exp_f32 v155, v155
    v_mfma_f32_16x16x32_bf16 v[132:135], a[136:139], a[24:27], v[132:135]
    v_fma_f32 v157, v157, s28, -v195
    v_fma_f32 v158, v158, s28, -v195
    v_mfma_f32_16x16x32_bf16 v[132:135], a[140:143], a[28:31], v[132:135]
    v_exp_f32 v156, v156
    v_mfma_f32_16x16x32_bf16 v[136:139], a[144:147], a[0:3], 0
    v_exp_f32 v157, v157
    v_mfma_f32_16x16x32_bf16 v[136:139], a[148:151], a[4:7], v[136:139]
    v_cvt_pk_bf16_f32 v171, v154, v155
    v_fma_f32 v159, v159, s28, -v195
    v_mfma_f32_16x16x32_bf16 v[136:139], a[152:155], a[8:11], v[136:139]
    v_exp_f32 v158, v158
    v_mfma_f32_16x16x32_bf16 v[136:139], a[156:159], a[12:15], v[136:139]
    v_exp_f32 v159, v159
    v_mfma_f32_16x16x32_bf16 v[140:143], a[144:147], a[16:19], 0
    v_cvt_pk_bf16_f32 v174, v156, v157
    v_cvt_pk_bf16_f32 v175, v158, v159
    v_mfma_f32_16x16x32_bf16 v[140:143], a[148:151], a[20:23], v[140:143]
    v_fma_f32 v128, v128, s28, -v192
    v_fma_f32 v129, v129, s28, -v192
    v_mfma_f32_16x16x32_bf16 v[140:143], a[152:155], a[24:27], v[140:143]
    s_waitcnt vmcnt(23)
    s_barrier
    v_exp_f32 v128, v128
    v_mfma_f32_16x16x32_bf16 v[140:143], a[156:159], a[28:31], v[140:143]
    v_fma_f32 v130, v130, s28, -v192
    v_fma_f32 v131, v131, s28, -v192
    v_mfma_f32_16x16x32_bf16 v[64:67], a[160:163], v[168:171], v[64:67]
    v_exp_f32 v129, v129
    v_mfma_f32_16x16x32_bf16 v[96:99], a[160:163], v[172:175], v[96:99]
    ds_read_b64_tr_b16 a[160:161], v200 offset:16384
    v_fma_f32 v132, v132, s28, -v193
    v_mfma_f32_16x16x32_bf16 v[68:71], a[164:167], v[168:171], v[68:71]
    ds_read_b64_tr_b16 a[162:163], v200 offset:20480
    v_cvt_pk_bf16_f32 v160, v128, v129
    v_mfma_f32_16x16x32_bf16 v[100:103], a[164:167], v[172:175], v[100:103]
    ds_read_b64_tr_b16 a[164:165], v201 offset:16384
    v_fma_f32 v133, v133, s28, -v193
    v_mfma_f32_16x16x32_bf16 v[184:187], v[220:223], v[168:171], v[184:187]
    ds_read_b64_tr_b16 a[166:167], v201 offset:20480
    v_fma_f32 v134, v134, s28, -v193
    v_mfma_f32_16x16x32_bf16 v[72:75], a[168:171], v[168:171], v[72:75]
    v_exp_f32 v130, v130
    v_mfma_f32_16x16x32_bf16 v[188:191], v[220:223], v[172:175], v[188:191]
    v_exp_f32 v131, v131
    v_mfma_f32_16x16x32_bf16 v[104:107], a[168:171], v[172:175], v[104:107]
    ds_read_b64_tr_b16 a[168:169], v202 offset:16384
    v_cvt_pk_bf16_f32 v161, v130, v131
    v_mfma_f32_16x16x32_bf16 v[76:79], a[172:175], v[168:171], v[76:79]
    ds_read_b64_tr_b16 a[170:171], v202 offset:20480
    v_fma_f32 v135, v135, s28, -v193
    v_mfma_f32_16x16x32_bf16 v[108:111], a[172:175], v[172:175], v[108:111]
    ds_read_b64_tr_b16 a[172:173], v203 offset:16384
    v_fma_f32 v136, v136, s28, -v192
    v_mfma_f32_16x16x32_bf16 v[80:83], a[176:179], v[168:171], v[80:83]
    ds_read_b64_tr_b16 a[174:175], v203 offset:20480
    v_fma_f32 v137, v137, s28, -v192
    v_mfma_f32_16x16x32_bf16 v[112:115], a[176:179], v[172:175], v[112:115]
    ds_read_b64_tr_b16 a[176:177], v204 offset:16384
    v_exp_f32 v132, v132
    v_mfma_f32_16x16x32_bf16 v[84:87], a[180:183], v[168:171], v[84:87]
    ds_read_b64_tr_b16 a[178:179], v204 offset:20480
    v_fma_f32 v138, v138, s28, -v192
    v_mfma_f32_16x16x32_bf16 v[116:119], a[180:183], v[172:175], v[116:119]
    ds_read_b64_tr_b16 a[180:181], v205 offset:16384
    v_exp_f32 v133, v133
    v_mfma_f32_16x16x32_bf16 v[88:91], a[184:187], v[168:171], v[88:91]
    ds_read_b64_tr_b16 a[182:183], v205 offset:20480
    v_cvt_pk_bf16_f32 v164, v132, v133
    v_mfma_f32_16x16x32_bf16 v[120:123], a[184:187], v[172:175], v[120:123]
    ds_read_b64_tr_b16 a[184:185], v206 offset:16384
    v_fma_f32 v139, v139, s28, -v192
    v_mfma_f32_16x16x32_bf16 v[92:95], a[188:191], v[168:171], v[92:95]
    ds_read_b64_tr_b16 a[186:187], v206 offset:20480
    v_exp_f32 v134, v134
    v_mfma_f32_16x16x32_bf16 v[124:127], a[188:191], v[172:175], v[124:127]
    ds_read_b64_tr_b16 a[188:189], v207 offset:16384
    v_fma_f32 v140, v140, s28, -v193
    v_mfma_f32_16x16x32_bf16 v[144:147], a[128:131], a[32:35], 0
    ds_read_b64_tr_b16 a[190:191], v207 offset:20480
    v_exp_f32 v135, v135
    v_mfma_f32_16x16x32_bf16 v[144:147], a[132:135], a[36:39], v[144:147]
    v_exp_f32 v136, v136
    v_mfma_f32_16x16x32_bf16 v[144:147], a[136:139], a[40:43], v[144:147]
    v_exp_f32 v137, v137
    v_mfma_f32_16x16x32_bf16 v[144:147], a[140:143], a[44:47], v[144:147]
    v_cvt_pk_bf16_f32 v165, v134, v135
    v_cvt_pk_bf16_f32 v162, v136, v137
    v_mfma_f32_16x16x32_bf16 v[148:151], a[128:131], a[48:51], 0
    ds_read_b128 a[128:131], v196 offset:24576
    v_fma_f32 v141, v141, s28, -v193
    v_mfma_f32_16x16x32_bf16 v[148:151], a[132:135], a[52:55], v[148:151]
    ds_read_b128 a[132:135], v197 offset:24576
    v_fma_f32 v142, v142, s28, -v193
    v_mfma_f32_16x16x32_bf16 v[148:151], a[136:139], a[56:59], v[148:151]
    ds_read_b128 a[136:139], v198 offset:24576
    v_fma_f32 v143, v143, s28, -v193
    v_mfma_f32_16x16x32_bf16 v[148:151], a[140:143], a[60:63], v[148:151]
    ds_read_b128 a[140:143], v199 offset:24576
    v_exp_f32 v138, v138
    v_mfma_f32_16x16x32_bf16 v[152:155], a[144:147], a[32:35], 0
    v_exp_f32 v139, v139
    v_mfma_f32_16x16x32_bf16 v[152:155], a[148:151], a[36:39], v[152:155]
    v_exp_f32 v140, v140
    v_mfma_f32_16x16x32_bf16 v[152:155], a[152:155], a[40:43], v[152:155]
    v_exp_f32 v141, v141
    v_mfma_f32_16x16x32_bf16 v[152:155], a[156:159], a[44:47], v[152:155]
    v_cvt_pk_bf16_f32 v163, v138, v139
    v_cvt_pk_bf16_f32 v166, v140, v141
    v_mfma_f32_16x16x32_bf16 v[156:159], a[144:147], a[48:51], 0
    ds_read_b128 a[144:147], v196 offset:28672
    v_fma_f32 v144, v144, s28, -v194
    v_mfma_f32_16x16x32_bf16 v[156:159], a[148:151], a[52:55], v[156:159]
    ds_read_b128 a[148:151], v197 offset:28672
    v_fma_f32 v145, v145, s28, -v194
    v_mfma_f32_16x16x32_bf16 v[156:159], a[152:155], a[56:59], v[156:159]
    ds_read_b128 a[152:155], v198 offset:28672
    v_fma_f32 v146, v146, s28, -v194
    v_mfma_f32_16x16x32_bf16 v[156:159], a[156:159], a[60:63], v[156:159]
    s_waitcnt lgkmcnt(7)
    ds_read_b128 a[156:159], v199 offset:28672
    v_fma_f32 v147, v147, s28, -v194
    v_mfma_f32_16x16x32_bf16 v[0:3], a[160:163], v[160:163], v[0:3]
    v_exp_f32 v142, v142
    v_exp_f32 v143, v143
    s_nop 0
    v_cvt_pk_bf16_f32 v167, v142, v143
    s_nop 1
    v_mfma_f32_16x16x32_bf16 v[32:35], a[160:163], v[164:167], v[32:35]
    s_add_u32 m0, s34, 0x10000
    v_exp_f32 v144, v144
    v_mfma_f32_16x16x32_bf16 v[4:7], a[164:167], v[160:163], v[4:7]
    buffer_load_dwordx4 v210, s[16:19], 0 offen nt lds
    buffer_load_dwordx4 v211, s[16:19], 0 offen offset:1024 nt lds
    v_mfma_f32_16x16x32_bf16 v[36:39], a[164:167], v[164:167], v[36:39]
    s_add_u32 s16, s16, 0x2000
    v_exp_f32 v145, v145
    v_mfma_f32_16x16x32_bf16 v[176:179], v[220:223], v[160:163], v[176:179]
    s_addc_u32 s17, s17, 0
    v_exp_f32 v146, v146
    v_mfma_f32_16x16x32_bf16 v[8:11], a[168:171], v[160:163], v[8:11]
    v_fma_f32 v148, v148, s28, -v195
    v_cvt_pk_bf16_f32 v168, v144, v145
    v_mfma_f32_16x16x32_bf16 v[180:183], v[220:223], v[164:167], v[180:183]
    s_add_u32 m0, s34, 0x2000
    v_exp_f32 v147, v147
    v_mfma_f32_16x16x32_bf16 v[40:43], a[168:171], v[164:167], v[40:43]
    buffer_load_dwordx4 v208, s[12:15], 0 offen nt lds
    buffer_load_dwordx4 v209, s[12:15], 0 offen offset:1024 nt lds
    v_mfma_f32_16x16x32_bf16 v[12:15], a[172:175], v[160:163], v[12:15]
    s_add_u32 s12, s12, 0x2000
    v_fma_f32 v149, v149, s28, -v195
    v_fma_f32 v150, v150, s28, -v195
    v_mfma_f32_16x16x32_bf16 v[44:47], a[172:175], v[164:167], v[44:47]
    s_addc_u32 s13, s13, 0
    v_exp_f32 v148, v148
    v_mfma_f32_16x16x32_bf16 v[16:19], a[176:179], v[160:163], v[16:19]
    v_exp_f32 v149, v149
    v_mfma_f32_16x16x32_bf16 v[48:51], a[176:179], v[164:167], v[48:51]
    s_add_u32 s38, s58, 0x3000
    v_cvt_pk_bf16_f32 v169, v146, v147
    v_fma_f32 v151, v151, s28, -v195
    v_mfma_f32_16x16x32_bf16 v[20:23], a[180:183], v[160:163], v[20:23]
    buffer_store_dwordx4 a[116:119], v214, s[20:23], s38 offen offset:1024 sc1
    v_exp_f32 v150, v150
    v_fma_f32 v152, v152, s28, -v194
    v_mfma_f32_16x16x32_bf16 v[52:55], a[180:183], v[164:167], v[52:55]
    v_exp_f32 v151, v151
    v_mfma_f32_16x16x32_bf16 v[24:27], a[184:187], v[160:163], v[24:27]
    v_cvt_pk_bf16_f32 v172, v148, v149
    v_fma_f32 v153, v153, s28, -v194
    v_mfma_f32_16x16x32_bf16 v[56:59], a[184:187], v[164:167], v[56:59]
    v_exp_f32 v152, v152
    v_mfma_f32_16x16x32_bf16 v[28:31], a[188:191], v[160:163], v[28:31]
    v_fma_f32 v154, v154, s28, -v194
    v_cvt_pk_bf16_f32 v173, v150, v151
    v_mfma_f32_16x16x32_bf16 v[60:63], a[188:191], v[164:167], v[60:63]
    s_waitcnt lgkmcnt(0)
    v_exp_f32 v153, v153
    v_mfma_f32_16x16x32_bf16 v[128:131], a[128:131], a[0:3], 0
    v_fma_f32 v155, v155, s28, -v194
    v_fma_f32 v156, v156, s28, -v195
    v_mfma_f32_16x16x32_bf16 v[128:131], a[132:135], a[4:7], v[128:131]
    s_add_u32 s38, s58, 0x3000
    v_exp_f32 v154, v154
    v_mfma_f32_16x16x32_bf16 v[128:131], a[136:139], a[8:11], v[128:131]
    buffer_store_dwordx4 a[120:123], v214, s[20:23], s38 offen offset:2048 sc1
    v_exp_f32 v155, v155
    v_cvt_pk_bf16_f32 v170, v152, v153
    v_mfma_f32_16x16x32_bf16 v[128:131], a[140:143], a[12:15], v[128:131]
    v_fma_f32 v157, v157, s28, -v195
    v_fma_f32 v158, v158, s28, -v195
    v_mfma_f32_16x16x32_bf16 v[132:135], a[128:131], a[16:19], 0
    v_exp_f32 v156, v156
    v_mfma_f32_16x16x32_bf16 v[132:135], a[132:135], a[20:23], v[132:135]
    v_exp_f32 v157, v157
    v_mfma_f32_16x16x32_bf16 v[132:135], a[136:139], a[24:27], v[132:135]
    v_cvt_pk_bf16_f32 v171, v154, v155
    v_fma_f32 v159, v159, s28, -v195
    v_mfma_f32_16x16x32_bf16 v[132:135], a[140:143], a[28:31], v[132:135]
    v_exp_f32 v158, v158
    v_mfma_f32_16x16x32_bf16 v[136:139], a[144:147], a[0:3], 0
    s_add_u32 s38, s58, 0x3000
    v_exp_f32 v159, v159
    v_mfma_f32_16x16x32_bf16 v[136:139], a[148:151], a[4:7], v[136:139]
    buffer_store_dwordx4 a[124:127], v214, s[20:23], s38 offen offset:3072 sc1
    v_cvt_pk_bf16_f32 v174, v156, v157
    v_cvt_pk_bf16_f32 v175, v158, v159
    v_fma_f32 v128, v128, s28, -v192
    v_mfma_f32_16x16x32_bf16 v[136:139], a[152:155], a[8:11], v[136:139]
    v_fma_f32 v129, v129, s28, -v192
    v_fma_f32 v130, v130, s28, -v192
    v_mfma_f32_16x16x32_bf16 v[136:139], a[156:159], a[12:15], v[136:139]
    v_exp_f32 v128, v128
    v_mfma_f32_16x16x32_bf16 v[140:143], a[144:147], a[16:19], 0
    v_exp_f32 v129, v129
    v_mfma_f32_16x16x32_bf16 v[140:143], a[148:151], a[20:23], v[140:143]
    v_fma_f32 v131, v131, s28, -v192
    v_fma_f32 v132, v132, s28, -v193
    v_mfma_f32_16x16x32_bf16 v[140:143], a[152:155], a[24:27], v[140:143]
    v_exp_f32 v130, v130
    v_mfma_f32_16x16x32_bf16 v[140:143], a[156:159], a[28:31], v[140:143]
    v_exp_f32 v131, v131
    v_mfma_f32_16x16x32_bf16 v[64:67], a[160:163], v[168:171], v[64:67]
    v_cvt_pk_bf16_f32 v160, v128, v129
    v_fma_f32 v133, v133, s28, -v193
    v_mfma_f32_16x16x32_bf16 v[96:99], a[160:163], v[172:175], v[96:99]
    ds_read_b64_tr_b16 a[160:161], v200 offset:24576
    v_fma_f32 v134, v134, s28, -v193
    v_mfma_f32_16x16x32_bf16 v[68:71], a[164:167], v[168:171], v[68:71]
    ds_read_b64_tr_b16 a[162:163], v200 offset:28672
    v_cvt_pk_bf16_f32 v161, v130, v131
    v_mfma_f32_16x16x32_bf16 v[100:103], a[164:167], v[172:175], v[100:103]
    ds_read_b64_tr_b16 a[164:165], v201 offset:24576
    v_fma_f32 v135, v135, s28, -v193
    v_mfma_f32_16x16x32_bf16 v[184:187], v[220:223], v[168:171], v[184:187]
    ds_read_b64_tr_b16 a[166:167], v201 offset:28672
    v_fma_f32 v136, v136, s28, -v192
    v_mfma_f32_16x16x32_bf16 v[72:75], a[168:171], v[168:171], v[72:75]
    v_exp_f32 v132, v132
    v_mfma_f32_16x16x32_bf16 v[188:191], v[220:223], v[172:175], v[188:191]
    v_exp_f32 v133, v133
    v_mfma_f32_16x16x32_bf16 v[104:107], a[168:171], v[172:175], v[104:107]
    ds_read_b64_tr_b16 a[168:169], v202 offset:24576
    v_cvt_pk_bf16_f32 v164, v132, v133
    v_mfma_f32_16x16x32_bf16 v[76:79], a[172:175], v[168:171], v[76:79]
    ds_read_b64_tr_b16 a[170:171], v202 offset:28672
    v_fma_f32 v137, v137, s28, -v192
    v_mfma_f32_16x16x32_bf16 v[108:111], a[172:175], v[172:175], v[108:111]
    ds_read_b64_tr_b16 a[172:173], v203 offset:24576
    v_fma_f32 v138, v138, s28, -v192
    v_mfma_f32_16x16x32_bf16 v[80:83], a[176:179], v[168:171], v[80:83]
    ds_read_b64_tr_b16 a[174:175], v203 offset:28672
    v_fma_f32 v139, v139, s28, -v192
    v_mfma_f32_16x16x32_bf16 v[112:115], a[176:179], v[172:175], v[112:115]
    ds_read_b64_tr_b16 a[176:177], v204 offset:24576
    v_exp_f32 v134, v134
    v_mfma_f32_16x16x32_bf16 v[84:87], a[180:183], v[168:171], v[84:87]
    ds_read_b64_tr_b16 a[178:179], v204 offset:28672
    v_fma_f32 v140, v140, s28, -v193
    v_mfma_f32_16x16x32_bf16 v[116:119], a[180:183], v[172:175], v[116:119]
    ds_read_b64_tr_b16 a[180:181], v205 offset:24576
    v_exp_f32 v135, v135
    v_mfma_f32_16x16x32_bf16 v[88:91], a[184:187], v[168:171], v[88:91]
    ds_read_b64_tr_b16 a[182:183], v205 offset:28672
    v_cvt_pk_bf16_f32 v165, v134, v135
    v_mfma_f32_16x16x32_bf16 v[120:123], a[184:187], v[172:175], v[120:123]
    ds_read_b64_tr_b16 a[184:185], v206 offset:24576
    v_fma_f32 v141, v141, s28, -v193
    v_mfma_f32_16x16x32_bf16 v[92:95], a[188:191], v[168:171], v[92:95]
    ds_read_b64_tr_b16 a[186:187], v206 offset:28672
    v_exp_f32 v136, v136
    v_mfma_f32_16x16x32_bf16 v[124:127], a[188:191], v[172:175], v[124:127]
    ds_read_b64_tr_b16 a[188:189], v207 offset:24576
    v_fma_f32 v142, v142, s28, -v193
    v_mfma_f32_16x16x32_bf16 v[144:147], a[128:131], a[32:35], 0
    ds_read_b64_tr_b16 a[190:191], v207 offset:28672
    v_exp_f32 v137, v137
    v_mfma_f32_16x16x32_bf16 v[144:147], a[132:135], a[36:39], v[144:147]
    v_exp_f32 v138, v138
    v_mfma_f32_16x16x32_bf16 v[144:147], a[136:139], a[40:43], v[144:147]
    v_exp_f32 v139, v139
    v_mfma_f32_16x16x32_bf16 v[144:147], a[140:143], a[44:47], v[144:147]
    v_cvt_pk_bf16_f32 v162, v136, v137
    v_cvt_pk_bf16_f32 v163, v138, v139
    v_mfma_f32_16x16x32_bf16 v[148:151], a[128:131], a[48:51], 0
    ds_read_b128 a[128:131], v196 offset:32768
    v_fma_f32 v143, v143, s28, -v193
    v_mfma_f32_16x16x32_bf16 v[148:151], a[132:135], a[52:55], v[148:151]
    ds_read_b128 a[132:135], v197 offset:32768
    v_exp_f32 v140, v140
    v_mfma_f32_16x16x32_bf16 v[148:151], a[136:139], a[56:59], v[148:151]
    ds_read_b128 a[136:139], v198 offset:32768
    v_fma_f32 v144, v144, s28, -v194
    v_mfma_f32_16x16x32_bf16 v[148:151], a[140:143], a[60:63], v[148:151]
    ds_read_b128 a[140:143], v199 offset:32768
    v_fma_f32 v145, v145, s28, -v194
    v_mfma_f32_16x16x32_bf16 v[152:155], a[144:147], a[32:35], 0
    v_exp_f32 v141, v141
    v_mfma_f32_16x16x32_bf16 v[152:155], a[148:151], a[36:39], v[152:155]
    v_exp_f32 v142, v142
    v_mfma_f32_16x16x32_bf16 v[152:155], a[152:155], a[40:43], v[152:155]
    v_exp_f32 v143, v143
    v_mfma_f32_16x16x32_bf16 v[152:155], a[156:159], a[44:47], v[152:155]
    v_cvt_pk_bf16_f32 v166, v140, v141
    v_cvt_pk_bf16_f32 v167, v142, v143
    v_mfma_f32_16x16x32_bf16 v[156:159], a[144:147], a[48:51], 0
    ds_read_b128 a[144:147], v196 offset:36864
    v_fma_f32 v146, v146, s28, -v194
    v_mfma_f32_16x16x32_bf16 v[156:159], a[148:151], a[52:55], v[156:159]
    ds_read_b128 a[148:151], v197 offset:36864
    v_fma_f32 v147, v147, s28, -v194
    v_mfma_f32_16x16x32_bf16 v[156:159], a[152:155], a[56:59], v[156:159]
    ds_read_b128 a[152:155], v198 offset:36864
    v_fma_f32 v148, v148, s28, -v195
    v_mfma_f32_16x16x32_bf16 v[156:159], a[156:159], a[60:63], v[156:159]
    s_waitcnt lgkmcnt(7)
    ds_read_b128 a[156:159], v199 offset:36864
    v_fma_f32 v149, v149, s28, -v195
    v_mfma_f32_16x16x32_bf16 v[0:3], a[160:163], v[160:163], v[0:3]
    v_exp_f32 v144, v144
    v_mfma_f32_16x16x32_bf16 v[32:35], a[160:163], v[164:167], v[32:35]
    s_add_u32 m0, s34, 0x12000
    v_exp_f32 v145, v145
    v_mfma_f32_16x16x32_bf16 v[4:7], a[164:167], v[160:163], v[4:7]
    buffer_load_dwordx4 v210, s[16:19], 0 offen nt lds
    buffer_load_dwordx4 v211, s[16:19], 0 offen offset:1024 nt lds
    v_mfma_f32_16x16x32_bf16 v[36:39], a[164:167], v[164:167], v[36:39]
    s_add_u32 s16, s16, 0x2000
    v_exp_f32 v146, v146
    v_mfma_f32_16x16x32_bf16 v[176:179], v[220:223], v[160:163], v[176:179]
    s_addc_u32 s17, s17, 0
    v_exp_f32 v147, v147
    v_mfma_f32_16x16x32_bf16 v[8:11], a[168:171], v[160:163], v[8:11]
    v_cvt_pk_bf16_f32 v168, v144, v145
    v_fma_f32 v150, v150, s28, -v195
    v_mfma_f32_16x16x32_bf16 v[180:183], v[220:223], v[164:167], v[180:183]
    s_add_u32 m0, s34, 0x4000
    v_exp_f32 v148, v148
    v_mfma_f32_16x16x32_bf16 v[40:43], a[168:171], v[164:167], v[40:43]
    buffer_load_dwordx4 v208, s[12:15], 0 offen nt lds
    buffer_load_dwordx4 v209, s[12:15], 0 offen offset:1024 nt lds
    v_mfma_f32_16x16x32_bf16 v[12:15], a[172:175], v[160:163], v[12:15]
    s_add_u32 s12, s12, 0x2000
    v_exp_f32 v149, v149
    v_mfma_f32_16x16x32_bf16 v[44:47], a[172:175], v[164:167], v[44:47]
    s_addc_u32 s13, s13, 0
    v_cvt_pk_bf16_f32 v169, v146, v147
    v_fma_f32 v151, v151, s28, -v195
    v_mfma_f32_16x16x32_bf16 v[16:19], a[176:179], v[160:163], v[16:19]
    v_exp_f32 v150, v150
    v_mfma_f32_16x16x32_bf16 v[48:51], a[176:179], v[164:167], v[48:51]
    v_fma_f32 v152, v152, s28, -v194
    v_cvt_pk_bf16_f32 v172, v148, v149
    v_mfma_f32_16x16x32_bf16 v[20:23], a[180:183], v[160:163], v[20:23]
    s_add_u32 s38, s58, 0x1002000
    v_exp_f32 v151, v151
    v_mfma_f32_16x16x32_bf16 v[52:55], a[180:183], v[164:167], v[52:55]
    buffer_store_dwordx4 a[224:227], v214, s[20:23], s38 offen sc1
    v_fma_f32 v153, v153, s28, -v194
    v_exp_f32 v152, v152
    v_mfma_f32_16x16x32_bf16 v[24:27], a[184:187], v[160:163], v[24:27]
    v_fma_f32 v154, v154, s28, -v194
    v_cvt_pk_bf16_f32 v173, v150, v151
    v_mfma_f32_16x16x32_bf16 v[56:59], a[184:187], v[164:167], v[56:59]
    v_exp_f32 v153, v153
    v_mfma_f32_16x16x32_bf16 v[28:31], a[188:191], v[160:163], v[28:31]
    v_fma_f32 v155, v155, s28, -v194
    v_fma_f32 v156, v156, s28, -v195
    v_mfma_f32_16x16x32_bf16 v[60:63], a[188:191], v[164:167], v[60:63]
    s_waitcnt lgkmcnt(0)
    v_exp_f32 v154, v154
    v_mfma_f32_16x16x32_bf16 v[128:131], a[128:131], a[0:3], 0
    v_exp_f32 v155, v155
    v_mfma_f32_16x16x32_bf16 v[128:131], a[132:135], a[4:7], v[128:131]
    v_cvt_pk_bf16_f32 v170, v152, v153
    v_fma_f32 v157, v157, s28, -v195
    v_mfma_f32_16x16x32_bf16 v[128:131], a[136:139], a[8:11], v[128:131]
    v_exp_f32 v156, v156
    v_mfma_f32_16x16x32_bf16 v[128:131], a[140:143], a[12:15], v[128:131]
    s_add_u32 s38, s58, 0x1002000
    v_fma_f32 v158, v158, s28, -v195
    v_cvt_pk_bf16_f32 v171, v154, v155
    v_mfma_f32_16x16x32_bf16 v[132:135], a[128:131], a[16:19], 0
    buffer_store_dwordx4 a[228:231], v214, s[20:23], s38 offen offset:1024 sc1
    v_exp_f32 v157, v157
    v_fma_f32 v159, v159, s28, -v195
    v_mfma_f32_16x16x32_bf16 v[132:135], a[132:135], a[20:23], v[132:135]
    v_exp_f32 v158, v158
    v_mfma_f32_16x16x32_bf16 v[132:135], a[136:139], a[24:27], v[132:135]
    v_exp_f32 v159, v159
    v_mfma_f32_16x16x32_bf16 v[132:135], a[140:143], a[28:31], v[132:135]
    v_cvt_pk_bf16_f32 v174, v156, v157
    v_cvt_pk_bf16_f32 v175, v158, v159
    v_mfma_f32_16x16x32_bf16 v[136:139], a[144:147], a[0:3], 0
    v_fma_f32 v128, v128, s28, -v192
    v_fma_f32 v129, v129, s28, -v192
    v_mfma_f32_16x16x32_bf16 v[136:139], a[148:151], a[4:7], v[136:139]
    v_exp_f32 v128, v128
    v_mfma_f32_16x16x32_bf16 v[136:139], a[152:155], a[8:11], v[136:139]
    v_fma_f32 v130, v130, s28, -v192
    v_fma_f32 v131, v131, s28, -v192
    v_mfma_f32_16x16x32_bf16 v[136:139], a[156:159], a[12:15], v[136:139]
    v_exp_f32 v129, v129
    v_mfma_f32_16x16x32_bf16 v[140:143], a[144:147], a[16:19], 0
    v_exp_f32 v130, v130
    v_mfma_f32_16x16x32_bf16 v[140:143], a[148:151], a[20:23], v[140:143]
    v_fma_f32 v132, v132, s28, -v193
    v_cvt_pk_bf16_f32 v160, v128, v129
    v_mfma_f32_16x16x32_bf16 v[140:143], a[152:155], a[24:27], v[140:143]
    s_waitcnt vmcnt(26)
    s_barrier
    v_exp_f32 v131, v131
    v_mfma_f32_16x16x32_bf16 v[140:143], a[156:159], a[28:31], v[140:143]
    v_fma_f32 v133, v133, s28, -v193
    v_fma_f32 v134, v134, s28, -v193
    v_mfma_f32_16x16x32_bf16 v[64:67], a[160:163], v[168:171], v[64:67]
    v_exp_f32 v132, v132
    v_mfma_f32_16x16x32_bf16 v[96:99], a[160:163], v[172:175], v[96:99]
    ds_read_b64_tr_b16 a[160:161], v200 offset:32768
    v_cvt_pk_bf16_f32 v161, v130, v131
    v_mfma_f32_16x16x32_bf16 v[68:71], a[164:167], v[168:171], v[68:71]
    ds_read_b64_tr_b16 a[162:163], v200 offset:36864
    v_fma_f32 v135, v135, s28, -v193
    v_mfma_f32_16x16x32_bf16 v[100:103], a[164:167], v[172:175], v[100:103]
    ds_read_b64_tr_b16 a[164:165], v201 offset:32768
    v_fma_f32 v136, v136, s28, -v192
    v_mfma_f32_16x16x32_bf16 v[184:187], v[220:223], v[168:171], v[184:187]
    ds_read_b64_tr_b16 a[166:167], v201 offset:36864
    v_fma_f32 v137, v137, s28, -v192
    v_mfma_f32_16x16x32_bf16 v[72:75], a[168:171], v[168:171], v[72:75]
    v_exp_f32 v133, v133
    v_mfma_f32_16x16x32_bf16 v[188:191], v[220:223], v[172:175], v[188:191]
    v_exp_f32 v134, v134
    v_mfma_f32_16x16x32_bf16 v[104:107], a[168:171], v[172:175], v[104:107]
    ds_read_b64_tr_b16 a[168:169], v202 offset:32768
    v_cvt_pk_bf16_f32 v164, v132, v133
    v_mfma_f32_16x16x32_bf16 v[76:79], a[172:175], v[168:171], v[76:79]
    ds_read_b64_tr_b16 a[170:171], v202 offset:36864
    v_fma_f32 v138, v138, s28, -v192
    v_mfma_f32_16x16x32_bf16 v[108:111], a[172:175], v[172:175], v[108:111]
    ds_read_b64_tr_b16 a[172:173], v203 offset:32768
    v_fma_f32 v139, v139, s28, -v192
    v_mfma_f32_16x16x32_bf16 v[80:83], a[176:179], v[168:171], v[80:83]
    ds_read_b64_tr_b16 a[174:175], v203 offset:36864
    v_fma_f32 v140, v140, s28, -v193
    v_mfma_f32_16x16x32_bf16 v[112:115], a[176:179], v[172:175], v[112:115]
    ds_read_b64_tr_b16 a[176:177], v204 offset:32768
    v_exp_f32 v135, v135
    v_mfma_f32_16x16x32_bf16 v[84:87], a[180:183], v[168:171], v[84:87]
    ds_read_b64_tr_b16 a[178:179], v204 offset:36864
    v_cvt_pk_bf16_f32 v165, v134, v135
    v_mfma_f32_16x16x32_bf16 v[116:119], a[180:183], v[172:175], v[116:119]
    ds_read_b64_tr_b16 a[180:181], v205 offset:32768
    v_fma_f32 v141, v141, s28, -v193
    v_mfma_f32_16x16x32_bf16 v[88:91], a[184:187], v[168:171], v[88:91]
    ds_read_b64_tr_b16 a[182:183], v205 offset:36864
    v_exp_f32 v136, v136
    v_mfma_f32_16x16x32_bf16 v[120:123], a[184:187], v[172:175], v[120:123]
    ds_read_b64_tr_b16 a[184:185], v206 offset:32768
    v_fma_f32 v142, v142, s28, -v193
    v_mfma_f32_16x16x32_bf16 v[92:95], a[188:191], v[168:171], v[92:95]
    ds_read_b64_tr_b16 a[186:187], v206 offset:36864
    v_exp_f32 v137, v137
    v_mfma_f32_16x16x32_bf16 v[124:127], a[188:191], v[172:175], v[124:127]
    ds_read_b64_tr_b16 a[188:189], v207 offset:32768
    v_cvt_pk_bf16_f32 v162, v136, v137
    v_mfma_f32_16x16x32_bf16 v[144:147], a[128:131], a[32:35], 0
    ds_read_b64_tr_b16 a[190:191], v207 offset:36864
    v_fma_f32 v143, v143, s28, -v193
    v_mfma_f32_16x16x32_bf16 v[144:147], a[132:135], a[36:39], v[144:147]
    v_exp_f32 v138, v138
    v_mfma_f32_16x16x32_bf16 v[144:147], a[136:139], a[40:43], v[144:147]
    v_exp_f32 v139, v139
    v_mfma_f32_16x16x32_bf16 v[144:147], a[140:143], a[44:47], v[144:147]
    v_exp_f32 v140, v140
    v_mfma_f32_16x16x32_bf16 v[148:151], a[128:131], a[48:51], 0
    ds_read_b128 a[128:131], v196 offset:40960
    v_cvt_pk_bf16_f32 v163, v138, v139
    v_mfma_f32_16x16x32_bf16 v[148:151], a[132:135], a[52:55], v[148:151]
    ds_read_b128 a[132:135], v197 offset:40960
    v_exp_f32 v141, v141
    v_mfma_f32_16x16x32_bf16 v[148:151], a[136:139], a[56:59], v[148:151]
    ds_read_b128 a[136:139], v198 offset:40960
    v_cvt_pk_bf16_f32 v166, v140, v141
    v_mfma_f32_16x16x32_bf16 v[148:151], a[140:143], a[60:63], v[148:151]
    ds_read_b128 a[140:143], v199 offset:40960
    v_fma_f32 v144, v144, s28, -v194
    v_mfma_f32_16x16x32_bf16 v[152:155], a[144:147], a[32:35], 0
    v_exp_f32 v142, v142
    v_mfma_f32_16x16x32_bf16 v[152:155], a[148:151], a[36:39], v[152:155]
    v_exp_f32 v143, v143
    v_mfma_f32_16x16x32_bf16 v[152:155], a[152:155], a[40:43], v[152:155]
    v_cvt_pk_bf16_f32 v167, v142, v143
    v_fma_f32 v145, v145, s28, -v194
    v_mfma_f32_16x16x32_bf16 v[152:155], a[156:159], a[44:47], v[152:155]
    v_exp_f32 v144, v144
    v_mfma_f32_16x16x32_bf16 v[156:159], a[144:147], a[48:51], 0
    ds_read_b128 a[144:147], v196 offset:45056
    v_fma_f32 v146, v146, s28, -v194
    v_mfma_f32_16x16x32_bf16 v[156:159], a[148:151], a[52:55], v[156:159]
    ds_read_b128 a[148:151], v197 offset:45056
    v_fma_f32 v147, v147, s28, -v194
    v_mfma_f32_16x16x32_bf16 v[156:159], a[152:155], a[56:59], v[156:159]
    ds_read_b128 a[152:155], v198 offset:45056
    v_fma_f32 v148, v148, s28, -v195
    v_mfma_f32_16x16x32_bf16 v[156:159], a[156:159], a[60:63], v[156:159]
    s_waitcnt lgkmcnt(7)
    ds_read_b128 a[156:159], v199 offset:45056
    v_fma_f32 v149, v149, s28, -v195
    v_mfma_f32_16x16x32_bf16 v[0:3], a[160:163], v[160:163], v[0:3]
    v_exp_f32 v145, v145
    v_mfma_f32_16x16x32_bf16 v[32:35], a[160:163], v[164:167], v[32:35]
    s_add_u32 m0, s34, 0x14000
    v_exp_f32 v146, v146
    v_mfma_f32_16x16x32_bf16 v[4:7], a[164:167], v[160:163], v[4:7]
    buffer_load_dwordx4 v210, s[16:19], 0 offen nt lds
    buffer_load_dwordx4 v211, s[16:19], 0 offen offset:1024 nt lds
    v_mfma_f32_16x16x32_bf16 v[36:39], a[164:167], v[164:167], v[36:39]
    s_add_u32 s16, s16, 0x2000
    v_exp_f32 v147, v147
    v_mfma_f32_16x16x32_bf16 v[176:179], v[220:223], v[160:163], v[176:179]
    s_addc_u32 s17, s17, 0
    v_cvt_pk_bf16_f32 v168, v144, v145
    v_fma_f32 v150, v150, s28, -v195
    v_mfma_f32_16x16x32_bf16 v[8:11], a[168:171], v[160:163], v[8:11]
    v_exp_f32 v148, v148
    v_mfma_f32_16x16x32_bf16 v[180:183], v[220:223], v[164:167], v[180:183]
    s_add_u32 m0, s34, 0x6000
    v_exp_f32 v149, v149
    v_mfma_f32_16x16x32_bf16 v[40:43], a[168:171], v[164:167], v[40:43]
    buffer_load_dwordx4 v208, s[12:15], 0 offen nt lds
    buffer_load_dwordx4 v209, s[12:15], 0 offen offset:1024 nt lds
    v_mfma_f32_16x16x32_bf16 v[12:15], a[172:175], v[160:163], v[12:15]
    s_add_u32 s12, s12, 0x2000
    v_cvt_pk_bf16_f32 v169, v146, v147
    v_fma_f32 v151, v151, s28, -v195
    v_mfma_f32_16x16x32_bf16 v[44:47], a[172:175], v[164:167], v[44:47]
    s_addc_u32 s13, s13, 0
    v_exp_f32 v150, v150
    v_mfma_f32_16x16x32_bf16 v[16:19], a[176:179], v[160:163], v[16:19]
    v_fma_f32 v152, v152, s28, -v194
    v_cvt_pk_bf16_f32 v172, v148, v149
    v_mfma_f32_16x16x32_bf16 v[48:51], a[176:179], v[164:167], v[48:51]
    s_add_u32 s38, s58, 0x1002000
    v_exp_f32 v151, v151
    v_mfma_f32_16x16x32_bf16 v[20:23], a[180:183], v[160:163], v[20:23]
    buffer_store_dwordx4 a[232:235], v214, s[20:23], s38 offen offset:2048 sc1
    v_fma_f32 v153, v153, s28, -v194
    v_exp_f32 v152, v152
    v_mfma_f32_16x16x32_bf16 v[52:55], a[180:183], v[164:167], v[52:55]
    v_fma_f32 v154, v154, s28, -v194
    v_cvt_pk_bf16_f32 v173, v150, v151
    v_mfma_f32_16x16x32_bf16 v[24:27], a[184:187], v[160:163], v[24:27]
    v_exp_f32 v153, v153
    v_mfma_f32_16x16x32_bf16 v[56:59], a[184:187], v[164:167], v[56:59]
    v_fma_f32 v155, v155, s28, -v194
    v_fma_f32 v156, v156, s28, -v195
    v_mfma_f32_16x16x32_bf16 v[28:31], a[188:191], v[160:163], v[28:31]
    v_exp_f32 v154, v154
    v_mfma_f32_16x16x32_bf16 v[60:63], a[188:191], v[164:167], v[60:63]
    s_waitcnt lgkmcnt(0)
    v_exp_f32 v155, v155
    v_mfma_f32_16x16x32_bf16 v[128:131], a[128:131], a[0:3], 0
    v_cvt_pk_bf16_f32 v170, v152, v153
    v_fma_f32 v157, v157, s28, -v195
    v_mfma_f32_16x16x32_bf16 v[128:131], a[132:135], a[4:7], v[128:131]
    v_exp_f32 v156, v156
    v_mfma_f32_16x16x32_bf16 v[128:131], a[136:139], a[8:11], v[128:131]
    v_fma_f32 v158, v158, s28, -v195
    v_cvt_pk_bf16_f32 v171, v154, v155
    v_mfma_f32_16x16x32_bf16 v[128:131], a[140:143], a[12:15], v[128:131]
    s_add_u32 s38, s58, 0x1002000
    v_exp_f32 v157, v157
    v_mfma_f32_16x16x32_bf16 v[132:135], a[128:131], a[16:19], 0
    buffer_store_dwordx4 a[236:239], v214, s[20:23], s38 offen offset:3072 sc1
    v_fma_f32 v159, v159, s28, -v195
    v_exp_f32 v158, v158
    v_mfma_f32_16x16x32_bf16 v[132:135], a[132:135], a[20:23], v[132:135]
    v_exp_f32 v159, v159
    v_mfma_f32_16x16x32_bf16 v[132:135], a[136:139], a[24:27], v[132:135]
    v_cvt_pk_bf16_f32 v174, v156, v157
    v_cvt_pk_bf16_f32 v175, v158, v159
    v_mfma_f32_16x16x32_bf16 v[132:135], a[140:143], a[28:31], v[132:135]
    v_fma_f32 v128, v128, s28, -v192
    v_fma_f32 v129, v129, s28, -v192
    v_mfma_f32_16x16x32_bf16 v[136:139], a[144:147], a[0:3], 0
    v_exp_f32 v128, v128
    v_mfma_f32_16x16x32_bf16 v[136:139], a[148:151], a[4:7], v[136:139]
    v_fma_f32 v130, v130, s28, -v192
    v_fma_f32 v131, v131, s28, -v192
    v_mfma_f32_16x16x32_bf16 v[136:139], a[152:155], a[8:11], v[136:139]
    v_exp_f32 v129, v129
    v_mfma_f32_16x16x32_bf16 v[136:139], a[156:159], a[12:15], v[136:139]
    v_exp_f32 v130, v130
    v_mfma_f32_16x16x32_bf16 v[140:143], a[144:147], a[16:19], 0
    v_fma_f32 v132, v132, s28, -v193
    v_cvt_pk_bf16_f32 v160, v128, v129
    v_mfma_f32_16x16x32_bf16 v[140:143], a[148:151], a[20:23], v[140:143]
    v_exp_f32 v131, v131
    v_mfma_f32_16x16x32_bf16 v[140:143], a[152:155], a[24:27], v[140:143]
    v_fma_f32 v133, v133, s28, -v193
    v_fma_f32 v134, v134, s28, -v193
    v_mfma_f32_16x16x32_bf16 v[140:143], a[156:159], a[28:31], v[140:143]
    v_exp_f32 v132, v132
    v_mfma_f32_16x16x32_bf16 v[64:67], a[160:163], v[168:171], v[64:67]
    v_exp_f32 v133, v133
    v_mfma_f32_16x16x32_bf16 v[96:99], a[160:163], v[172:175], v[96:99]
    ds_read_b64_tr_b16 a[160:161], v200 offset:40960
    v_cvt_pk_bf16_f32 v161, v130, v131
    v_mfma_f32_16x16x32_bf16 v[68:71], a[164:167], v[168:171], v[68:71]
    ds_read_b64_tr_b16 a[162:163], v200 offset:45056
    v_fma_f32 v135, v135, s28, -v193
    v_mfma_f32_16x16x32_bf16 v[100:103], a[164:167], v[172:175], v[100:103]
    ds_read_b64_tr_b16 a[164:165], v201 offset:40960
    v_fma_f32 v136, v136, s28, -v192
    v_mfma_f32_16x16x32_bf16 v[184:187], v[220:223], v[168:171], v[184:187]
    ds_read_b64_tr_b16 a[166:167], v201 offset:45056
    v_cvt_pk_bf16_f32 v164, v132, v133
    v_mfma_f32_16x16x32_bf16 v[72:75], a[168:171], v[168:171], v[72:75]
    v_exp_f32 v134, v134
    v_mfma_f32_16x16x32_bf16 v[188:191], v[220:223], v[172:175], v[188:191]
    v_exp_f32 v135, v135
    v_mfma_f32_16x16x32_bf16 v[104:107], a[168:171], v[172:175], v[104:107]
    ds_read_b64_tr_b16 a[168:169], v202 offset:40960
    v_fma_f32 v137, v137, s28, -v192
    v_mfma_f32_16x16x32_bf16 v[76:79], a[172:175], v[168:171], v[76:79]
    ds_read_b64_tr_b16 a[170:171], v202 offset:45056
    v_fma_f32 v138, v138, s28, -v192
    v_mfma_f32_16x16x32_bf16 v[108:111], a[172:175], v[172:175], v[108:111]
    ds_read_b64_tr_b16 a[172:173], v203 offset:40960
    v_cvt_pk_bf16_f32 v165, v134, v135
    v_mfma_f32_16x16x32_bf16 v[80:83], a[176:179], v[168:171], v[80:83]
    ds_read_b64_tr_b16 a[174:175], v203 offset:45056
    v_fma_f32 v139, v139, s28, -v192
    v_mfma_f32_16x16x32_bf16 v[112:115], a[176:179], v[172:175], v[112:115]
    ds_read_b64_tr_b16 a[176:177], v204 offset:40960
    v_fma_f32 v140, v140, s28, -v193
    v_mfma_f32_16x16x32_bf16 v[84:87], a[180:183], v[168:171], v[84:87]
    ds_read_b64_tr_b16 a[178:179], v204 offset:45056
    v_fma_f32 v141, v141, s28, -v193
    v_mfma_f32_16x16x32_bf16 v[116:119], a[180:183], v[172:175], v[116:119]
    ds_read_b64_tr_b16 a[180:181], v205 offset:40960
    v_exp_f32 v136, v136
    v_mfma_f32_16x16x32_bf16 v[88:91], a[184:187], v[168:171], v[88:91]
    ds_read_b64_tr_b16 a[182:183], v205 offset:45056
    v_fma_f32 v142, v142, s28, -v193
    v_mfma_f32_16x16x32_bf16 v[120:123], a[184:187], v[172:175], v[120:123]
    ds_read_b64_tr_b16 a[184:185], v206 offset:40960
    v_exp_f32 v137, v137
    v_mfma_f32_16x16x32_bf16 v[92:95], a[188:191], v[168:171], v[92:95]
    ds_read_b64_tr_b16 a[186:187], v206 offset:45056
    v_cvt_pk_bf16_f32 v162, v136, v137
    v_mfma_f32_16x16x32_bf16 v[124:127], a[188:191], v[172:175], v[124:127]
    ds_read_b64_tr_b16 a[188:189], v207 offset:40960
    v_fma_f32 v143, v143, s28, -v193
    v_mfma_f32_16x16x32_bf16 v[144:147], a[128:131], a[32:35], 0
    ds_read_b64_tr_b16 a[190:191], v207 offset:45056
    v_exp_f32 v138, v138
    v_mfma_f32_16x16x32_bf16 v[144:147], a[132:135], a[36:39], v[144:147]
    v_exp_f32 v139, v139
    v_mfma_f32_16x16x32_bf16 v[144:147], a[136:139], a[40:43], v[144:147]
    v_exp_f32 v140, v140
    v_mfma_f32_16x16x32_bf16 v[144:147], a[140:143], a[44:47], v[144:147]
    v_exp_f32 v141, v141
    v_mfma_f32_16x16x32_bf16 v[148:151], a[128:131], a[48:51], 0
    ds_read_b128 a[128:131], v196 offset:49152
    v_cvt_pk_bf16_f32 v163, v138, v139
    v_mfma_f32_16x16x32_bf16 v[148:151], a[132:135], a[52:55], v[148:151]
    ds_read_b128 a[132:135], v197 offset:49152
    v_cvt_pk_bf16_f32 v166, v140, v141
    v_mfma_f32_16x16x32_bf16 v[148:151], a[136:139], a[56:59], v[148:151]
    ds_read_b128 a[136:139], v198 offset:49152
    v_fma_f32 v144, v144, s28, -v194
    v_mfma_f32_16x16x32_bf16 v[148:151], a[140:143], a[60:63], v[148:151]
    ds_read_b128 a[140:143], v199 offset:49152
    v_fma_f32 v145, v145, s28, -v194
    v_mfma_f32_16x16x32_bf16 v[152:155], a[144:147], a[32:35], 0
    v_exp_f32 v142, v142
    v_mfma_f32_16x16x32_bf16 v[152:155], a[148:151], a[36:39], v[152:155]
    v_exp_f32 v143, v143
    v_mfma_f32_16x16x32_bf16 v[152:155], a[152:155], a[40:43], v[152:155]
    v_cvt_pk_bf16_f32 v167, v142, v143
    v_fma_f32 v146, v146, s28, -v194
    v_mfma_f32_16x16x32_bf16 v[152:155], a[156:159], a[44:47], v[152:155]
    v_exp_f32 v144, v144
    v_mfma_f32_16x16x32_bf16 v[156:159], a[144:147], a[48:51], 0
    ds_read_b128 a[144:147], v196 offset:53248
    v_fma_f32 v147, v147, s28, -v194
    v_mfma_f32_16x16x32_bf16 v[156:159], a[148:151], a[52:55], v[156:159]
    ds_read_b128 a[148:151], v197 offset:53248
    v_fma_f32 v148, v148, s28, -v195
    v_mfma_f32_16x16x32_bf16 v[156:159], a[152:155], a[56:59], v[156:159]
    ds_read_b128 a[152:155], v198 offset:53248
    v_fma_f32 v149, v149, s28, -v195
    v_mfma_f32_16x16x32_bf16 v[156:159], a[156:159], a[60:63], v[156:159]
    s_waitcnt lgkmcnt(7)
    ds_read_b128 a[156:159], v199 offset:53248
    v_fma_f32 v150, v150, s28, -v195
    v_mfma_f32_16x16x32_bf16 v[0:3], a[160:163], v[160:163], v[0:3]
    v_exp_f32 v145, v145
    v_mfma_f32_16x16x32_bf16 v[32:35], a[160:163], v[164:167], v[32:35]
    s_add_u32 m0, s34, 0x16000
    v_exp_f32 v146, v146
    v_mfma_f32_16x16x32_bf16 v[4:7], a[164:167], v[160:163], v[4:7]
    buffer_load_dwordx4 v210, s[16:19], 0 offen nt lds
    buffer_load_dwordx4 v211, s[16:19], 0 offen offset:1024 nt lds
    v_mfma_f32_16x16x32_bf16 v[36:39], a[164:167], v[164:167], v[36:39]
    s_add_u32 s16, s16, 0x2000
    v_exp_f32 v147, v147
    v_mfma_f32_16x16x32_bf16 v[176:179], v[220:223], v[160:163], v[176:179]
    s_addc_u32 s17, s17, 0
    v_cvt_pk_bf16_f32 v168, v144, v145
    v_cvt_pk_bf16_f32 v169, v146, v147
    v_mfma_f32_16x16x32_bf16 v[8:11], a[168:171], v[160:163], v[8:11]
    v_exp_f32 v148, v148
    v_mfma_f32_16x16x32_bf16 v[180:183], v[220:223], v[164:167], v[180:183]
    s_add_u32 m0, s34, 0x8000
    v_exp_f32 v149, v149
    v_mfma_f32_16x16x32_bf16 v[40:43], a[168:171], v[164:167], v[40:43]
    buffer_load_dwordx4 v208, s[12:15], 0 offen nt lds
    buffer_load_dwordx4 v209, s[12:15], 0 offen offset:1024 nt lds
    v_mfma_f32_16x16x32_bf16 v[12:15], a[172:175], v[160:163], v[12:15]
    s_add_u32 s12, s12, 0x2000
    v_fma_f32 v151, v151, s28, -v195
    v_fma_f32 v152, v152, s28, -v194
    v_mfma_f32_16x16x32_bf16 v[44:47], a[172:175], v[164:167], v[44:47]
    s_addc_u32 s13, s13, 0
    v_exp_f32 v150, v150
    v_mfma_f32_16x16x32_bf16 v[16:19], a[176:179], v[160:163], v[16:19]
    v_exp_f32 v151, v151
    v_mfma_f32_16x16x32_bf16 v[48:51], a[176:179], v[164:167], v[48:51]
    s_add_u32 s38, s58, 0x1003000
    v_cvt_pk_bf16_f32 v172, v148, v149
    v_fma_f32 v153, v153, s28, -v194
    v_mfma_f32_16x16x32_bf16 v[20:23], a[180:183], v[160:163], v[20:23]
    buffer_store_dwordx4 a[240:243], v214, s[20:23], s38 offen sc1
    v_exp_f32 v152, v152
    v_fma_f32 v154, v154, s28, -v194
    v_mfma_f32_16x16x32_bf16 v[52:55], a[180:183], v[164:167], v[52:55]
    v_exp_f32 v153, v153
    v_mfma_f32_16x16x32_bf16 v[24:27], a[184:187], v[160:163], v[24:27]
    v_cvt_pk_bf16_f32 v173, v150, v151
    v_fma_f32 v155, v155, s28, -v194
    v_mfma_f32_16x16x32_bf16 v[56:59], a[184:187], v[164:167], v[56:59]
    v_exp_f32 v154, v154
    v_mfma_f32_16x16x32_bf16 v[28:31], a[188:191], v[160:163], v[28:31]
    v_fma_f32 v156, v156, s28, -v195
    v_cvt_pk_bf16_f32 v170, v152, v153
    v_mfma_f32_16x16x32_bf16 v[60:63], a[188:191], v[164:167], v[60:63]
    s_waitcnt lgkmcnt(0)
    v_exp_f32 v155, v155
    v_mfma_f32_16x16x32_bf16 v[128:131], a[128:131], a[0:3], 0
    v_fma_f32 v157, v157, s28, -v195
    v_fma_f32 v158, v158, s28, -v195
    v_mfma_f32_16x16x32_bf16 v[128:131], a[132:135], a[4:7], v[128:131]
    s_add_u32 s38, s58, 0x1003000
    v_exp_f32 v156, v156
    v_mfma_f32_16x16x32_bf16 v[128:131], a[136:139], a[8:11], v[128:131]
    buffer_store_dwordx4 a[244:247], v214, s[20:23], s38 offen offset:1024 sc1
    v_exp_f32 v157, v157
    v_cvt_pk_bf16_f32 v171, v154, v155
    v_mfma_f32_16x16x32_bf16 v[128:131], a[140:143], a[12:15], v[128:131]
    v_fma_f32 v159, v159, s28, -v195
    v_cvt_pk_bf16_f32 v174, v156, v157
    v_mfma_f32_16x16x32_bf16 v[132:135], a[128:131], a[16:19], 0
    v_exp_f32 v158, v158
    v_mfma_f32_16x16x32_bf16 v[132:135], a[132:135], a[20:23], v[132:135]
    v_exp_f32 v159, v159
    v_mfma_f32_16x16x32_bf16 v[132:135], a[136:139], a[24:27], v[132:135]
    v_cvt_pk_bf16_f32 v175, v158, v159
    v_fma_f32 v128, v128, s28, -v192
    v_mfma_f32_16x16x32_bf16 v[132:135], a[140:143], a[28:31], v[132:135]
    v_fma_f32 v129, v129, s28, -v192
    v_fma_f32 v130, v130, s28, -v192
    v_mfma_f32_16x16x32_bf16 v[136:139], a[144:147], a[0:3], 0
    s_add_u32 s38, s58, 0x1003000
    v_exp_f32 v128, v128
    v_mfma_f32_16x16x32_bf16 v[136:139], a[148:151], a[4:7], v[136:139]
    buffer_store_dwordx4 a[248:251], v214, s[20:23], s38 offen offset:2048 sc1
    v_exp_f32 v129, v129
    v_fma_f32 v131, v131, s28, -v192
    v_mfma_f32_16x16x32_bf16 v[136:139], a[152:155], a[8:11], v[136:139]
    v_exp_f32 v130, v130
    v_mfma_f32_16x16x32_bf16 v[136:139], a[156:159], a[12:15], v[136:139]
    v_fma_f32 v132, v132, s28, -v193
    v_cvt_pk_bf16_f32 v160, v128, v129
    v_mfma_f32_16x16x32_bf16 v[140:143], a[144:147], a[16:19], 0
    v_exp_f32 v131, v131
    v_mfma_f32_16x16x32_bf16 v[140:143], a[148:151], a[20:23], v[140:143]
    v_fma_f32 v133, v133, s28, -v193
    v_fma_f32 v134, v134, s28, -v193
    v_mfma_f32_16x16x32_bf16 v[140:143], a[152:155], a[24:27], v[140:143]
    s_waitcnt vmcnt(28)
    s_barrier
    v_exp_f32 v132, v132
    v_mfma_f32_16x16x32_bf16 v[140:143], a[156:159], a[28:31], v[140:143]
    v_exp_f32 v133, v133
    v_mfma_f32_16x16x32_bf16 v[64:67], a[160:163], v[168:171], v[64:67]
    v_cvt_pk_bf16_f32 v161, v130, v131
    v_fma_f32 v135, v135, s28, -v193
    v_mfma_f32_16x16x32_bf16 v[96:99], a[160:163], v[172:175], v[96:99]
    ds_read_b64_tr_b16 a[160:161], v200 offset:49152
    v_fma_f32 v136, v136, s28, -v192
    v_mfma_f32_16x16x32_bf16 v[68:71], a[164:167], v[168:171], v[68:71]
    ds_read_b64_tr_b16 a[162:163], v200 offset:53248
    v_cvt_pk_bf16_f32 v164, v132, v133
    v_mfma_f32_16x16x32_bf16 v[100:103], a[164:167], v[172:175], v[100:103]
    ds_read_b64_tr_b16 a[164:165], v201 offset:49152
    v_fma_f32 v137, v137, s28, -v192
    v_mfma_f32_16x16x32_bf16 v[184:187], v[220:223], v[168:171], v[184:187]
    ds_read_b64_tr_b16 a[166:167], v201 offset:53248
    v_fma_f32 v138, v138, s28, -v192
    v_mfma_f32_16x16x32_bf16 v[72:75], a[168:171], v[168:171], v[72:75]
    v_exp_f32 v134, v134
    v_mfma_f32_16x16x32_bf16 v[188:191], v[220:223], v[172:175], v[188:191]
    v_exp_f32 v135, v135
    v_mfma_f32_16x16x32_bf16 v[104:107], a[168:171], v[172:175], v[104:107]
    ds_read_b64_tr_b16 a[168:169], v202 offset:49152
    v_cvt_pk_bf16_f32 v165, v134, v135
    v_mfma_f32_16x16x32_bf16 v[76:79], a[172:175], v[168:171], v[76:79]
    ds_read_b64_tr_b16 a[170:171], v202 offset:53248
    v_fma_f32 v139, v139, s28, -v192
    v_mfma_f32_16x16x32_bf16 v[108:111], a[172:175], v[172:175], v[108:111]
    ds_read_b64_tr_b16 a[172:173], v203 offset:49152
    v_fma_f32 v140, v140, s28, -v193
    v_mfma_f32_16x16x32_bf16 v[80:83], a[176:179], v[168:171], v[80:83]
    ds_read_b64_tr_b16 a[174:175], v203 offset:53248
    v_fma_f32 v141, v141, s28, -v193
    v_mfma_f32_16x16x32_bf16 v[112:115], a[176:179], v[172:175], v[112:115]
    ds_read_b64_tr_b16 a[176:177], v204 offset:49152
    v_exp_f32 v136, v136
    v_mfma_f32_16x16x32_bf16 v[84:87], a[180:183], v[168:171], v[84:87]
    ds_read_b64_tr_b16 a[178:179], v204 offset:53248
    v_fma_f32 v142, v142, s28, -v193
    v_mfma_f32_16x16x32_bf16 v[116:119], a[180:183], v[172:175], v[116:119]
    ds_read_b64_tr_b16 a[180:181], v205 offset:49152
    v_exp_f32 v137, v137
    v_mfma_f32_16x16x32_bf16 v[88:91], a[184:187], v[168:171], v[88:91]
    ds_read_b64_tr_b16 a[182:183], v205 offset:53248
    v_cvt_pk_bf16_f32 v162, v136, v137
    v_mfma_f32_16x16x32_bf16 v[120:123], a[184:187], v[172:175], v[120:123]
    ds_read_b64_tr_b16 a[184:185], v206 offset:49152
    v_fma_f32 v143, v143, s28, -v193
    v_mfma_f32_16x16x32_bf16 v[92:95], a[188:191], v[168:171], v[92:95]
    ds_read_b64_tr_b16 a[186:187], v206 offset:53248
    v_exp_f32 v138, v138
    v_mfma_f32_16x16x32_bf16 v[124:127], a[188:191], v[172:175], v[124:127]
    ds_read_b64_tr_b16 a[188:189], v207 offset:49152
    v_exp_f32 v139, v139
    v_mfma_f32_16x16x32_bf16 v[144:147], a[128:131], a[32:35], 0
    ds_read_b64_tr_b16 a[190:191], v207 offset:53248
    v_cvt_pk_bf16_f32 v163, v138, v139
    v_mfma_f32_16x16x32_bf16 v[144:147], a[132:135], a[36:39], v[144:147]
    v_exp_f32 v140, v140
    v_mfma_f32_16x16x32_bf16 v[144:147], a[136:139], a[40:43], v[144:147]
    v_exp_f32 v141, v141
    v_mfma_f32_16x16x32_bf16 v[144:147], a[140:143], a[44:47], v[144:147]
    v_exp_f32 v142, v142
    v_mfma_f32_16x16x32_bf16 v[148:151], a[128:131], a[48:51], 0
    ds_read_b128 a[128:131], v196 offset:57344
    v_cvt_pk_bf16_f32 v166, v140, v141
    v_mfma_f32_16x16x32_bf16 v[148:151], a[132:135], a[52:55], v[148:151]
    ds_read_b128 a[132:135], v197 offset:57344
    v_exp_f32 v143, v143
    v_mfma_f32_16x16x32_bf16 v[148:151], a[136:139], a[56:59], v[148:151]
    ds_read_b128 a[136:139], v198 offset:57344
    v_cvt_pk_bf16_f32 v167, v142, v143
    v_mfma_f32_16x16x32_bf16 v[148:151], a[140:143], a[60:63], v[148:151]
    ds_read_b128 a[140:143], v199 offset:57344
    v_fma_f32 v144, v144, s28, -v194
    v_mfma_f32_16x16x32_bf16 v[152:155], a[144:147], a[32:35], 0
    v_fma_f32 v145, v145, s28, -v194
    v_fma_f32 v146, v146, s28, -v194
    v_mfma_f32_16x16x32_bf16 v[152:155], a[148:151], a[36:39], v[152:155]
    v_exp_f32 v144, v144
    v_mfma_f32_16x16x32_bf16 v[152:155], a[152:155], a[40:43], v[152:155]
    v_exp_f32 v145, v145
    v_mfma_f32_16x16x32_bf16 v[152:155], a[156:159], a[44:47], v[152:155]
    v_fma_f32 v147, v147, s28, -v194
    v_fma_f32 v148, v148, s28, -v195
    v_mfma_f32_16x16x32_bf16 v[156:159], a[144:147], a[48:51], 0
    ds_read_b128 a[144:147], v196 offset:61440
    v_cvt_pk_bf16_f32 v168, v144, v145
    v_mfma_f32_16x16x32_bf16 v[156:159], a[148:151], a[52:55], v[156:159]
    ds_read_b128 a[148:151], v197 offset:61440
    v_fma_f32 v149, v149, s28, -v195
    v_mfma_f32_16x16x32_bf16 v[156:159], a[152:155], a[56:59], v[156:159]
    ds_read_b128 a[152:155], v198 offset:61440
    v_fma_f32 v150, v150, s28, -v195
    v_mfma_f32_16x16x32_bf16 v[156:159], a[156:159], a[60:63], v[156:159]
    s_waitcnt lgkmcnt(7)
    ds_read_b128 a[156:159], v199 offset:61440
    v_fma_f32 v151, v151, s28, -v195
    v_mfma_f32_16x16x32_bf16 v[0:3], a[160:163], v[160:163], v[0:3]
    v_exp_f32 v146, v146
    v_mfma_f32_16x16x32_bf16 v[32:35], a[160:163], v[164:167], v[32:35]
    s_add_u32 m0, s34, 0x18000
    v_exp_f32 v147, v147
    v_mfma_f32_16x16x32_bf16 v[4:7], a[164:167], v[160:163], v[4:7]
    buffer_load_dwordx4 v210, s[16:19], 0 offen nt lds
    buffer_load_dwordx4 v211, s[16:19], 0 offen offset:1024 nt lds
    v_mfma_f32_16x16x32_bf16 v[36:39], a[164:167], v[164:167], v[36:39]
    s_add_u32 s16, s16, 0x2000
    v_exp_f32 v148, v148
    v_mfma_f32_16x16x32_bf16 v[176:179], v[220:223], v[160:163], v[176:179]
    s_addc_u32 s17, s17, 0
    v_exp_f32 v149, v149
    v_mfma_f32_16x16x32_bf16 v[8:11], a[168:171], v[160:163], v[8:11]
    v_cvt_pk_bf16_f32 v169, v146, v147
    v_fma_f32 v152, v152, s28, -v194
    v_mfma_f32_16x16x32_bf16 v[180:183], v[220:223], v[164:167], v[180:183]
    s_add_u32 m0, s34, 0xa000
    v_exp_f32 v150, v150
    v_mfma_f32_16x16x32_bf16 v[40:43], a[168:171], v[164:167], v[40:43]
    buffer_load_dwordx4 v208, s[12:15], 0 offen nt lds
    buffer_load_dwordx4 v209, s[12:15], 0 offen offset:1024 nt lds
    v_mfma_f32_16x16x32_bf16 v[12:15], a[172:175], v[160:163], v[12:15]
    s_add_u32 s12, s12, 0x2000
    v_exp_f32 v151, v151
    v_mfma_f32_16x16x32_bf16 v[44:47], a[172:175], v[164:167], v[44:47]
    s_addc_u32 s13, s13, 0
    v_cvt_pk_bf16_f32 v172, v148, v149
    v_fma_f32 v153, v153, s28, -v194
    v_mfma_f32_16x16x32_bf16 v[16:19], a[176:179], v[160:163], v[16:19]
    v_exp_f32 v152, v152
    v_mfma_f32_16x16x32_bf16 v[48:51], a[176:179], v[164:167], v[48:51]
    v_fma_f32 v154, v154, s28, -v194
    v_cvt_pk_bf16_f32 v173, v150, v151
    v_mfma_f32_16x16x32_bf16 v[20:23], a[180:183], v[160:163], v[20:23]
    s_add_u32 s38, s58, 0x1003000
    v_exp_f32 v153, v153
    v_mfma_f32_16x16x32_bf16 v[52:55], a[180:183], v[164:167], v[52:55]
    buffer_store_dwordx4 a[252:255], v214, s[20:23], s38 offen offset:3072 sc1
    v_fma_f32 v155, v155, s28, -v194
    v_exp_f32 v154, v154
    v_mfma_f32_16x16x32_bf16 v[24:27], a[184:187], v[160:163], v[24:27]
    v_fma_f32 v156, v156, s28, -v195
    v_cvt_pk_bf16_f32 v170, v152, v153
    v_mfma_f32_16x16x32_bf16 v[56:59], a[184:187], v[164:167], v[56:59]
    v_exp_f32 v155, v155
    v_mfma_f32_16x16x32_bf16 v[28:31], a[188:191], v[160:163], v[28:31]
    v_fma_f32 v157, v157, s28, -v195
    v_fma_f32 v158, v158, s28, -v195
    v_mfma_f32_16x16x32_bf16 v[60:63], a[188:191], v[164:167], v[60:63]
    s_waitcnt lgkmcnt(0)
    v_exp_f32 v156, v156
    v_mfma_f32_16x16x32_bf16 v[128:131], a[128:131], a[0:3], 0
    v_exp_f32 v157, v157
    v_mfma_f32_16x16x32_bf16 v[128:131], a[132:135], a[4:7], v[128:131]
    v_cvt_pk_bf16_f32 v171, v154, v155
    v_fma_f32 v159, v159, s28, -v195
    v_mfma_f32_16x16x32_bf16 v[128:131], a[136:139], a[8:11], v[128:131]
    v_exp_f32 v158, v158
    v_mfma_f32_16x16x32_bf16 v[128:131], a[140:143], a[12:15], v[128:131]
    s_waitcnt lgkmcnt(15)
    v_exp_f32 v159, v159
    v_mfma_f32_16x16x32_bf16 v[132:135], a[128:131], a[16:19], 0
    s_add_u32 s38, s32, 0
    v_cvt_pk_bf16_f32 v174, v156, v157
    v_cvt_pk_bf16_f32 v175, v158, v159
    v_mfma_f32_16x16x32_bf16 v[132:135], a[132:135], a[20:23], v[132:135]
    buffer_store_dwordx4 a[192:195], v214, s[20:23], s38 offen sc1
    v_fma_f32 v128, v128, s28, -v192
    v_fma_f32 v129, v129, s28, -v192
    v_fma_f32 v130, v130, s28, -v192
    v_mfma_f32_16x16x32_bf16 v[132:135], a[136:139], a[24:27], v[132:135]
    v_exp_f32 v128, v128
    v_mfma_f32_16x16x32_bf16 v[132:135], a[140:143], a[28:31], v[132:135]
    v_exp_f32 v129, v129
    v_mfma_f32_16x16x32_bf16 v[136:139], a[144:147], a[0:3], 0
    v_fma_f32 v131, v131, s28, -v192
    v_cvt_pk_bf16_f32 v160, v128, v129
    v_mfma_f32_16x16x32_bf16 v[136:139], a[148:151], a[4:7], v[136:139]
    v_exp_f32 v130, v130
    v_mfma_f32_16x16x32_bf16 v[136:139], a[152:155], a[8:11], v[136:139]
    v_exp_f32 v131, v131
    v_mfma_f32_16x16x32_bf16 v[136:139], a[156:159], a[12:15], v[136:139]
    v_fma_f32 v132, v132, s28, -v193
    v_fma_f32 v133, v133, s28, -v193
    v_mfma_f32_16x16x32_bf16 v[140:143], a[144:147], a[16:19], 0
    v_exp_f32 v132, v132
    v_mfma_f32_16x16x32_bf16 v[140:143], a[148:151], a[20:23], v[140:143]
    v_fma_f32 v134, v134, s28, -v193
    v_cvt_pk_bf16_f32 v161, v130, v131
    v_mfma_f32_16x16x32_bf16 v[140:143], a[152:155], a[24:27], v[140:143]
    v_exp_f32 v133, v133
    v_mfma_f32_16x16x32_bf16 v[140:143], a[156:159], a[28:31], v[140:143]
    v_fma_f32 v135, v135, s28, -v193
    v_fma_f32 v136, v136, s28, -v192
    v_mfma_f32_16x16x32_bf16 v[64:67], a[160:163], v[168:171], v[64:67]
    v_exp_f32 v134, v134
    v_mfma_f32_16x16x32_bf16 v[96:99], a[160:163], v[172:175], v[96:99]
    ds_read_b64_tr_b16 a[160:161], v200 offset:57344
    v_cvt_pk_bf16_f32 v164, v132, v133
    v_mfma_f32_16x16x32_bf16 v[68:71], a[164:167], v[168:171], v[68:71]
    ds_read_b64_tr_b16 a[162:163], v200 offset:61440
    v_fma_f32 v137, v137, s28, -v192
    v_mfma_f32_16x16x32_bf16 v[100:103], a[164:167], v[172:175], v[100:103]
    ds_read_b64_tr_b16 a[164:165], v201 offset:57344
    v_fma_f32 v138, v138, s28, -v192
    v_mfma_f32_16x16x32_bf16 v[184:187], v[220:223], v[168:171], v[184:187]
    ds_read_b64_tr_b16 a[166:167], v201 offset:61440
    v_fma_f32 v139, v139, s28, -v192
    v_mfma_f32_16x16x32_bf16 v[72:75], a[168:171], v[168:171], v[72:75]
    v_exp_f32 v135, v135
    v_mfma_f32_16x16x32_bf16 v[188:191], v[220:223], v[172:175], v[188:191]
    v_exp_f32 v136, v136
    v_mfma_f32_16x16x32_bf16 v[104:107], a[168:171], v[172:175], v[104:107]
    ds_read_b64_tr_b16 a[168:169], v202 offset:57344
    v_cvt_pk_bf16_f32 v165, v134, v135
    v_mfma_f32_16x16x32_bf16 v[76:79], a[172:175], v[168:171], v[76:79]
    ds_read_b64_tr_b16 a[170:171], v202 offset:61440
    v_fma_f32 v140, v140, s28, -v193
    v_mfma_f32_16x16x32_bf16 v[108:111], a[172:175], v[172:175], v[108:111]
    ds_read_b64_tr_b16 a[172:173], v203 offset:57344
    v_fma_f32 v141, v141, s28, -v193
    v_mfma_f32_16x16x32_bf16 v[80:83], a[176:179], v[168:171], v[80:83]
    ds_read_b64_tr_b16 a[174:175], v203 offset:61440
    v_fma_f32 v142, v142, s28, -v193
    v_mfma_f32_16x16x32_bf16 v[112:115], a[176:179], v[172:175], v[112:115]
    ds_read_b64_tr_b16 a[176:177], v204 offset:57344
    v_exp_f32 v137, v137
    v_mfma_f32_16x16x32_bf16 v[84:87], a[180:183], v[168:171], v[84:87]
    ds_read_b64_tr_b16 a[178:179], v204 offset:61440
    v_cvt_pk_bf16_f32 v162, v136, v137
    v_mfma_f32_16x16x32_bf16 v[116:119], a[180:183], v[172:175], v[116:119]
    ds_read_b64_tr_b16 a[180:181], v205 offset:57344
    v_fma_f32 v143, v143, s28, -v193
    v_mfma_f32_16x16x32_bf16 v[88:91], a[184:187], v[168:171], v[88:91]
    ds_read_b64_tr_b16 a[182:183], v205 offset:61440
    v_exp_f32 v138, v138
    v_mfma_f32_16x16x32_bf16 v[120:123], a[184:187], v[172:175], v[120:123]
    ds_read_b64_tr_b16 a[184:185], v206 offset:57344
    v_exp_f32 v139, v139
    v_mfma_f32_16x16x32_bf16 v[92:95], a[188:191], v[168:171], v[92:95]
    ds_read_b64_tr_b16 a[186:187], v206 offset:61440
    v_cvt_pk_bf16_f32 v163, v138, v139
    v_mfma_f32_16x16x32_bf16 v[124:127], a[188:191], v[172:175], v[124:127]
    ds_read_b64_tr_b16 a[188:189], v207 offset:57344
    v_exp_f32 v140, v140
    v_mfma_f32_16x16x32_bf16 v[144:147], a[128:131], a[32:35], 0
    ds_read_b64_tr_b16 a[190:191], v207 offset:61440
    v_exp_f32 v141, v141
    v_mfma_f32_16x16x32_bf16 v[144:147], a[132:135], a[36:39], v[144:147]
    v_exp_f32 v142, v142
    v_mfma_f32_16x16x32_bf16 v[144:147], a[136:139], a[40:43], v[144:147]
    v_exp_f32 v143, v143
    v_mfma_f32_16x16x32_bf16 v[144:147], a[140:143], a[44:47], v[144:147]
    v_cvt_pk_bf16_f32 v166, v140, v141
    v_cvt_pk_bf16_f32 v167, v142, v143
    v_mfma_f32_16x16x32_bf16 v[148:151], a[128:131], a[48:51], 0
    ds_read_b128 a[128:131], v196 offset:0
    v_mfma_f32_16x16x32_bf16 v[148:151], a[132:135], a[52:55], v[148:151]
    ds_read_b128 a[132:135], v197 offset:0
    v_mfma_f32_16x16x32_bf16 v[148:151], a[136:139], a[56:59], v[148:151]
    ds_read_b128 a[136:139], v198 offset:0
    v_fma_f32 v144, v144, s28, -v194
    v_mfma_f32_16x16x32_bf16 v[148:151], a[140:143], a[60:63], v[148:151]
    ds_read_b128 a[140:143], v199 offset:0
    v_fma_f32 v145, v145, s28, -v194
    v_mfma_f32_16x16x32_bf16 v[152:155], a[144:147], a[32:35], 0
    v_exp_f32 v144, v144
    v_mfma_f32_16x16x32_bf16 v[152:155], a[148:151], a[36:39], v[152:155]
    v_fma_f32 v146, v146, s28, -v194
    v_fma_f32 v147, v147, s28, -v194
    v_mfma_f32_16x16x32_bf16 v[152:155], a[152:155], a[40:43], v[152:155]
    v_exp_f32 v145, v145
    v_mfma_f32_16x16x32_bf16 v[152:155], a[156:159], a[44:47], v[152:155]
    v_exp_f32 v146, v146
    v_mfma_f32_16x16x32_bf16 v[156:159], a[144:147], a[48:51], 0
    ds_read_b128 a[144:147], v196 offset:4096
    v_fma_f32 v148, v148, s28, -v195
    v_mfma_f32_16x16x32_bf16 v[156:159], a[148:151], a[52:55], v[156:159]
    ds_read_b128 a[148:151], v197 offset:4096
    v_cvt_pk_bf16_f32 v168, v144, v145
    v_mfma_f32_16x16x32_bf16 v[156:159], a[152:155], a[56:59], v[156:159]
    ds_read_b128 a[152:155], v198 offset:4096
    v_fma_f32 v149, v149, s28, -v195
    v_mfma_f32_16x16x32_bf16 v[156:159], a[156:159], a[60:63], v[156:159]
    s_waitcnt lgkmcnt(7)
    ds_read_b128 a[156:159], v199 offset:4096
    v_fma_f32 v150, v150, s28, -v195
    v_mfma_f32_16x16x32_bf16 v[0:3], a[160:163], v[160:163], v[0:3]
    v_exp_f32 v147, v147
    v_mfma_f32_16x16x32_bf16 v[32:35], a[160:163], v[164:167], v[32:35]
    s_add_u32 m0, s34, 0x1a000
    v_exp_f32 v148, v148
    v_mfma_f32_16x16x32_bf16 v[4:7], a[164:167], v[160:163], v[4:7]
    buffer_load_dwordx4 v210, s[16:19], 0 offen nt lds
    buffer_load_dwordx4 v211, s[16:19], 0 offen offset:1024 nt lds
    v_mfma_f32_16x16x32_bf16 v[36:39], a[164:167], v[164:167], v[36:39]
    s_add_u32 s16, s16, 0x2000
    v_exp_f32 v149, v149
    v_mfma_f32_16x16x32_bf16 v[176:179], v[220:223], v[160:163], v[176:179]
    s_addc_u32 s17, s17, 0
    v_cvt_pk_bf16_f32 v169, v146, v147
    v_fma_f32 v151, v151, s28, -v195
    v_mfma_f32_16x16x32_bf16 v[8:11], a[168:171], v[160:163], v[8:11]
    v_exp_f32 v150, v150
    v_mfma_f32_16x16x32_bf16 v[180:183], v[220:223], v[164:167], v[180:183]
    s_add_u32 m0, s34, 0xc000
    v_fma_f32 v152, v152, s28, -v194
    v_cvt_pk_bf16_f32 v172, v148, v149
    v_mfma_f32_16x16x32_bf16 v[40:43], a[168:171], v[164:167], v[40:43]
    buffer_load_dwordx4 v208, s[12:15], 0 offen nt lds
    buffer_load_dwordx4 v209, s[12:15], 0 offen offset:1024 nt lds
    v_mfma_f32_16x16x32_bf16 v[12:15], a[172:175], v[160:163], v[12:15]
    s_add_u32 s12, s12, 0x2000
    v_exp_f32 v151, v151
    v_mfma_f32_16x16x32_bf16 v[44:47], a[172:175], v[164:167], v[44:47]
    s_addc_u32 s13, s13, 0
    v_fma_f32 v153, v153, s28, -v194
    v_fma_f32 v154, v154, s28, -v194
    v_mfma_f32_16x16x32_bf16 v[16:19], a[176:179], v[160:163], v[16:19]
    v_exp_f32 v152, v152
    v_mfma_f32_16x16x32_bf16 v[48:51], a[176:179], v[164:167], v[48:51]
    s_add_u32 s38, s32, 0
    v_exp_f32 v153, v153
    v_mfma_f32_16x16x32_bf16 v[20:23], a[180:183], v[160:163], v[20:23]
    buffer_store_dwordx4 a[196:199], v214, s[20:23], s38 offen offset:1024 sc1
    v_cvt_pk_bf16_f32 v173, v150, v151
    v_fma_f32 v155, v155, s28, -v194
    v_fma_f32 v156, v156, s28, -v195
    v_mfma_f32_16x16x32_bf16 v[52:55], a[180:183], v[164:167], v[52:55]
    v_exp_f32 v154, v154
    v_mfma_f32_16x16x32_bf16 v[24:27], a[184:187], v[160:163], v[24:27]
    v_exp_f32 v155, v155
    v_mfma_f32_16x16x32_bf16 v[56:59], a[184:187], v[164:167], v[56:59]
    v_cvt_pk_bf16_f32 v170, v152, v153
    v_fma_f32 v157, v157, s28, -v195
    v_mfma_f32_16x16x32_bf16 v[28:31], a[188:191], v[160:163], v[28:31]
    v_exp_f32 v156, v156
    v_mfma_f32_16x16x32_bf16 v[60:63], a[188:191], v[164:167], v[60:63]
    s_waitcnt lgkmcnt(0)
    v_fma_f32 v158, v158, s28, -v195
    v_cvt_pk_bf16_f32 v171, v154, v155
    v_mfma_f32_16x16x32_bf16 v[128:131], a[128:131], a[0:3], 0
    v_exp_f32 v157, v157
    v_mfma_f32_16x16x32_bf16 v[128:131], a[132:135], a[4:7], v[128:131]
    v_fma_f32 v159, v159, s28, -v195
    v_cvt_pk_bf16_f32 v174, v156, v157
    v_mfma_f32_16x16x32_bf16 v[128:131], a[136:139], a[8:11], v[128:131]
    v_exp_f32 v158, v158
    v_mfma_f32_16x16x32_bf16 v[128:131], a[140:143], a[12:15], v[128:131]
    s_add_u32 s38, s32, 0
    v_exp_f32 v159, v159
    v_mfma_f32_16x16x32_bf16 v[132:135], a[128:131], a[16:19], 0
    buffer_store_dwordx4 a[200:203], v214, s[20:23], s38 offen offset:2048 sc1
    v_cvt_pk_bf16_f32 v175, v158, v159
    v_mfma_f32_16x16x32_bf16 v[132:135], a[132:135], a[20:23], v[132:135]
    v_mfma_f32_16x16x32_bf16 v[132:135], a[136:139], a[24:27], v[132:135]
    v_mfma_f32_16x16x32_bf16 v[132:135], a[140:143], a[28:31], v[132:135]
    v_fma_f32 v128, v128, s28, -v192
    v_fma_f32 v129, v129, s28, -v192
    v_mfma_f32_16x16x32_bf16 v[136:139], a[144:147], a[0:3], 0
    v_exp_f32 v128, v128
    v_mfma_f32_16x16x32_bf16 v[136:139], a[148:151], a[4:7], v[136:139]
    v_fma_f32 v130, v130, s28, -v192
    v_fma_f32 v131, v131, s28, -v192
    v_mfma_f32_16x16x32_bf16 v[136:139], a[152:155], a[8:11], v[136:139]
    v_exp_f32 v129, v129
    v_mfma_f32_16x16x32_bf16 v[136:139], a[156:159], a[12:15], v[136:139]
    v_exp_f32 v130, v130
    v_mfma_f32_16x16x32_bf16 v[140:143], a[144:147], a[16:19], 0
    v_fma_f32 v132, v132, s28, -v193
    v_cvt_pk_bf16_f32 v160, v128, v129
    v_mfma_f32_16x16x32_bf16 v[140:143], a[148:151], a[20:23], v[140:143]
    v_exp_f32 v131, v131
    v_mfma_f32_16x16x32_bf16 v[140:143], a[152:155], a[24:27], v[140:143]
    s_waitcnt vmcnt(27)
    s_barrier
    v_fma_f32 v133, v133, s28, -v193
    v_mfma_f32_16x16x32_bf16 v[140:143], a[156:159], a[28:31], v[140:143]
    v_exp_f32 v132, v132
    v_mfma_f32_16x16x32_bf16 v[64:67], a[160:163], v[168:171], v[64:67]
    v_fma_f32 v134, v134, s28, -v193
    v_cvt_pk_bf16_f32 v161, v130, v131
    v_mfma_f32_16x16x32_bf16 v[96:99], a[160:163], v[172:175], v[96:99]
    ds_read_b64_tr_b16 a[160:161], v200 offset:0
    v_fma_f32 v135, v135, s28, -v193
    v_mfma_f32_16x16x32_bf16 v[68:71], a[164:167], v[168:171], v[68:71]
    ds_read_b64_tr_b16 a[162:163], v200 offset:4096
    v_fma_f32 v136, v136, s28, -v192
    v_mfma_f32_16x16x32_bf16 v[100:103], a[164:167], v[172:175], v[100:103]
    ds_read_b64_tr_b16 a[164:165], v201 offset:0
    v_fma_f32 v137, v137, s28, -v192
    v_mfma_f32_16x16x32_bf16 v[184:187], v[220:223], v[168:171], v[184:187]
    ds_read_b64_tr_b16 a[166:167], v201 offset:4096
    v_fma_f32 v138, v138, s28, -v192
    v_mfma_f32_16x16x32_bf16 v[72:75], a[168:171], v[168:171], v[72:75]
    v_exp_f32 v133, v133
    v_mfma_f32_16x16x32_bf16 v[188:191], v[220:223], v[172:175], v[188:191]
    v_exp_f32 v134, v134
    v_mfma_f32_16x16x32_bf16 v[104:107], a[168:171], v[172:175], v[104:107]
    ds_read_b64_tr_b16 a[168:169], v202 offset:0
    v_cvt_pk_bf16_f32 v164, v132, v133
    v_mfma_f32_16x16x32_bf16 v[76:79], a[172:175], v[168:171], v[76:79]
    ds_read_b64_tr_b16 a[170:171], v202 offset:4096
    v_fma_f32 v139, v139, s28, -v192
    v_mfma_f32_16x16x32_bf16 v[108:111], a[172:175], v[172:175], v[108:111]
    ds_read_b64_tr_b16 a[172:173], v203 offset:0
    v_fma_f32 v140, v140, s28, -v193
    v_mfma_f32_16x16x32_bf16 v[80:83], a[176:179], v[168:171], v[80:83]
    ds_read_b64_tr_b16 a[174:175], v203 offset:4096
    v_exp_f32 v135, v135
    v_mfma_f32_16x16x32_bf16 v[112:115], a[176:179], v[172:175], v[112:115]
    ds_read_b64_tr_b16 a[176:177], v204 offset:0
    v_cvt_pk_bf16_f32 v165, v134, v135
    v_mfma_f32_16x16x32_bf16 v[84:87], a[180:183], v[168:171], v[84:87]
    ds_read_b64_tr_b16 a[178:179], v204 offset:4096
    v_fma_f32 v141, v141, s28, -v193
    v_mfma_f32_16x16x32_bf16 v[116:119], a[180:183], v[172:175], v[116:119]
    ds_read_b64_tr_b16 a[180:181], v205 offset:0
    v_exp_f32 v136, v136
    v_mfma_f32_16x16x32_bf16 v[88:91], a[184:187], v[168:171], v[88:91]
    ds_read_b64_tr_b16 a[182:183], v205 offset:4096
    v_fma_f32 v142, v142, s28, -v193
    v_mfma_f32_16x16x32_bf16 v[120:123], a[184:187], v[172:175], v[120:123]
    ds_read_b64_tr_b16 a[184:185], v206 offset:0
    v_exp_f32 v137, v137
    v_mfma_f32_16x16x32_bf16 v[92:95], a[188:191], v[168:171], v[92:95]
    ds_read_b64_tr_b16 a[186:187], v206 offset:4096
    v_cvt_pk_bf16_f32 v162, v136, v137
    v_mfma_f32_16x16x32_bf16 v[124:127], a[188:191], v[172:175], v[124:127]
    ds_read_b64_tr_b16 a[188:189], v207 offset:0
    v_fma_f32 v143, v143, s28, -v193
    v_mfma_f32_16x16x32_bf16 v[144:147], a[128:131], a[32:35], 0
    ds_read_b64_tr_b16 a[190:191], v207 offset:4096
    v_exp_f32 v138, v138
    v_mfma_f32_16x16x32_bf16 v[144:147], a[132:135], a[36:39], v[144:147]
    v_exp_f32 v139, v139
    v_mfma_f32_16x16x32_bf16 v[144:147], a[136:139], a[40:43], v[144:147]
    v_exp_f32 v140, v140
    v_mfma_f32_16x16x32_bf16 v[144:147], a[140:143], a[44:47], v[144:147]
    v_exp_f32 v141, v141
    v_mfma_f32_16x16x32_bf16 v[148:151], a[128:131], a[48:51], 0
    ds_read_b128 a[128:131], v196 offset:8192
    v_cvt_pk_bf16_f32 v163, v138, v139
    v_mfma_f32_16x16x32_bf16 v[148:151], a[132:135], a[52:55], v[148:151]
    ds_read_b128 a[132:135], v197 offset:8192
    v_cvt_pk_bf16_f32 v166, v140, v141
    v_mfma_f32_16x16x32_bf16 v[148:151], a[136:139], a[56:59], v[148:151]
    ds_read_b128 a[136:139], v198 offset:8192
    v_fma_f32 v144, v144, s28, -v194
    v_mfma_f32_16x16x32_bf16 v[148:151], a[140:143], a[60:63], v[148:151]
    ds_read_b128 a[140:143], v199 offset:8192
    v_fma_f32 v145, v145, s28, -v194
    v_mfma_f32_16x16x32_bf16 v[152:155], a[144:147], a[32:35], 0
    v_exp_f32 v142, v142
    v_mfma_f32_16x16x32_bf16 v[152:155], a[148:151], a[36:39], v[152:155]
    v_exp_f32 v143, v143
    v_mfma_f32_16x16x32_bf16 v[152:155], a[152:155], a[40:43], v[152:155]
    v_cvt_pk_bf16_f32 v167, v142, v143
    v_fma_f32 v146, v146, s28, -v194
    v_mfma_f32_16x16x32_bf16 v[152:155], a[156:159], a[44:47], v[152:155]
    v_exp_f32 v144, v144
    v_mfma_f32_16x16x32_bf16 v[156:159], a[144:147], a[48:51], 0
    ds_read_b128 a[144:147], v196 offset:12288
    v_fma_f32 v147, v147, s28, -v194
    v_mfma_f32_16x16x32_bf16 v[156:159], a[148:151], a[52:55], v[156:159]
    ds_read_b128 a[148:151], v197 offset:12288
    v_fma_f32 v148, v148, s28, -v195
    v_mfma_f32_16x16x32_bf16 v[156:159], a[152:155], a[56:59], v[156:159]
    ds_read_b128 a[152:155], v198 offset:12288
    v_fma_f32 v149, v149, s28, -v195
    v_mfma_f32_16x16x32_bf16 v[156:159], a[156:159], a[60:63], v[156:159]
    s_waitcnt lgkmcnt(7)
    ds_read_b128 a[156:159], v199 offset:12288
    v_fma_f32 v150, v150, s28, -v195
    v_mfma_f32_16x16x32_bf16 v[0:3], a[160:163], v[160:163], v[0:3]
    v_exp_f32 v145, v145
    v_mfma_f32_16x16x32_bf16 v[32:35], a[160:163], v[164:167], v[32:35]
    s_add_u32 m0, s34, 0x1c000
    v_exp_f32 v146, v146
    v_mfma_f32_16x16x32_bf16 v[4:7], a[164:167], v[160:163], v[4:7]
    buffer_load_dwordx4 v210, s[16:19], 0 offen nt lds
    buffer_load_dwordx4 v211, s[16:19], 0 offen offset:1024 nt lds
    v_mfma_f32_16x16x32_bf16 v[36:39], a[164:167], v[164:167], v[36:39]
    s_add_u32 s16, s16, 0x2000
    v_exp_f32 v147, v147
    v_mfma_f32_16x16x32_bf16 v[176:179], v[220:223], v[160:163], v[176:179]
    s_addc_u32 s17, s17, 0
    v_cvt_pk_bf16_f32 v168, v144, v145
    v_cvt_pk_bf16_f32 v169, v146, v147
    v_mfma_f32_16x16x32_bf16 v[8:11], a[168:171], v[160:163], v[8:11]
    v_exp_f32 v148, v148
    v_mfma_f32_16x16x32_bf16 v[180:183], v[220:223], v[164:167], v[180:183]
    s_add_u32 m0, s34, 0xe000
    v_exp_f32 v149, v149
    v_mfma_f32_16x16x32_bf16 v[40:43], a[168:171], v[164:167], v[40:43]
    buffer_load_dwordx4 v208, s[12:15], 0 offen nt lds
    buffer_load_dwordx4 v209, s[12:15], 0 offen offset:1024 nt lds
    v_mfma_f32_16x16x32_bf16 v[12:15], a[172:175], v[160:163], v[12:15]
    s_add_u32 s12, s12, 0xfe2000
    v_fma_f32 v151, v151, s28, -v195
    v_fma_f32 v152, v152, s28, -v194
    v_mfma_f32_16x16x32_bf16 v[44:47], a[172:175], v[164:167], v[44:47]
    s_addc_u32 s13, s13, 0
    v_exp_f32 v150, v150
    v_mfma_f32_16x16x32_bf16 v[16:19], a[176:179], v[160:163], v[16:19]
    v_exp_f32 v151, v151
    v_mfma_f32_16x16x32_bf16 v[48:51], a[176:179], v[164:167], v[48:51]
    s_add_u32 s38, s32, 0
    v_cvt_pk_bf16_f32 v172, v148, v149
    v_fma_f32 v153, v153, s28, -v194
    v_mfma_f32_16x16x32_bf16 v[20:23], a[180:183], v[160:163], v[20:23]
    buffer_store_dwordx4 a[204:207], v214, s[20:23], s38 offen offset:3072 sc1
    v_exp_f32 v152, v152
    v_fma_f32 v154, v154, s28, -v194
    v_mfma_f32_16x16x32_bf16 v[52:55], a[180:183], v[164:167], v[52:55]
    v_exp_f32 v153, v153
    v_mfma_f32_16x16x32_bf16 v[24:27], a[184:187], v[160:163], v[24:27]
    v_cvt_pk_bf16_f32 v173, v150, v151
    v_fma_f32 v155, v155, s28, -v194
    v_mfma_f32_16x16x32_bf16 v[56:59], a[184:187], v[164:167], v[56:59]
    v_exp_f32 v154, v154
    v_mfma_f32_16x16x32_bf16 v[28:31], a[188:191], v[160:163], v[28:31]
    v_fma_f32 v156, v156, s28, -v195
    v_cvt_pk_bf16_f32 v170, v152, v153
    v_mfma_f32_16x16x32_bf16 v[60:63], a[188:191], v[164:167], v[60:63]
    s_waitcnt lgkmcnt(0)
    v_exp_f32 v155, v155
    v_mfma_f32_16x16x32_bf16 v[128:131], a[128:131], a[0:3], 0
    v_fma_f32 v157, v157, s28, -v195
    v_fma_f32 v158, v158, s28, -v195
    v_mfma_f32_16x16x32_bf16 v[128:131], a[132:135], a[4:7], v[128:131]
    v_exp_f32 v156, v156
    v_mfma_f32_16x16x32_bf16 v[128:131], a[136:139], a[8:11], v[128:131]
    v_exp_f32 v157, v157
    v_mfma_f32_16x16x32_bf16 v[128:131], a[140:143], a[12:15], v[128:131]
    s_add_u32 s38, s32, 0x1000
    v_cvt_pk_bf16_f32 v171, v154, v155
    v_fma_f32 v159, v159, s28, -v195
    v_mfma_f32_16x16x32_bf16 v[132:135], a[128:131], a[16:19], 0
    buffer_store_dwordx4 a[208:211], v214, s[20:23], s38 offen sc1
    v_exp_f32 v158, v158
    v_cvt_pk_bf16_f32 v174, v156, v157
    v_mfma_f32_16x16x32_bf16 v[132:135], a[132:135], a[20:23], v[132:135]
    v_exp_f32 v159, v159
    v_mfma_f32_16x16x32_bf16 v[132:135], a[136:139], a[24:27], v[132:135]
    v_cvt_pk_bf16_f32 v175, v158, v159
    v_fma_f32 v128, v128, s28, -v192
    v_mfma_f32_16x16x32_bf16 v[132:135], a[140:143], a[28:31], v[132:135]
    v_fma_f32 v129, v129, s28, -v192
    v_fma_f32 v130, v130, s28, -v192
    v_mfma_f32_16x16x32_bf16 v[136:139], a[144:147], a[0:3], 0
    v_exp_f32 v128, v128
    v_mfma_f32_16x16x32_bf16 v[136:139], a[148:151], a[4:7], v[136:139]
    v_exp_f32 v129, v129
    v_mfma_f32_16x16x32_bf16 v[136:139], a[152:155], a[8:11], v[136:139]
    v_fma_f32 v131, v131, s28, -v192
    v_fma_f32 v132, v132, s28, -v193
    v_mfma_f32_16x16x32_bf16 v[136:139], a[156:159], a[12:15], v[136:139]
    v_exp_f32 v130, v130
    v_mfma_f32_16x16x32_bf16 v[140:143], a[144:147], a[16:19], 0
    v_exp_f32 v131, v131
    v_mfma_f32_16x16x32_bf16 v[140:143], a[148:151], a[20:23], v[140:143]
    v_cvt_pk_bf16_f32 v160, v128, v129
    v_fma_f32 v133, v133, s28, -v193
    v_mfma_f32_16x16x32_bf16 v[140:143], a[152:155], a[24:27], v[140:143]
    v_exp_f32 v132, v132
    v_mfma_f32_16x16x32_bf16 v[140:143], a[156:159], a[28:31], v[140:143]
    v_fma_f32 v134, v134, s28, -v193
    v_cvt_pk_bf16_f32 v161, v130, v131
    v_mfma_f32_16x16x32_bf16 v[64:67], a[160:163], v[168:171], v[64:67]
    v_exp_f32 v133, v133
    v_mfma_f32_16x16x32_bf16 v[96:99], a[160:163], v[172:175], v[96:99]
    ds_read_b64_tr_b16 a[160:161], v200 offset:8192
    v_fma_f32 v135, v135, s28, -v193
    v_mfma_f32_16x16x32_bf16 v[68:71], a[164:167], v[168:171], v[68:71]
    ds_read_b64_tr_b16 a[162:163], v200 offset:12288
    v_fma_f32 v136, v136, s28, -v192
    v_mfma_f32_16x16x32_bf16 v[100:103], a[164:167], v[172:175], v[100:103]
    ds_read_b64_tr_b16 a[164:165], v201 offset:8192
    v_cvt_pk_bf16_f32 v164, v132, v133
    v_mfma_f32_16x16x32_bf16 v[184:187], v[220:223], v[168:171], v[184:187]
    ds_read_b64_tr_b16 a[166:167], v201 offset:12288
    v_fma_f32 v137, v137, s28, -v192
    v_mfma_f32_16x16x32_bf16 v[72:75], a[168:171], v[168:171], v[72:75]
    v_exp_f32 v134, v134
    v_mfma_f32_16x16x32_bf16 v[188:191], v[220:223], v[172:175], v[188:191]
    v_exp_f32 v135, v135
    v_mfma_f32_16x16x32_bf16 v[104:107], a[168:171], v[172:175], v[104:107]
    ds_read_b64_tr_b16 a[168:169], v202 offset:8192
    v_fma_f32 v138, v138, s28, -v192
    v_mfma_f32_16x16x32_bf16 v[76:79], a[172:175], v[168:171], v[76:79]
    ds_read_b64_tr_b16 a[170:171], v202 offset:12288
    v_cvt_pk_bf16_f32 v165, v134, v135
    v_mfma_f32_16x16x32_bf16 v[108:111], a[172:175], v[172:175], v[108:111]
    ds_read_b64_tr_b16 a[172:173], v203 offset:8192
    v_fma_f32 v139, v139, s28, -v192
    v_mfma_f32_16x16x32_bf16 v[80:83], a[176:179], v[168:171], v[80:83]
    ds_read_b64_tr_b16 a[174:175], v203 offset:12288
    v_fma_f32 v140, v140, s28, -v193
    v_mfma_f32_16x16x32_bf16 v[112:115], a[176:179], v[172:175], v[112:115]
    ds_read_b64_tr_b16 a[176:177], v204 offset:8192
    v_fma_f32 v141, v141, s28, -v193
    v_mfma_f32_16x16x32_bf16 v[84:87], a[180:183], v[168:171], v[84:87]
    ds_read_b64_tr_b16 a[178:179], v204 offset:12288
    v_exp_f32 v136, v136
    v_mfma_f32_16x16x32_bf16 v[116:119], a[180:183], v[172:175], v[116:119]
    ds_read_b64_tr_b16 a[180:181], v205 offset:8192
    v_fma_f32 v142, v142, s28, -v193
    v_mfma_f32_16x16x32_bf16 v[88:91], a[184:187], v[168:171], v[88:91]
    ds_read_b64_tr_b16 a[182:183], v205 offset:12288
    v_exp_f32 v137, v137
    v_mfma_f32_16x16x32_bf16 v[120:123], a[184:187], v[172:175], v[120:123]
    ds_read_b64_tr_b16 a[184:185], v206 offset:8192
    v_cvt_pk_bf16_f32 v162, v136, v137
    v_mfma_f32_16x16x32_bf16 v[92:95], a[188:191], v[168:171], v[92:95]
    ds_read_b64_tr_b16 a[186:187], v206 offset:12288
    v_fma_f32 v143, v143, s28, -v193
    v_mfma_f32_16x16x32_bf16 v[124:127], a[188:191], v[172:175], v[124:127]
    ds_read_b64_tr_b16 a[188:189], v207 offset:8192
    v_exp_f32 v138, v138
    v_mfma_f32_16x16x32_bf16 v[144:147], a[128:131], a[32:35], 0
    ds_read_b64_tr_b16 a[190:191], v207 offset:12288
    v_exp_f32 v139, v139
    v_mfma_f32_16x16x32_bf16 v[144:147], a[132:135], a[36:39], v[144:147]
    v_exp_f32 v140, v140
    v_mfma_f32_16x16x32_bf16 v[144:147], a[136:139], a[40:43], v[144:147]
    v_exp_f32 v141, v141
    v_mfma_f32_16x16x32_bf16 v[144:147], a[140:143], a[44:47], v[144:147]
    v_cvt_pk_bf16_f32 v163, v138, v139
    v_cvt_pk_bf16_f32 v166, v140, v141
    v_mfma_f32_16x16x32_bf16 v[148:151], a[128:131], a[48:51], 0
    ds_read_b128 a[128:131], v196 offset:16384
    v_exp_f32 v142, v142
    v_mfma_f32_16x16x32_bf16 v[148:151], a[132:135], a[52:55], v[148:151]
    ds_read_b128 a[132:135], v197 offset:16384
    v_exp_f32 v143, v143
    v_mfma_f32_16x16x32_bf16 v[148:151], a[136:139], a[56:59], v[148:151]
    ds_read_b128 a[136:139], v198 offset:16384
    v_cvt_pk_bf16_f32 v167, v142, v143
    v_mfma_f32_16x16x32_bf16 v[148:151], a[140:143], a[60:63], v[148:151]
    ds_read_b128 a[140:143], v199 offset:16384
    v_fma_f32 v144, v144, s28, -v194
    v_mfma_f32_16x16x32_bf16 v[152:155], a[144:147], a[32:35], 0
    v_fma_f32 v145, v145, s28, -v194
    v_fma_f32 v146, v146, s28, -v194
    v_mfma_f32_16x16x32_bf16 v[152:155], a[148:151], a[36:39], v[152:155]
    v_exp_f32 v144, v144
    v_mfma_f32_16x16x32_bf16 v[152:155], a[152:155], a[40:43], v[152:155]
    v_exp_f32 v145, v145
    v_mfma_f32_16x16x32_bf16 v[152:155], a[156:159], a[44:47], v[152:155]
    v_fma_f32 v147, v147, s28, -v194
    v_fma_f32 v148, v148, s28, -v195
    v_mfma_f32_16x16x32_bf16 v[156:159], a[144:147], a[48:51], 0
    ds_read_b128 a[144:147], v196 offset:20480
    v_cvt_pk_bf16_f32 v168, v144, v145
    v_mfma_f32_16x16x32_bf16 v[156:159], a[148:151], a[52:55], v[156:159]
    ds_read_b128 a[148:151], v197 offset:20480
    v_fma_f32 v149, v149, s28, -v195
    v_mfma_f32_16x16x32_bf16 v[156:159], a[152:155], a[56:59], v[156:159]
    ds_read_b128 a[152:155], v198 offset:20480
    v_fma_f32 v150, v150, s28, -v195
    v_mfma_f32_16x16x32_bf16 v[156:159], a[156:159], a[60:63], v[156:159]
    s_waitcnt lgkmcnt(7)
    ds_read_b128 a[156:159], v199 offset:20480
    v_fma_f32 v151, v151, s28, -v195
    v_mfma_f32_16x16x32_bf16 v[0:3], a[160:163], v[160:163], v[0:3]
    v_exp_f32 v146, v146
    v_mfma_f32_16x16x32_bf16 v[32:35], a[160:163], v[164:167], v[32:35]
    s_add_u32 m0, s34, 0x1e000
    v_exp_f32 v147, v147
    v_mfma_f32_16x16x32_bf16 v[4:7], a[164:167], v[160:163], v[4:7]
    buffer_load_dwordx4 v210, s[16:19], 0 offen nt lds
    buffer_load_dwordx4 v211, s[16:19], 0 offen offset:1024 nt lds
    v_mfma_f32_16x16x32_bf16 v[36:39], a[164:167], v[164:167], v[36:39]
    s_add_u32 s16, s16, 0xfe2000
    v_exp_f32 v148, v148
    v_mfma_f32_16x16x32_bf16 v[176:179], v[220:223], v[160:163], v[176:179]
    s_addc_u32 s17, s17, 0
    v_exp_f32 v149, v149
    v_mfma_f32_16x16x32_bf16 v[8:11], a[168:171], v[160:163], v[8:11]
    v_cvt_pk_bf16_f32 v169, v146, v147
    v_fma_f32 v152, v152, s28, -v194
    v_mfma_f32_16x16x32_bf16 v[180:183], v[220:223], v[164:167], v[180:183]
    v_exp_f32 v150, v150
    v_mfma_f32_16x16x32_bf16 v[40:43], a[168:171], v[164:167], v[40:43]
    v_exp_f32 v151, v151
    v_mfma_f32_16x16x32_bf16 v[12:15], a[172:175], v[160:163], v[12:15]
    v_cvt_pk_bf16_f32 v172, v148, v149
    v_fma_f32 v153, v153, s28, -v194
    v_mfma_f32_16x16x32_bf16 v[44:47], a[172:175], v[164:167], v[44:47]
    v_exp_f32 v152, v152
    v_mfma_f32_16x16x32_bf16 v[16:19], a[176:179], v[160:163], v[16:19]
    v_fma_f32 v154, v154, s28, -v194
    v_cvt_pk_bf16_f32 v173, v150, v151
    v_mfma_f32_16x16x32_bf16 v[48:51], a[176:179], v[164:167], v[48:51]
    s_add_u32 s38, s32, 0x1000
    v_exp_f32 v153, v153
    v_mfma_f32_16x16x32_bf16 v[20:23], a[180:183], v[160:163], v[20:23]
    buffer_store_dwordx4 a[212:215], v214, s[20:23], s38 offen offset:1024 sc1
    v_fma_f32 v155, v155, s28, -v194
    v_exp_f32 v154, v154
    v_mfma_f32_16x16x32_bf16 v[52:55], a[180:183], v[164:167], v[52:55]
    v_fma_f32 v156, v156, s28, -v195
    v_cvt_pk_bf16_f32 v170, v152, v153
    v_mfma_f32_16x16x32_bf16 v[24:27], a[184:187], v[160:163], v[24:27]
    v_exp_f32 v155, v155
    v_mfma_f32_16x16x32_bf16 v[56:59], a[184:187], v[164:167], v[56:59]
    v_fma_f32 v157, v157, s28, -v195
    v_fma_f32 v158, v158, s28, -v195
    v_mfma_f32_16x16x32_bf16 v[28:31], a[188:191], v[160:163], v[28:31]
    v_exp_f32 v156, v156
    v_mfma_f32_16x16x32_bf16 v[60:63], a[188:191], v[164:167], v[60:63]
    s_waitcnt lgkmcnt(0)
    v_exp_f32 v157, v157
    v_mfma_f32_16x16x32_bf16 v[128:131], a[128:131], a[0:3], 0
    v_cvt_pk_bf16_f32 v171, v154, v155
    v_fma_f32 v159, v159, s28, -v195
    v_mfma_f32_16x16x32_bf16 v[128:131], a[132:135], a[4:7], v[128:131]
    s_add_u32 s38, s32, 0x1000
    v_exp_f32 v158, v158
    v_mfma_f32_16x16x32_bf16 v[128:131], a[136:139], a[8:11], v[128:131]
    buffer_store_dwordx4 a[216:219], v214, s[20:23], s38 offen offset:2048 sc1
    v_exp_f32 v159, v159
    v_cvt_pk_bf16_f32 v174, v156, v157
    v_mfma_f32_16x16x32_bf16 v[128:131], a[140:143], a[12:15], v[128:131]
    v_cvt_pk_bf16_f32 v175, v158, v159
    v_mfma_f32_16x16x32_bf16 v[132:135], a[128:131], a[16:19], 0
    v_mfma_f32_16x16x32_bf16 v[132:135], a[132:135], a[20:23], v[132:135]
    v_mfma_f32_16x16x32_bf16 v[132:135], a[136:139], a[24:27], v[132:135]
    v_mfma_f32_16x16x32_bf16 v[132:135], a[140:143], a[28:31], v[132:135]
    v_mfma_f32_16x16x32_bf16 v[136:139], a[144:147], a[0:3], 0
    s_add_u32 s38, s32, 0x1000
    v_mfma_f32_16x16x32_bf16 v[136:139], a[148:151], a[4:7], v[136:139]
    buffer_store_dwordx4 a[220:223], v214, s[20:23], s38 offen offset:3072 sc1
    v_fma_f32 v128, v128, s28, -v192
    v_fma_f32 v129, v129, s28, -v192
    v_fma_f32 v130, v130, s28, -v192
    v_mfma_f32_16x16x32_bf16 v[136:139], a[152:155], a[8:11], v[136:139]
    v_exp_f32 v128, v128
    v_mfma_f32_16x16x32_bf16 v[136:139], a[156:159], a[12:15], v[136:139]
    v_exp_f32 v129, v129
    v_mfma_f32_16x16x32_bf16 v[140:143], a[144:147], a[16:19], 0
    v_fma_f32 v131, v131, s28, -v192
    v_fma_f32 v132, v132, s28, -v193
    v_mfma_f32_16x16x32_bf16 v[140:143], a[148:151], a[20:23], v[140:143]
    v_exp_f32 v130, v130
    v_mfma_f32_16x16x32_bf16 v[140:143], a[152:155], a[24:27], v[140:143]
    s_waitcnt vmcnt(26)
    s_barrier
    v_exp_f32 v131, v131
    v_mfma_f32_16x16x32_bf16 v[140:143], a[156:159], a[28:31], v[140:143]
    v_cvt_pk_bf16_f32 v160, v128, v129
    v_fma_f32 v133, v133, s28, -v193
    v_mfma_f32_16x16x32_bf16 v[64:67], a[160:163], v[168:171], v[64:67]
    v_exp_f32 v132, v132
    v_mfma_f32_16x16x32_bf16 v[96:99], a[160:163], v[172:175], v[96:99]
    ds_read_b64_tr_b16 a[160:161], v200 offset:16384
    v_fma_f32 v134, v134, s28, -v193
    v_mfma_f32_16x16x32_bf16 v[68:71], a[164:167], v[168:171], v[68:71]
    ds_read_b64_tr_b16 a[162:163], v200 offset:20480
    v_cvt_pk_bf16_f32 v161, v130, v131
    v_mfma_f32_16x16x32_bf16 v[100:103], a[164:167], v[172:175], v[100:103]
    ds_read_b64_tr_b16 a[164:165], v201 offset:16384
    v_fma_f32 v135, v135, s28, -v193
    v_mfma_f32_16x16x32_bf16 v[184:187], v[220:223], v[168:171], v[184:187]
    ds_read_b64_tr_b16 a[166:167], v201 offset:20480
    v_fma_f32 v136, v136, s28, -v192
    v_mfma_f32_16x16x32_bf16 v[72:75], a[168:171], v[168:171], v[72:75]
    v_exp_f32 v133, v133
    v_mfma_f32_16x16x32_bf16 v[188:191], v[220:223], v[172:175], v[188:191]
    v_exp_f32 v134, v134
    v_mfma_f32_16x16x32_bf16 v[104:107], a[168:171], v[172:175], v[104:107]
    ds_read_b64_tr_b16 a[168:169], v202 offset:16384
    v_cvt_pk_bf16_f32 v164, v132, v133
    v_mfma_f32_16x16x32_bf16 v[76:79], a[172:175], v[168:171], v[76:79]
    ds_read_b64_tr_b16 a[170:171], v202 offset:20480
    v_fma_f32 v137, v137, s28, -v192
    v_mfma_f32_16x16x32_bf16 v[108:111], a[172:175], v[172:175], v[108:111]
    ds_read_b64_tr_b16 a[172:173], v203 offset:16384
    v_fma_f32 v138, v138, s28, -v192
    v_mfma_f32_16x16x32_bf16 v[80:83], a[176:179], v[168:171], v[80:83]
    ds_read_b64_tr_b16 a[174:175], v203 offset:20480
    v_fma_f32 v139, v139, s28, -v192
    v_mfma_f32_16x16x32_bf16 v[112:115], a[176:179], v[172:175], v[112:115]
    ds_read_b64_tr_b16 a[176:177], v204 offset:16384
    v_fma_f32 v140, v140, s28, -v193
    v_mfma_f32_16x16x32_bf16 v[84:87], a[180:183], v[168:171], v[84:87]
    ds_read_b64_tr_b16 a[178:179], v204 offset:20480
    v_exp_f32 v135, v135
    v_mfma_f32_16x16x32_bf16 v[116:119], a[180:183], v[172:175], v[116:119]
    ds_read_b64_tr_b16 a[180:181], v205 offset:16384
    v_cvt_pk_bf16_f32 v165, v134, v135
    v_mfma_f32_16x16x32_bf16 v[88:91], a[184:187], v[168:171], v[88:91]
    ds_read_b64_tr_b16 a[182:183], v205 offset:20480
    v_fma_f32 v141, v141, s28, -v193
    v_mfma_f32_16x16x32_bf16 v[120:123], a[184:187], v[172:175], v[120:123]
    ds_read_b64_tr_b16 a[184:185], v206 offset:16384
    v_exp_f32 v136, v136
    v_mfma_f32_16x16x32_bf16 v[92:95], a[188:191], v[168:171], v[92:95]
    ds_read_b64_tr_b16 a[186:187], v206 offset:20480
    v_fma_f32 v142, v142, s28, -v193
    v_mfma_f32_16x16x32_bf16 v[124:127], a[188:191], v[172:175], v[124:127]
    ds_read_b64_tr_b16 a[188:189], v207 offset:16384
    v_exp_f32 v137, v137
    v_mfma_f32_16x16x32_bf16 v[144:147], a[128:131], a[32:35], 0
    ds_read_b64_tr_b16 a[190:191], v207 offset:20480
    v_cvt_pk_bf16_f32 v162, v136, v137
    v_mfma_f32_16x16x32_bf16 v[144:147], a[132:135], a[36:39], v[144:147]
    v_exp_f32 v138, v138
    v_mfma_f32_16x16x32_bf16 v[144:147], a[136:139], a[40:43], v[144:147]
    v_exp_f32 v139, v139
    v_mfma_f32_16x16x32_bf16 v[144:147], a[140:143], a[44:47], v[144:147]
    v_exp_f32 v140, v140
    v_mfma_f32_16x16x32_bf16 v[148:151], a[128:131], a[48:51], 0
    ds_read_b128 a[128:131], v196 offset:24576
    v_cvt_pk_bf16_f32 v163, v138, v139
    v_mfma_f32_16x16x32_bf16 v[148:151], a[132:135], a[52:55], v[148:151]
    ds_read_b128 a[132:135], v197 offset:24576
    v_fma_f32 v143, v143, s28, -v193
    v_mfma_f32_16x16x32_bf16 v[148:151], a[136:139], a[56:59], v[148:151]
    ds_read_b128 a[136:139], v198 offset:24576
    v_fma_f32 v144, v144, s28, -v194
    v_mfma_f32_16x16x32_bf16 v[148:151], a[140:143], a[60:63], v[148:151]
    ds_read_b128 a[140:143], v199 offset:24576
    v_fma_f32 v145, v145, s28, -v194
    v_mfma_f32_16x16x32_bf16 v[152:155], a[144:147], a[32:35], 0
    v_exp_f32 v141, v141
    v_mfma_f32_16x16x32_bf16 v[152:155], a[148:151], a[36:39], v[152:155]
    v_exp_f32 v142, v142
    v_mfma_f32_16x16x32_bf16 v[152:155], a[152:155], a[40:43], v[152:155]
    v_exp_f32 v143, v143
    v_mfma_f32_16x16x32_bf16 v[152:155], a[156:159], a[44:47], v[152:155]
    v_cvt_pk_bf16_f32 v166, v140, v141
    v_cvt_pk_bf16_f32 v167, v142, v143
    v_mfma_f32_16x16x32_bf16 v[156:159], a[144:147], a[48:51], 0
    ds_read_b128 a[144:147], v196 offset:28672
    v_fma_f32 v146, v146, s28, -v194
    v_mfma_f32_16x16x32_bf16 v[156:159], a[148:151], a[52:55], v[156:159]
    ds_read_b128 a[148:151], v197 offset:28672
    v_fma_f32 v147, v147, s28, -v194
    v_mfma_f32_16x16x32_bf16 v[156:159], a[152:155], a[56:59], v[156:159]
    ds_read_b128 a[152:155], v198 offset:28672
    v_fma_f32 v148, v148, s28, -v195
    v_mfma_f32_16x16x32_bf16 v[156:159], a[156:159], a[60:63], v[156:159]
    s_waitcnt lgkmcnt(7)
    ds_read_b128 a[156:159], v199 offset:28672
    v_fma_f32 v149, v149, s28, -v195
    v_mfma_f32_16x16x32_bf16 v[0:3], a[160:163], v[160:163], v[0:3]
    v_exp_f32 v144, v144
    v_mfma_f32_16x16x32_bf16 v[32:35], a[160:163], v[164:167], v[32:35]
    v_exp_f32 v145, v145
    v_mfma_f32_16x16x32_bf16 v[4:7], a[164:167], v[160:163], v[4:7]
    v_exp_f32 v146, v146
    v_mfma_f32_16x16x32_bf16 v[36:39], a[164:167], v[164:167], v[36:39]
    v_exp_f32 v147, v147
    v_mfma_f32_16x16x32_bf16 v[176:179], v[220:223], v[160:163], v[176:179]
    v_cvt_pk_bf16_f32 v168, v144, v145
    v_fma_f32 v150, v150, s28, -v195
    v_mfma_f32_16x16x32_bf16 v[8:11], a[168:171], v[160:163], v[8:11]
    v_exp_f32 v148, v148
    v_mfma_f32_16x16x32_bf16 v[180:183], v[220:223], v[164:167], v[180:183]
    v_exp_f32 v149, v149
    v_mfma_f32_16x16x32_bf16 v[40:43], a[168:171], v[164:167], v[40:43]
    v_cvt_pk_bf16_f32 v169, v146, v147
    v_fma_f32 v151, v151, s28, -v195
    v_mfma_f32_16x16x32_bf16 v[12:15], a[172:175], v[160:163], v[12:15]
    v_exp_f32 v150, v150
    v_mfma_f32_16x16x32_bf16 v[44:47], a[172:175], v[164:167], v[44:47]
    v_fma_f32 v152, v152, s28, -v194
    v_cvt_pk_bf16_f32 v172, v148, v149
    v_mfma_f32_16x16x32_bf16 v[16:19], a[176:179], v[160:163], v[16:19]
    v_exp_f32 v151, v151
    v_mfma_f32_16x16x32_bf16 v[48:51], a[176:179], v[164:167], v[48:51]
    v_fma_f32 v153, v153, s28, -v194
    v_fma_f32 v154, v154, s28, -v194
    v_mfma_f32_16x16x32_bf16 v[20:23], a[180:183], v[160:163], v[20:23]
    s_waitcnt lgkmcnt(15)
    v_exp_f32 v152, v152
    v_mfma_f32_16x16x32_bf16 v[52:55], a[180:183], v[164:167], v[52:55]
    s_add_u32 s38, s32, 0x2000
    v_exp_f32 v153, v153
    v_mfma_f32_16x16x32_bf16 v[24:27], a[184:187], v[160:163], v[24:27]
    buffer_store_dwordx4 a[64:67], v214, s[20:23], s38 offen sc1
    v_cvt_pk_bf16_f32 v173, v150, v151
    v_fma_f32 v155, v155, s28, -v194
    v_fma_f32 v156, v156, s28, -v195
    v_mfma_f32_16x16x32_bf16 v[56:59], a[184:187], v[164:167], v[56:59]
    v_exp_f32 v154, v154
    v_mfma_f32_16x16x32_bf16 v[28:31], a[188:191], v[160:163], v[28:31]
    v_exp_f32 v155, v155
    v_mfma_f32_16x16x32_bf16 v[60:63], a[188:191], v[164:167], v[60:63]
    s_waitcnt lgkmcnt(0)
    v_cvt_pk_bf16_f32 v170, v152, v153
    v_fma_f32 v157, v157, s28, -v195
    v_mfma_f32_16x16x32_bf16 v[128:131], a[128:131], a[0:3], 0
    v_exp_f32 v156, v156
    v_mfma_f32_16x16x32_bf16 v[128:131], a[132:135], a[4:7], v[128:131]
    v_fma_f32 v158, v158, s28, -v195
    v_cvt_pk_bf16_f32 v171, v154, v155
    v_mfma_f32_16x16x32_bf16 v[128:131], a[136:139], a[8:11], v[128:131]
    v_exp_f32 v157, v157
    v_mfma_f32_16x16x32_bf16 v[128:131], a[140:143], a[12:15], v[128:131]
    s_add_u32 s38, s32, 0x2000
    v_fma_f32 v159, v159, s28, -v195
    v_cvt_pk_bf16_f32 v174, v156, v157
    v_mfma_f32_16x16x32_bf16 v[132:135], a[128:131], a[16:19], 0
    buffer_store_dwordx4 a[68:71], v214, s[20:23], s38 offen offset:1024 sc1
    v_exp_f32 v158, v158
    v_exp_f32 v159, v159
    v_mfma_f32_16x16x32_bf16 v[132:135], a[132:135], a[20:23], v[132:135]
    v_cvt_pk_bf16_f32 v175, v158, v159
    v_fma_f32 v128, v128, s28, -v192
    v_mfma_f32_16x16x32_bf16 v[132:135], a[136:139], a[24:27], v[132:135]
    v_fma_f32 v129, v129, s28, -v192
    v_fma_f32 v130, v130, s28, -v192
    v_mfma_f32_16x16x32_bf16 v[132:135], a[140:143], a[28:31], v[132:135]
    v_exp_f32 v128, v128
    v_mfma_f32_16x16x32_bf16 v[136:139], a[144:147], a[0:3], 0
    v_exp_f32 v129, v129
    v_mfma_f32_16x16x32_bf16 v[136:139], a[148:151], a[4:7], v[136:139]
    v_fma_f32 v131, v131, s28, -v192
    v_cvt_pk_bf16_f32 v160, v128, v129
    v_mfma_f32_16x16x32_bf16 v[136:139], a[152:155], a[8:11], v[136:139]
    v_exp_f32 v130, v130
    v_mfma_f32_16x16x32_bf16 v[136:139], a[156:159], a[12:15], v[136:139]
    v_fma_f32 v132, v132, s28, -v193
    v_fma_f32 v133, v133, s28, -v193
    v_mfma_f32_16x16x32_bf16 v[140:143], a[144:147], a[16:19], 0
    v_exp_f32 v131, v131
    v_mfma_f32_16x16x32_bf16 v[140:143], a[148:151], a[20:23], v[140:143]
    v_exp_f32 v132, v132
    v_mfma_f32_16x16x32_bf16 v[140:143], a[152:155], a[24:27], v[140:143]
    v_fma_f32 v134, v134, s28, -v193
    v_cvt_pk_bf16_f32 v161, v130, v131
    v_mfma_f32_16x16x32_bf16 v[140:143], a[156:159], a[28:31], v[140:143]
    v_exp_f32 v133, v133
    v_mfma_f32_16x16x32_bf16 v[64:67], a[160:163], v[168:171], v[64:67]
    v_fma_f32 v135, v135, s28, -v193
    v_fma_f32 v136, v136, s28, -v192
    v_mfma_f32_16x16x32_bf16 v[96:99], a[160:163], v[172:175], v[96:99]
    ds_read_b64_tr_b16 a[160:161], v200 offset:24576
    v_cvt_pk_bf16_f32 v164, v132, v133
    v_mfma_f32_16x16x32_bf16 v[68:71], a[164:167], v[168:171], v[68:71]
    ds_read_b64_tr_b16 a[162:163], v200 offset:28672
    v_fma_f32 v137, v137, s28, -v192
    v_mfma_f32_16x16x32_bf16 v[100:103], a[164:167], v[172:175], v[100:103]
    ds_read_b64_tr_b16 a[164:165], v201 offset:24576
    v_fma_f32 v138, v138, s28, -v192
    v_mfma_f32_16x16x32_bf16 v[184:187], v[220:223], v[168:171], v[184:187]
    ds_read_b64_tr_b16 a[166:167], v201 offset:28672
    v_fma_f32 v139, v139, s28, -v192
    v_mfma_f32_16x16x32_bf16 v[72:75], a[168:171], v[168:171], v[72:75]
    v_exp_f32 v134, v134
    v_mfma_f32_16x16x32_bf16 v[188:191], v[220:223], v[172:175], v[188:191]
    v_exp_f32 v135, v135
    v_mfma_f32_16x16x32_bf16 v[104:107], a[168:171], v[172:175], v[104:107]
    ds_read_b64_tr_b16 a[168:169], v202 offset:24576
    v_cvt_pk_bf16_f32 v165, v134, v135
    v_mfma_f32_16x16x32_bf16 v[76:79], a[172:175], v[168:171], v[76:79]
    ds_read_b64_tr_b16 a[170:171], v202 offset:28672
    v_fma_f32 v140, v140, s28, -v193
    v_mfma_f32_16x16x32_bf16 v[108:111], a[172:175], v[172:175], v[108:111]
    ds_read_b64_tr_b16 a[172:173], v203 offset:24576
    v_fma_f32 v141, v141, s28, -v193
    v_mfma_f32_16x16x32_bf16 v[80:83], a[176:179], v[168:171], v[80:83]
    ds_read_b64_tr_b16 a[174:175], v203 offset:28672
    v_exp_f32 v136, v136
    v_mfma_f32_16x16x32_bf16 v[112:115], a[176:179], v[172:175], v[112:115]
    ds_read_b64_tr_b16 a[176:177], v204 offset:24576
    v_fma_f32 v142, v142, s28, -v193
    v_mfma_f32_16x16x32_bf16 v[84:87], a[180:183], v[168:171], v[84:87]
    ds_read_b64_tr_b16 a[178:179], v204 offset:28672
    v_exp_f32 v137, v137
    v_mfma_f32_16x16x32_bf16 v[116:119], a[180:183], v[172:175], v[116:119]
    ds_read_b64_tr_b16 a[180:181], v205 offset:24576
    v_cvt_pk_bf16_f32 v162, v136, v137
    v_mfma_f32_16x16x32_bf16 v[88:91], a[184:187], v[168:171], v[88:91]
    ds_read_b64_tr_b16 a[182:183], v205 offset:28672
    v_fma_f32 v143, v143, s28, -v193
    v_mfma_f32_16x16x32_bf16 v[120:123], a[184:187], v[172:175], v[120:123]
    ds_read_b64_tr_b16 a[184:185], v206 offset:24576
    v_exp_f32 v138, v138
    v_mfma_f32_16x16x32_bf16 v[92:95], a[188:191], v[168:171], v[92:95]
    ds_read_b64_tr_b16 a[186:187], v206 offset:28672
    v_exp_f32 v139, v139
    v_mfma_f32_16x16x32_bf16 v[124:127], a[188:191], v[172:175], v[124:127]
    ds_read_b64_tr_b16 a[188:189], v207 offset:24576
    v_cvt_pk_bf16_f32 v163, v138, v139
    v_mfma_f32_16x16x32_bf16 v[144:147], a[128:131], a[32:35], 0
    ds_read_b64_tr_b16 a[190:191], v207 offset:28672
    v_exp_f32 v140, v140
    v_mfma_f32_16x16x32_bf16 v[144:147], a[132:135], a[36:39], v[144:147]
    v_exp_f32 v141, v141
    v_mfma_f32_16x16x32_bf16 v[144:147], a[136:139], a[40:43], v[144:147]
    v_exp_f32 v142, v142
    v_mfma_f32_16x16x32_bf16 v[144:147], a[140:143], a[44:47], v[144:147]
    v_exp_f32 v143, v143
    v_mfma_f32_16x16x32_bf16 v[148:151], a[128:131], a[48:51], 0
    ds_read_b128 a[128:131], v196 offset:32768
    v_cvt_pk_bf16_f32 v166, v140, v141
    v_mfma_f32_16x16x32_bf16 v[148:151], a[132:135], a[52:55], v[148:151]
    ds_read_b128 a[132:135], v197 offset:32768
    v_cvt_pk_bf16_f32 v167, v142, v143
    v_mfma_f32_16x16x32_bf16 v[148:151], a[136:139], a[56:59], v[148:151]
    ds_read_b128 a[136:139], v198 offset:32768
    v_fma_f32 v144, v144, s28, -v194
    v_mfma_f32_16x16x32_bf16 v[148:151], a[140:143], a[60:63], v[148:151]
    ds_read_b128 a[140:143], v199 offset:32768
    v_fma_f32 v145, v145, s28, -v194
    v_mfma_f32_16x16x32_bf16 v[152:155], a[144:147], a[32:35], 0
    v_exp_f32 v144, v144
    v_mfma_f32_16x16x32_bf16 v[152:155], a[148:151], a[36:39], v[152:155]
    v_fma_f32 v146, v146, s28, -v194
    v_fma_f32 v147, v147, s28, -v194
    v_mfma_f32_16x16x32_bf16 v[152:155], a[152:155], a[40:43], v[152:155]
    v_exp_f32 v145, v145
    v_mfma_f32_16x16x32_bf16 v[152:155], a[156:159], a[44:47], v[152:155]
    v_exp_f32 v146, v146
    v_mfma_f32_16x16x32_bf16 v[156:159], a[144:147], a[48:51], 0
    ds_read_b128 a[144:147], v196 offset:36864
    v_fma_f32 v148, v148, s28, -v195
    v_mfma_f32_16x16x32_bf16 v[156:159], a[148:151], a[52:55], v[156:159]
    ds_read_b128 a[148:151], v197 offset:36864
    v_cvt_pk_bf16_f32 v168, v144, v145
    v_mfma_f32_16x16x32_bf16 v[156:159], a[152:155], a[56:59], v[156:159]
    ds_read_b128 a[152:155], v198 offset:36864
    v_fma_f32 v149, v149, s28, -v195
    v_mfma_f32_16x16x32_bf16 v[156:159], a[156:159], a[60:63], v[156:159]
    s_waitcnt lgkmcnt(7)
    ds_read_b128 a[156:159], v199 offset:36864
    v_fma_f32 v150, v150, s28, -v195
    v_mfma_f32_16x16x32_bf16 v[0:3], a[160:163], v[160:163], v[0:3]
    v_exp_f32 v147, v147
    v_mfma_f32_16x16x32_bf16 v[32:35], a[160:163], v[164:167], v[32:35]
    v_exp_f32 v148, v148
    v_mfma_f32_16x16x32_bf16 v[4:7], a[164:167], v[160:163], v[4:7]
    v_exp_f32 v149, v149
    v_mfma_f32_16x16x32_bf16 v[36:39], a[164:167], v[164:167], v[36:39]
    v_cvt_pk_bf16_f32 v169, v146, v147
    v_fma_f32 v151, v151, s28, -v195
    v_mfma_f32_16x16x32_bf16 v[176:179], v[220:223], v[160:163], v[176:179]
    v_exp_f32 v150, v150
    v_mfma_f32_16x16x32_bf16 v[8:11], a[168:171], v[160:163], v[8:11]
    v_fma_f32 v152, v152, s28, -v194
    v_cvt_pk_bf16_f32 v172, v148, v149
    v_mfma_f32_16x16x32_bf16 v[180:183], v[220:223], v[164:167], v[180:183]
    v_exp_f32 v151, v151
    v_mfma_f32_16x16x32_bf16 v[40:43], a[168:171], v[164:167], v[40:43]
    v_fma_f32 v153, v153, s28, -v194
    v_fma_f32 v154, v154, s28, -v194
    v_mfma_f32_16x16x32_bf16 v[12:15], a[172:175], v[160:163], v[12:15]
    v_exp_f32 v152, v152
    v_mfma_f32_16x16x32_bf16 v[44:47], a[172:175], v[164:167], v[44:47]
    v_exp_f32 v153, v153
    v_mfma_f32_16x16x32_bf16 v[16:19], a[176:179], v[160:163], v[16:19]
    v_cvt_pk_bf16_f32 v173, v150, v151
    v_fma_f32 v155, v155, s28, -v194
    v_mfma_f32_16x16x32_bf16 v[48:51], a[176:179], v[164:167], v[48:51]
    s_add_u32 s38, s32, 0x2000
    v_exp_f32 v154, v154
    v_mfma_f32_16x16x32_bf16 v[20:23], a[180:183], v[160:163], v[20:23]
    buffer_store_dwordx4 a[72:75], v214, s[20:23], s38 offen offset:2048 sc1
    v_fma_f32 v156, v156, s28, -v195
    v_exp_f32 v155, v155
    v_mfma_f32_16x16x32_bf16 v[52:55], a[180:183], v[164:167], v[52:55]
    v_cvt_pk_bf16_f32 v170, v152, v153
    v_fma_f32 v157, v157, s28, -v195
    v_mfma_f32_16x16x32_bf16 v[24:27], a[184:187], v[160:163], v[24:27]
    v_exp_f32 v156, v156
    v_mfma_f32_16x16x32_bf16 v[56:59], a[184:187], v[164:167], v[56:59]
    v_fma_f32 v158, v158, s28, -v195
    v_cvt_pk_bf16_f32 v171, v154, v155
    v_mfma_f32_16x16x32_bf16 v[28:31], a[188:191], v[160:163], v[28:31]
    v_exp_f32 v157, v157
    v_mfma_f32_16x16x32_bf16 v[60:63], a[188:191], v[164:167], v[60:63]
    s_waitcnt lgkmcnt(0)
    v_fma_f32 v159, v159, s28, -v195
    v_cvt_pk_bf16_f32 v174, v156, v157
    v_mfma_f32_16x16x32_bf16 v[128:131], a[128:131], a[0:3], 0
    v_exp_f32 v158, v158
    v_mfma_f32_16x16x32_bf16 v[128:131], a[132:135], a[4:7], v[128:131]
    v_exp_f32 v159, v159
    v_mfma_f32_16x16x32_bf16 v[128:131], a[136:139], a[8:11], v[128:131]
    v_cvt_pk_bf16_f32 v175, v158, v159
    v_mfma_f32_16x16x32_bf16 v[128:131], a[140:143], a[12:15], v[128:131]
    s_add_u32 s38, s32, 0x2000
    v_mfma_f32_16x16x32_bf16 v[132:135], a[128:131], a[16:19], 0
    buffer_store_dwordx4 a[76:79], v214, s[20:23], s38 offen offset:3072 sc1
    v_mfma_f32_16x16x32_bf16 v[132:135], a[132:135], a[20:23], v[132:135]
    v_mfma_f32_16x16x32_bf16 v[132:135], a[136:139], a[24:27], v[132:135]
    v_mfma_f32_16x16x32_bf16 v[132:135], a[140:143], a[28:31], v[132:135]
    v_mfma_f32_16x16x32_bf16 v[136:139], a[144:147], a[0:3], 0
    v_mfma_f32_16x16x32_bf16 v[136:139], a[148:151], a[4:7], v[136:139]
    v_fma_f32 v128, v128, s28, -v192
    v_fma_f32 v129, v129, s28, -v192
    v_mfma_f32_16x16x32_bf16 v[136:139], a[152:155], a[8:11], v[136:139]
    v_exp_f32 v128, v128
    v_mfma_f32_16x16x32_bf16 v[136:139], a[156:159], a[12:15], v[136:139]
    v_fma_f32 v130, v130, s28, -v192
    v_fma_f32 v131, v131, s28, -v192
    v_mfma_f32_16x16x32_bf16 v[140:143], a[144:147], a[16:19], 0
    v_exp_f32 v129, v129
    v_mfma_f32_16x16x32_bf16 v[140:143], a[148:151], a[20:23], v[140:143]
    v_exp_f32 v130, v130
    v_mfma_f32_16x16x32_bf16 v[140:143], a[152:155], a[24:27], v[140:143]
    s_waitcnt vmcnt(17)
    s_barrier
    v_fma_f32 v132, v132, s28, -v193
    v_mfma_f32_16x16x32_bf16 v[140:143], a[156:159], a[28:31], v[140:143]
    v_exp_f32 v131, v131
    v_mfma_f32_16x16x32_bf16 v[64:67], a[160:163], v[168:171], v[64:67]
    v_cvt_pk_bf16_f32 v160, v128, v129
    v_fma_f32 v133, v133, s28, -v193
    v_mfma_f32_16x16x32_bf16 v[96:99], a[160:163], v[172:175], v[96:99]
    ds_read_b64_tr_b16 a[160:161], v200 offset:32768
    v_fma_f32 v134, v134, s28, -v193
    v_mfma_f32_16x16x32_bf16 v[68:71], a[164:167], v[168:171], v[68:71]
    ds_read_b64_tr_b16 a[162:163], v200 offset:36864
    v_cvt_pk_bf16_f32 v161, v130, v131
    v_mfma_f32_16x16x32_bf16 v[100:103], a[164:167], v[172:175], v[100:103]
    ds_read_b64_tr_b16 a[164:165], v201 offset:32768
    v_fma_f32 v135, v135, s28, -v193
    v_mfma_f32_16x16x32_bf16 v[184:187], v[220:223], v[168:171], v[184:187]
    ds_read_b64_tr_b16 a[166:167], v201 offset:36864
    v_fma_f32 v136, v136, s28, -v192
    v_mfma_f32_16x16x32_bf16 v[72:75], a[168:171], v[168:171], v[72:75]
    v_exp_f32 v132, v132
    v_mfma_f32_16x16x32_bf16 v[188:191], v[220:223], v[172:175], v[188:191]
    v_exp_f32 v133, v133
    v_mfma_f32_16x16x32_bf16 v[104:107], a[168:171], v[172:175], v[104:107]
    ds_read_b64_tr_b16 a[168:169], v202 offset:32768
    v_cvt_pk_bf16_f32 v164, v132, v133
    v_mfma_f32_16x16x32_bf16 v[76:79], a[172:175], v[168:171], v[76:79]
    ds_read_b64_tr_b16 a[170:171], v202 offset:36864
    v_fma_f32 v137, v137, s28, -v192
    v_mfma_f32_16x16x32_bf16 v[108:111], a[172:175], v[172:175], v[108:111]
    ds_read_b64_tr_b16 a[172:173], v203 offset:32768
    v_fma_f32 v138, v138, s28, -v192
    v_mfma_f32_16x16x32_bf16 v[80:83], a[176:179], v[168:171], v[80:83]
    ds_read_b64_tr_b16 a[174:175], v203 offset:36864
    v_fma_f32 v139, v139, s28, -v192
    v_mfma_f32_16x16x32_bf16 v[112:115], a[176:179], v[172:175], v[112:115]
    ds_read_b64_tr_b16 a[176:177], v204 offset:32768
    v_exp_f32 v134, v134
    v_mfma_f32_16x16x32_bf16 v[84:87], a[180:183], v[168:171], v[84:87]
    ds_read_b64_tr_b16 a[178:179], v204 offset:36864
    v_fma_f32 v140, v140, s28, -v193
    v_mfma_f32_16x16x32_bf16 v[116:119], a[180:183], v[172:175], v[116:119]
    ds_read_b64_tr_b16 a[180:181], v205 offset:32768
    v_exp_f32 v135, v135
    v_mfma_f32_16x16x32_bf16 v[88:91], a[184:187], v[168:171], v[88:91]
    ds_read_b64_tr_b16 a[182:183], v205 offset:36864
    v_cvt_pk_bf16_f32 v165, v134, v135
    v_mfma_f32_16x16x32_bf16 v[120:123], a[184:187], v[172:175], v[120:123]
    ds_read_b64_tr_b16 a[184:185], v206 offset:32768
    v_fma_f32 v141, v141, s28, -v193
    v_mfma_f32_16x16x32_bf16 v[92:95], a[188:191], v[168:171], v[92:95]
    ds_read_b64_tr_b16 a[186:187], v206 offset:36864
    v_exp_f32 v136, v136
    v_mfma_f32_16x16x32_bf16 v[124:127], a[188:191], v[172:175], v[124:127]
    ds_read_b64_tr_b16 a[188:189], v207 offset:32768
    v_fma_f32 v142, v142, s28, -v193
    v_mfma_f32_16x16x32_bf16 v[144:147], a[128:131], a[32:35], 0
    ds_read_b64_tr_b16 a[190:191], v207 offset:36864
    v_exp_f32 v137, v137
    v_mfma_f32_16x16x32_bf16 v[144:147], a[132:135], a[36:39], v[144:147]
    v_exp_f32 v138, v138
    v_mfma_f32_16x16x32_bf16 v[144:147], a[136:139], a[40:43], v[144:147]
    v_exp_f32 v139, v139
    v_mfma_f32_16x16x32_bf16 v[144:147], a[140:143], a[44:47], v[144:147]
    v_cvt_pk_bf16_f32 v162, v136, v137
    v_cvt_pk_bf16_f32 v163, v138, v139
    v_mfma_f32_16x16x32_bf16 v[148:151], a[128:131], a[48:51], 0
    ds_read_b128 a[128:131], v196 offset:40960
    v_fma_f32 v143, v143, s28, -v193
    v_mfma_f32_16x16x32_bf16 v[148:151], a[132:135], a[52:55], v[148:151]
    ds_read_b128 a[132:135], v197 offset:40960
    v_exp_f32 v140, v140
    v_mfma_f32_16x16x32_bf16 v[148:151], a[136:139], a[56:59], v[148:151]
    ds_read_b128 a[136:139], v198 offset:40960
    v_fma_f32 v144, v144, s28, -v194
    v_mfma_f32_16x16x32_bf16 v[148:151], a[140:143], a[60:63], v[148:151]
    ds_read_b128 a[140:143], v199 offset:40960
    v_fma_f32 v145, v145, s28, -v194
    v_mfma_f32_16x16x32_bf16 v[152:155], a[144:147], a[32:35], 0
    v_exp_f32 v141, v141
    v_mfma_f32_16x16x32_bf16 v[152:155], a[148:151], a[36:39], v[152:155]
    v_exp_f32 v142, v142
    v_mfma_f32_16x16x32_bf16 v[152:155], a[152:155], a[40:43], v[152:155]
    v_exp_f32 v143, v143
    v_mfma_f32_16x16x32_bf16 v[152:155], a[156:159], a[44:47], v[152:155]
    v_cvt_pk_bf16_f32 v166, v140, v141
    v_cvt_pk_bf16_f32 v167, v142, v143
    v_mfma_f32_16x16x32_bf16 v[156:159], a[144:147], a[48:51], 0
    ds_read_b128 a[144:147], v196 offset:45056
    v_fma_f32 v146, v146, s28, -v194
    v_mfma_f32_16x16x32_bf16 v[156:159], a[148:151], a[52:55], v[156:159]
    ds_read_b128 a[148:151], v197 offset:45056
    v_fma_f32 v147, v147, s28, -v194
    v_mfma_f32_16x16x32_bf16 v[156:159], a[152:155], a[56:59], v[156:159]
    ds_read_b128 a[152:155], v198 offset:45056
    v_fma_f32 v148, v148, s28, -v195
    v_mfma_f32_16x16x32_bf16 v[156:159], a[156:159], a[60:63], v[156:159]
    s_waitcnt lgkmcnt(7)
    ds_read_b128 a[156:159], v199 offset:45056
    v_fma_f32 v149, v149, s28, -v195
    v_mfma_f32_16x16x32_bf16 v[0:3], a[160:163], v[160:163], v[0:3]
    v_exp_f32 v144, v144
    v_mfma_f32_16x16x32_bf16 v[32:35], a[160:163], v[164:167], v[32:35]
    v_exp_f32 v145, v145
    v_mfma_f32_16x16x32_bf16 v[4:7], a[164:167], v[160:163], v[4:7]
    v_exp_f32 v146, v146
    v_mfma_f32_16x16x32_bf16 v[36:39], a[164:167], v[164:167], v[36:39]
    v_exp_f32 v147, v147
    v_mfma_f32_16x16x32_bf16 v[176:179], v[220:223], v[160:163], v[176:179]
    v_cvt_pk_bf16_f32 v168, v144, v145
    v_fma_f32 v150, v150, s28, -v195
    v_mfma_f32_16x16x32_bf16 v[8:11], a[168:171], v[160:163], v[8:11]
    v_exp_f32 v148, v148
    v_mfma_f32_16x16x32_bf16 v[180:183], v[220:223], v[164:167], v[180:183]
    v_exp_f32 v149, v149
    v_mfma_f32_16x16x32_bf16 v[40:43], a[168:171], v[164:167], v[40:43]
    v_cvt_pk_bf16_f32 v169, v146, v147
    v_fma_f32 v151, v151, s28, -v195
    v_mfma_f32_16x16x32_bf16 v[12:15], a[172:175], v[160:163], v[12:15]
    v_exp_f32 v150, v150
    v_mfma_f32_16x16x32_bf16 v[44:47], a[172:175], v[164:167], v[44:47]
    v_fma_f32 v152, v152, s28, -v194
    v_cvt_pk_bf16_f32 v172, v148, v149
    v_mfma_f32_16x16x32_bf16 v[16:19], a[176:179], v[160:163], v[16:19]
    v_exp_f32 v151, v151
    v_mfma_f32_16x16x32_bf16 v[48:51], a[176:179], v[164:167], v[48:51]
    s_add_u32 s38, s32, 0x3000
    v_fma_f32 v153, v153, s28, -v194
    v_fma_f32 v154, v154, s28, -v194
    v_mfma_f32_16x16x32_bf16 v[20:23], a[180:183], v[160:163], v[20:23]
    buffer_store_dwordx4 a[80:83], v214, s[20:23], s38 offen sc1
    v_exp_f32 v152, v152
    v_cvt_pk_bf16_f32 v173, v150, v151
    v_mfma_f32_16x16x32_bf16 v[52:55], a[180:183], v[164:167], v[52:55]
    v_exp_f32 v153, v153
    v_mfma_f32_16x16x32_bf16 v[24:27], a[184:187], v[160:163], v[24:27]
    v_fma_f32 v155, v155, s28, -v194
    v_fma_f32 v156, v156, s28, -v195
    v_mfma_f32_16x16x32_bf16 v[56:59], a[184:187], v[164:167], v[56:59]
    v_exp_f32 v154, v154
    v_mfma_f32_16x16x32_bf16 v[28:31], a[188:191], v[160:163], v[28:31]
    v_exp_f32 v155, v155
    v_mfma_f32_16x16x32_bf16 v[60:63], a[188:191], v[164:167], v[60:63]
    s_waitcnt lgkmcnt(0)
    v_cvt_pk_bf16_f32 v170, v152, v153
    v_fma_f32 v157, v157, s28, -v195
    v_mfma_f32_16x16x32_bf16 v[128:131], a[128:131], a[0:3], 0
    v_exp_f32 v156, v156
    v_mfma_f32_16x16x32_bf16 v[128:131], a[132:135], a[4:7], v[128:131]
    s_add_u32 s38, s32, 0x3000
    v_fma_f32 v158, v158, s28, -v195
    v_cvt_pk_bf16_f32 v171, v154, v155
    v_mfma_f32_16x16x32_bf16 v[128:131], a[136:139], a[8:11], v[128:131]
    buffer_store_dwordx4 a[84:87], v214, s[20:23], s38 offen offset:1024 sc1
    v_exp_f32 v157, v157
    v_fma_f32 v159, v159, s28, -v195
    v_mfma_f32_16x16x32_bf16 v[128:131], a[140:143], a[12:15], v[128:131]
    v_exp_f32 v158, v158
    v_mfma_f32_16x16x32_bf16 v[132:135], a[128:131], a[16:19], 0
    v_exp_f32 v159, v159
    v_mfma_f32_16x16x32_bf16 v[132:135], a[132:135], a[20:23], v[132:135]
    v_cvt_pk_bf16_f32 v174, v156, v157
    v_cvt_pk_bf16_f32 v175, v158, v159
    v_mfma_f32_16x16x32_bf16 v[132:135], a[136:139], a[24:27], v[132:135]
    v_mfma_f32_16x16x32_bf16 v[132:135], a[140:143], a[28:31], v[132:135]
    v_fma_f32 v128, v128, s28, -v192
    v_fma_f32 v129, v129, s28, -v192
    v_mfma_f32_16x16x32_bf16 v[136:139], a[144:147], a[0:3], 0
    s_add_u32 s38, s32, 0x3000
    v_exp_f32 v128, v128
    v_mfma_f32_16x16x32_bf16 v[136:139], a[148:151], a[4:7], v[136:139]
    buffer_store_dwordx4 a[88:91], v214, s[20:23], s38 offen offset:2048 sc1
    v_fma_f32 v130, v130, s28, -v192
    v_exp_f32 v129, v129
    v_mfma_f32_16x16x32_bf16 v[136:139], a[152:155], a[8:11], v[136:139]
    v_fma_f32 v131, v131, s28, -v192
    v_fma_f32 v132, v132, s28, -v193
    v_mfma_f32_16x16x32_bf16 v[136:139], a[156:159], a[12:15], v[136:139]
    v_exp_f32 v130, v130
    v_mfma_f32_16x16x32_bf16 v[140:143], a[144:147], a[16:19], 0
    v_exp_f32 v131, v131
    v_mfma_f32_16x16x32_bf16 v[140:143], a[148:151], a[20:23], v[140:143]
    v_cvt_pk_bf16_f32 v160, v128, v129
    v_fma_f32 v133, v133, s28, -v193
    v_mfma_f32_16x16x32_bf16 v[140:143], a[152:155], a[24:27], v[140:143]
    v_exp_f32 v132, v132
    v_mfma_f32_16x16x32_bf16 v[140:143], a[156:159], a[28:31], v[140:143]
    v_fma_f32 v134, v134, s28, -v193
    v_cvt_pk_bf16_f32 v161, v130, v131
    v_mfma_f32_16x16x32_bf16 v[64:67], a[160:163], v[168:171], v[64:67]
    v_exp_f32 v133, v133
    v_mfma_f32_16x16x32_bf16 v[96:99], a[160:163], v[172:175], v[96:99]
    ds_read_b64_tr_b16 a[160:161], v200 offset:40960
    v_fma_f32 v135, v135, s28, -v193
    v_mfma_f32_16x16x32_bf16 v[68:71], a[164:167], v[168:171], v[68:71]
    ds_read_b64_tr_b16 a[162:163], v200 offset:45056
    v_fma_f32 v136, v136, s28, -v192
    v_mfma_f32_16x16x32_bf16 v[100:103], a[164:167], v[172:175], v[100:103]
    ds_read_b64_tr_b16 a[164:165], v201 offset:40960
    v_cvt_pk_bf16_f32 v164, v132, v133
    v_mfma_f32_16x16x32_bf16 v[184:187], v[220:223], v[168:171], v[184:187]
    ds_read_b64_tr_b16 a[166:167], v201 offset:45056
    v_fma_f32 v137, v137, s28, -v192
    v_mfma_f32_16x16x32_bf16 v[72:75], a[168:171], v[168:171], v[72:75]
    v_exp_f32 v134, v134
    v_mfma_f32_16x16x32_bf16 v[188:191], v[220:223], v[172:175], v[188:191]
    v_exp_f32 v135, v135
    v_mfma_f32_16x16x32_bf16 v[104:107], a[168:171], v[172:175], v[104:107]
    ds_read_b64_tr_b16 a[168:169], v202 offset:40960
    v_fma_f32 v138, v138, s28, -v192
    v_mfma_f32_16x16x32_bf16 v[76:79], a[172:175], v[168:171], v[76:79]
    ds_read_b64_tr_b16 a[170:171], v202 offset:45056
    v_cvt_pk_bf16_f32 v165, v134, v135
    v_mfma_f32_16x16x32_bf16 v[108:111], a[172:175], v[172:175], v[108:111]
    ds_read_b64_tr_b16 a[172:173], v203 offset:40960
    v_fma_f32 v139, v139, s28, -v192
    v_mfma_f32_16x16x32_bf16 v[80:83], a[176:179], v[168:171], v[80:83]
    ds_read_b64_tr_b16 a[174:175], v203 offset:45056
    v_fma_f32 v140, v140, s28, -v193
    v_mfma_f32_16x16x32_bf16 v[112:115], a[176:179], v[172:175], v[112:115]
    ds_read_b64_tr_b16 a[176:177], v204 offset:40960
    v_fma_f32 v141, v141, s28, -v193
    v_mfma_f32_16x16x32_bf16 v[84:87], a[180:183], v[168:171], v[84:87]
    ds_read_b64_tr_b16 a[178:179], v204 offset:45056
    v_exp_f32 v136, v136
    v_mfma_f32_16x16x32_bf16 v[116:119], a[180:183], v[172:175], v[116:119]
    ds_read_b64_tr_b16 a[180:181], v205 offset:40960
    v_fma_f32 v142, v142, s28, -v193
    v_mfma_f32_16x16x32_bf16 v[88:91], a[184:187], v[168:171], v[88:91]
    ds_read_b64_tr_b16 a[182:183], v205 offset:45056
    v_exp_f32 v137, v137
    v_mfma_f32_16x16x32_bf16 v[120:123], a[184:187], v[172:175], v[120:123]
    ds_read_b64_tr_b16 a[184:185], v206 offset:40960
    v_cvt_pk_bf16_f32 v162, v136, v137
    v_mfma_f32_16x16x32_bf16 v[92:95], a[188:191], v[168:171], v[92:95]
    ds_read_b64_tr_b16 a[186:187], v206 offset:45056
    v_fma_f32 v143, v143, s28, -v193
    v_mfma_f32_16x16x32_bf16 v[124:127], a[188:191], v[172:175], v[124:127]
    ds_read_b64_tr_b16 a[188:189], v207 offset:40960
    v_exp_f32 v138, v138
    v_mfma_f32_16x16x32_bf16 v[144:147], a[128:131], a[32:35], 0
    ds_read_b64_tr_b16 a[190:191], v207 offset:45056
    v_exp_f32 v139, v139
    v_mfma_f32_16x16x32_bf16 v[144:147], a[132:135], a[36:39], v[144:147]
    v_exp_f32 v140, v140
    v_mfma_f32_16x16x32_bf16 v[144:147], a[136:139], a[40:43], v[144:147]
    v_exp_f32 v141, v141
    v_mfma_f32_16x16x32_bf16 v[144:147], a[140:143], a[44:47], v[144:147]
    v_cvt_pk_bf16_f32 v163, v138, v139
    v_cvt_pk_bf16_f32 v166, v140, v141
    v_mfma_f32_16x16x32_bf16 v[148:151], a[128:131], a[48:51], 0
    ds_read_b128 a[128:131], v196 offset:49152
    v_exp_f32 v142, v142
    v_mfma_f32_16x16x32_bf16 v[148:151], a[132:135], a[52:55], v[148:151]
    ds_read_b128 a[132:135], v197 offset:49152
    v_exp_f32 v143, v143
    v_mfma_f32_16x16x32_bf16 v[148:151], a[136:139], a[56:59], v[148:151]
    ds_read_b128 a[136:139], v198 offset:49152
    v_cvt_pk_bf16_f32 v167, v142, v143
    v_mfma_f32_16x16x32_bf16 v[148:151], a[140:143], a[60:63], v[148:151]
    ds_read_b128 a[140:143], v199 offset:49152
    v_fma_f32 v144, v144, s28, -v194
    v_mfma_f32_16x16x32_bf16 v[152:155], a[144:147], a[32:35], 0
    v_fma_f32 v145, v145, s28, -v194
    v_fma_f32 v146, v146, s28, -v194
    v_mfma_f32_16x16x32_bf16 v[152:155], a[148:151], a[36:39], v[152:155]
    v_exp_f32 v144, v144
    v_mfma_f32_16x16x32_bf16 v[152:155], a[152:155], a[40:43], v[152:155]
    v_exp_f32 v145, v145
    v_mfma_f32_16x16x32_bf16 v[152:155], a[156:159], a[44:47], v[152:155]
    v_fma_f32 v147, v147, s28, -v194
    v_fma_f32 v148, v148, s28, -v195
    v_mfma_f32_16x16x32_bf16 v[156:159], a[144:147], a[48:51], 0
    ds_read_b128 a[144:147], v196 offset:53248
    v_cvt_pk_bf16_f32 v168, v144, v145
    v_mfma_f32_16x16x32_bf16 v[156:159], a[148:151], a[52:55], v[156:159]
    ds_read_b128 a[148:151], v197 offset:53248
    v_fma_f32 v149, v149, s28, -v195
    v_mfma_f32_16x16x32_bf16 v[156:159], a[152:155], a[56:59], v[156:159]
    ds_read_b128 a[152:155], v198 offset:53248
    v_fma_f32 v150, v150, s28, -v195
    v_mfma_f32_16x16x32_bf16 v[156:159], a[156:159], a[60:63], v[156:159]
    s_waitcnt lgkmcnt(7)
    ds_read_b128 a[156:159], v199 offset:53248
    v_fma_f32 v151, v151, s28, -v195
    v_mfma_f32_16x16x32_bf16 v[0:3], a[160:163], v[160:163], v[0:3]
    v_exp_f32 v146, v146
    v_mfma_f32_16x16x32_bf16 v[32:35], a[160:163], v[164:167], v[32:35]
    v_exp_f32 v147, v147
    v_mfma_f32_16x16x32_bf16 v[4:7], a[164:167], v[160:163], v[4:7]
    v_exp_f32 v148, v148
    v_mfma_f32_16x16x32_bf16 v[36:39], a[164:167], v[164:167], v[36:39]
    v_exp_f32 v149, v149
    v_mfma_f32_16x16x32_bf16 v[176:179], v[220:223], v[160:163], v[176:179]
    v_cvt_pk_bf16_f32 v169, v146, v147
    v_fma_f32 v152, v152, s28, -v194
    v_mfma_f32_16x16x32_bf16 v[8:11], a[168:171], v[160:163], v[8:11]
    v_exp_f32 v150, v150
    v_mfma_f32_16x16x32_bf16 v[180:183], v[220:223], v[164:167], v[180:183]
    v_exp_f32 v151, v151
    v_mfma_f32_16x16x32_bf16 v[40:43], a[168:171], v[164:167], v[40:43]
    v_cvt_pk_bf16_f32 v172, v148, v149
    v_fma_f32 v153, v153, s28, -v194
    v_mfma_f32_16x16x32_bf16 v[12:15], a[172:175], v[160:163], v[12:15]
    v_exp_f32 v152, v152
    v_mfma_f32_16x16x32_bf16 v[44:47], a[172:175], v[164:167], v[44:47]
    v_fma_f32 v154, v154, s28, -v194
    v_cvt_pk_bf16_f32 v173, v150, v151
    v_mfma_f32_16x16x32_bf16 v[16:19], a[176:179], v[160:163], v[16:19]
    v_exp_f32 v153, v153
    v_mfma_f32_16x16x32_bf16 v[48:51], a[176:179], v[164:167], v[48:51]
    v_fma_f32 v155, v155, s28, -v194
    v_fma_f32 v156, v156, s28, -v195
    v_mfma_f32_16x16x32_bf16 v[20:23], a[180:183], v[160:163], v[20:23]
    s_add_u32 s38, s32, 0x3000
    v_exp_f32 v154, v154
    v_mfma_f32_16x16x32_bf16 v[52:55], a[180:183], v[164:167], v[52:55]
    buffer_store_dwordx4 a[92:95], v214, s[20:23], s38 offen offset:3072 sc1
    v_exp_f32 v155, v155
    v_cvt_pk_bf16_f32 v170, v152, v153
    v_mfma_f32_16x16x32_bf16 v[24:27], a[184:187], v[160:163], v[24:27]
    v_fma_f32 v157, v157, s28, -v195
    v_fma_f32 v158, v158, s28, -v195
    v_mfma_f32_16x16x32_bf16 v[56:59], a[184:187], v[164:167], v[56:59]
    v_exp_f32 v156, v156
    v_mfma_f32_16x16x32_bf16 v[28:31], a[188:191], v[160:163], v[28:31]
    v_exp_f32 v157, v157
    v_mfma_f32_16x16x32_bf16 v[60:63], a[188:191], v[164:167], v[60:63]
    s_waitcnt lgkmcnt(0)
    v_cvt_pk_bf16_f32 v171, v154, v155
    v_fma_f32 v159, v159, s28, -v195
    v_mfma_f32_16x16x32_bf16 v[128:131], a[128:131], a[0:3], 0
    v_exp_f32 v158, v158
    v_mfma_f32_16x16x32_bf16 v[128:131], a[132:135], a[4:7], v[128:131]
    v_exp_f32 v159, v159
    v_mfma_f32_16x16x32_bf16 v[128:131], a[136:139], a[8:11], v[128:131]
    v_cvt_pk_bf16_f32 v174, v156, v157
    v_cvt_pk_bf16_f32 v175, v158, v159
    v_mfma_f32_16x16x32_bf16 v[128:131], a[140:143], a[12:15], v[128:131]
    v_mfma_f32_16x16x32_bf16 v[132:135], a[128:131], a[16:19], 0
    v_mfma_f32_16x16x32_bf16 v[132:135], a[132:135], a[20:23], v[132:135]
    v_mfma_f32_16x16x32_bf16 v[132:135], a[136:139], a[24:27], v[132:135]
    v_mfma_f32_16x16x32_bf16 v[132:135], a[140:143], a[28:31], v[132:135]
    v_mfma_f32_16x16x32_bf16 v[136:139], a[144:147], a[0:3], 0
    v_mfma_f32_16x16x32_bf16 v[136:139], a[148:151], a[4:7], v[136:139]
    v_mfma_f32_16x16x32_bf16 v[136:139], a[152:155], a[8:11], v[136:139]
    v_mfma_f32_16x16x32_bf16 v[136:139], a[156:159], a[12:15], v[136:139]
    v_fma_f32 v128, v128, s28, -v192
    v_fma_f32 v129, v129, s28, -v192
    v_mfma_f32_16x16x32_bf16 v[140:143], a[144:147], a[16:19], 0
    v_exp_f32 v128, v128
    v_mfma_f32_16x16x32_bf16 v[140:143], a[148:151], a[20:23], v[140:143]
    v_fma_f32 v130, v130, s28, -v192
    v_fma_f32 v131, v131, s28, -v192
    v_mfma_f32_16x16x32_bf16 v[140:143], a[152:155], a[24:27], v[140:143]
    s_waitcnt vmcnt(11)
    s_barrier
    v_exp_f32 v129, v129
    v_mfma_f32_16x16x32_bf16 v[140:143], a[156:159], a[28:31], v[140:143]
    v_exp_f32 v130, v130
    v_mfma_f32_16x16x32_bf16 v[64:67], a[160:163], v[168:171], v[64:67]
    v_fma_f32 v132, v132, s28, -v193
    v_cvt_pk_bf16_f32 v160, v128, v129
    v_mfma_f32_16x16x32_bf16 v[96:99], a[160:163], v[172:175], v[96:99]
    ds_read_b64_tr_b16 a[160:161], v200 offset:49152
    v_fma_f32 v133, v133, s28, -v193
    v_mfma_f32_16x16x32_bf16 v[68:71], a[164:167], v[168:171], v[68:71]
    ds_read_b64_tr_b16 a[162:163], v200 offset:53248
    v_fma_f32 v134, v134, s28, -v193
    v_mfma_f32_16x16x32_bf16 v[100:103], a[164:167], v[172:175], v[100:103]
    ds_read_b64_tr_b16 a[164:165], v201 offset:49152
    v_fma_f32 v135, v135, s28, -v193
    v_mfma_f32_16x16x32_bf16 v[184:187], v[220:223], v[168:171], v[184:187]
    ds_read_b64_tr_b16 a[166:167], v201 offset:53248
    v_fma_f32 v136, v136, s28, -v192
    v_mfma_f32_16x16x32_bf16 v[72:75], a[168:171], v[168:171], v[72:75]
    v_exp_f32 v131, v131
    v_mfma_f32_16x16x32_bf16 v[188:191], v[220:223], v[172:175], v[188:191]
    v_exp_f32 v132, v132
    v_mfma_f32_16x16x32_bf16 v[104:107], a[168:171], v[172:175], v[104:107]
    ds_read_b64_tr_b16 a[168:169], v202 offset:49152
    v_cvt_pk_bf16_f32 v161, v130, v131
    v_mfma_f32_16x16x32_bf16 v[76:79], a[172:175], v[168:171], v[76:79]
    ds_read_b64_tr_b16 a[170:171], v202 offset:53248
    v_fma_f32 v137, v137, s28, -v192
    v_mfma_f32_16x16x32_bf16 v[108:111], a[172:175], v[172:175], v[108:111]
    ds_read_b64_tr_b16 a[172:173], v203 offset:49152
    v_fma_f32 v138, v138, s28, -v192
    v_mfma_f32_16x16x32_bf16 v[80:83], a[176:179], v[168:171], v[80:83]
    ds_read_b64_tr_b16 a[174:175], v203 offset:53248
    v_exp_f32 v133, v133
    v_mfma_f32_16x16x32_bf16 v[112:115], a[176:179], v[172:175], v[112:115]
    ds_read_b64_tr_b16 a[176:177], v204 offset:49152
    v_cvt_pk_bf16_f32 v164, v132, v133
    v_mfma_f32_16x16x32_bf16 v[84:87], a[180:183], v[168:171], v[84:87]
    ds_read_b64_tr_b16 a[178:179], v204 offset:53248
    v_fma_f32 v139, v139, s28, -v192
    v_mfma_f32_16x16x32_bf16 v[116:119], a[180:183], v[172:175], v[116:119]
    ds_read_b64_tr_b16 a[180:181], v205 offset:49152
    v_exp_f32 v134, v134
    v_mfma_f32_16x16x32_bf16 v[88:91], a[184:187], v[168:171], v[88:91]
    ds_read_b64_tr_b16 a[182:183], v205 offset:53248
    v_fma_f32 v140, v140, s28, -v193
    v_mfma_f32_16x16x32_bf16 v[120:123], a[184:187], v[172:175], v[120:123]
    ds_read_b64_tr_b16 a[184:185], v206 offset:49152
    v_exp_f32 v135, v135
    v_mfma_f32_16x16x32_bf16 v[92:95], a[188:191], v[168:171], v[92:95]
    ds_read_b64_tr_b16 a[186:187], v206 offset:53248
    v_cvt_pk_bf16_f32 v165, v134, v135
    v_mfma_f32_16x16x32_bf16 v[124:127], a[188:191], v[172:175], v[124:127]
    ds_read_b64_tr_b16 a[188:189], v207 offset:49152
    v_fma_f32 v141, v141, s28, -v193
    v_mfma_f32_16x16x32_bf16 v[144:147], a[128:131], a[32:35], 0
    ds_read_b64_tr_b16 a[190:191], v207 offset:53248
    v_exp_f32 v136, v136
    v_mfma_f32_16x16x32_bf16 v[144:147], a[132:135], a[36:39], v[144:147]
    v_exp_f32 v137, v137
    v_mfma_f32_16x16x32_bf16 v[144:147], a[136:139], a[40:43], v[144:147]
    v_exp_f32 v138, v138
    v_mfma_f32_16x16x32_bf16 v[144:147], a[140:143], a[44:47], v[144:147]
    v_exp_f32 v139, v139
    v_mfma_f32_16x16x32_bf16 v[148:151], a[128:131], a[48:51], 0
    ds_read_b128 a[128:131], v196 offset:57344
    v_cvt_pk_bf16_f32 v162, v136, v137
    v_mfma_f32_16x16x32_bf16 v[148:151], a[132:135], a[52:55], v[148:151]
    ds_read_b128 a[132:135], v197 offset:57344
    v_fma_f32 v142, v142, s28, -v193
    v_mfma_f32_16x16x32_bf16 v[148:151], a[136:139], a[56:59], v[148:151]
    ds_read_b128 a[136:139], v198 offset:57344
    v_cvt_pk_bf16_f32 v163, v138, v139
    v_mfma_f32_16x16x32_bf16 v[148:151], a[140:143], a[60:63], v[148:151]
    ds_read_b128 a[140:143], v199 offset:57344
    v_fma_f32 v143, v143, s28, -v193
    v_mfma_f32_16x16x32_bf16 v[152:155], a[144:147], a[32:35], 0
    v_exp_f32 v140, v140
    v_mfma_f32_16x16x32_bf16 v[152:155], a[148:151], a[36:39], v[152:155]
    v_exp_f32 v141, v141
    v_mfma_f32_16x16x32_bf16 v[152:155], a[152:155], a[40:43], v[152:155]
    v_exp_f32 v142, v142
    v_mfma_f32_16x16x32_bf16 v[152:155], a[156:159], a[44:47], v[152:155]
    v_exp_f32 v143, v143
    v_mfma_f32_16x16x32_bf16 v[156:159], a[144:147], a[48:51], 0
    ds_read_b128 a[144:147], v196 offset:61440
    v_cvt_pk_bf16_f32 v166, v140, v141
    v_mfma_f32_16x16x32_bf16 v[156:159], a[148:151], a[52:55], v[156:159]
    ds_read_b128 a[148:151], v197 offset:61440
    v_cvt_pk_bf16_f32 v167, v142, v143
    v_mfma_f32_16x16x32_bf16 v[156:159], a[152:155], a[56:59], v[156:159]
    ds_read_b128 a[152:155], v198 offset:61440
    v_fma_f32 v144, v144, s28, -v194
    v_mfma_f32_16x16x32_bf16 v[156:159], a[156:159], a[60:63], v[156:159]
    s_waitcnt lgkmcnt(7)
    ds_read_b128 a[156:159], v199 offset:61440
    v_fma_f32 v145, v145, s28, -v194
    v_mfma_f32_16x16x32_bf16 v[0:3], a[160:163], v[160:163], v[0:3]
    v_exp_f32 v144, v144
    v_mfma_f32_16x16x32_bf16 v[32:35], a[160:163], v[164:167], v[32:35]
    v_fma_f32 v146, v146, s28, -v194
    v_fma_f32 v147, v147, s28, -v194
    v_mfma_f32_16x16x32_bf16 v[4:7], a[164:167], v[160:163], v[4:7]
    v_exp_f32 v145, v145
    v_mfma_f32_16x16x32_bf16 v[36:39], a[164:167], v[164:167], v[36:39]
    v_exp_f32 v146, v146
    v_mfma_f32_16x16x32_bf16 v[176:179], v[220:223], v[160:163], v[176:179]
    v_fma_f32 v148, v148, s28, -v195
    v_cvt_pk_bf16_f32 v168, v144, v145
    v_mfma_f32_16x16x32_bf16 v[8:11], a[168:171], v[160:163], v[8:11]
    v_exp_f32 v147, v147
    v_mfma_f32_16x16x32_bf16 v[180:183], v[220:223], v[164:167], v[180:183]
    v_fma_f32 v149, v149, s28, -v195
    v_fma_f32 v150, v150, s28, -v195
    v_mfma_f32_16x16x32_bf16 v[40:43], a[168:171], v[164:167], v[40:43]
    v_exp_f32 v148, v148
    v_mfma_f32_16x16x32_bf16 v[12:15], a[172:175], v[160:163], v[12:15]
    v_exp_f32 v149, v149
    v_mfma_f32_16x16x32_bf16 v[44:47], a[172:175], v[164:167], v[44:47]
    v_cvt_pk_bf16_f32 v169, v146, v147
    v_fma_f32 v151, v151, s28, -v195
    v_mfma_f32_16x16x32_bf16 v[16:19], a[176:179], v[160:163], v[16:19]
    v_exp_f32 v150, v150
    v_mfma_f32_16x16x32_bf16 v[48:51], a[176:179], v[164:167], v[48:51]
    v_fma_f32 v152, v152, s28, -v194
    v_cvt_pk_bf16_f32 v172, v148, v149
    v_mfma_f32_16x16x32_bf16 v[20:23], a[180:183], v[160:163], v[20:23]
    v_exp_f32 v151, v151
    v_mfma_f32_16x16x32_bf16 v[52:55], a[180:183], v[164:167], v[52:55]
    v_fma_f32 v153, v153, s28, -v194
    v_fma_f32 v154, v154, s28, -v194
    v_mfma_f32_16x16x32_bf16 v[24:27], a[184:187], v[160:163], v[24:27]
    v_exp_f32 v152, v152
    v_mfma_f32_16x16x32_bf16 v[56:59], a[184:187], v[164:167], v[56:59]
    v_exp_f32 v153, v153
    v_mfma_f32_16x16x32_bf16 v[28:31], a[188:191], v[160:163], v[28:31]
    v_cvt_pk_bf16_f32 v173, v150, v151
    v_fma_f32 v155, v155, s28, -v194
    v_mfma_f32_16x16x32_bf16 v[60:63], a[188:191], v[164:167], v[60:63]
    s_waitcnt lgkmcnt(0)
    v_exp_f32 v154, v154
    v_mfma_f32_16x16x32_bf16 v[128:131], a[128:131], a[0:3], 0
    v_fma_f32 v156, v156, s28, -v195
    v_cvt_pk_bf16_f32 v170, v152, v153
    v_mfma_f32_16x16x32_bf16 v[128:131], a[132:135], a[4:7], v[128:131]
    v_exp_f32 v155, v155
    v_mfma_f32_16x16x32_bf16 v[128:131], a[136:139], a[8:11], v[128:131]
    v_fma_f32 v157, v157, s28, -v195
    v_fma_f32 v158, v158, s28, -v195
    v_mfma_f32_16x16x32_bf16 v[128:131], a[140:143], a[12:15], v[128:131]
    v_exp_f32 v156, v156
    v_mfma_f32_16x16x32_bf16 v[132:135], a[128:131], a[16:19], 0
    v_exp_f32 v157, v157
    v_mfma_f32_16x16x32_bf16 v[132:135], a[132:135], a[20:23], v[132:135]
    v_cvt_pk_bf16_f32 v171, v154, v155
    v_fma_f32 v159, v159, s28, -v195
    v_mfma_f32_16x16x32_bf16 v[132:135], a[136:139], a[24:27], v[132:135]
    v_exp_f32 v158, v158
    v_mfma_f32_16x16x32_bf16 v[132:135], a[140:143], a[28:31], v[132:135]
    v_exp_f32 v159, v159
    v_mfma_f32_16x16x32_bf16 v[136:139], a[144:147], a[0:3], 0
    v_cvt_pk_bf16_f32 v174, v156, v157
    v_cvt_pk_bf16_f32 v175, v158, v159
    v_mfma_f32_16x16x32_bf16 v[136:139], a[148:151], a[4:7], v[136:139]
    v_fma_f32 v128, v128, s28, -v192
    v_fma_f32 v129, v129, s28, -v192
    v_mfma_f32_16x16x32_bf16 v[136:139], a[152:155], a[8:11], v[136:139]
    v_exp_f32 v128, v128
    v_mfma_f32_16x16x32_bf16 v[136:139], a[156:159], a[12:15], v[136:139]
    v_fma_f32 v130, v130, s28, -v192
    v_fma_f32 v131, v131, s28, -v192
    v_mfma_f32_16x16x32_bf16 v[140:143], a[144:147], a[16:19], 0
    v_exp_f32 v129, v129
    v_mfma_f32_16x16x32_bf16 v[140:143], a[148:151], a[20:23], v[140:143]
    v_exp_f32 v130, v130
    v_mfma_f32_16x16x32_bf16 v[140:143], a[152:155], a[24:27], v[140:143]
    v_fma_f32 v132, v132, s28, -v193
    v_cvt_pk_bf16_f32 v160, v128, v129
    v_mfma_f32_16x16x32_bf16 v[140:143], a[156:159], a[28:31], v[140:143]
    v_exp_f32 v131, v131
    v_mfma_f32_16x16x32_bf16 v[64:67], a[160:163], v[168:171], v[64:67]
    v_fma_f32 v133, v133, s28, -v193
    v_fma_f32 v134, v134, s28, -v193
    v_mfma_f32_16x16x32_bf16 v[96:99], a[160:163], v[172:175], v[96:99]
    ds_read_b64_tr_b16 a[160:161], v200 offset:57344
    v_cvt_pk_bf16_f32 v161, v130, v131
    v_mfma_f32_16x16x32_bf16 v[68:71], a[164:167], v[168:171], v[68:71]
    ds_read_b64_tr_b16 a[162:163], v200 offset:61440
    v_fma_f32 v135, v135, s28, -v193
    v_mfma_f32_16x16x32_bf16 v[100:103], a[164:167], v[172:175], v[100:103]
    ds_read_b64_tr_b16 a[164:165], v201 offset:57344
    v_fma_f32 v136, v136, s28, -v192
    v_mfma_f32_16x16x32_bf16 v[184:187], v[220:223], v[168:171], v[184:187]
    ds_read_b64_tr_b16 a[166:167], v201 offset:61440
    v_fma_f32 v137, v137, s28, -v192
    v_mfma_f32_16x16x32_bf16 v[72:75], a[168:171], v[168:171], v[72:75]
    v_exp_f32 v132, v132
    v_mfma_f32_16x16x32_bf16 v[188:191], v[220:223], v[172:175], v[188:191]
    v_exp_f32 v133, v133
    v_mfma_f32_16x16x32_bf16 v[104:107], a[168:171], v[172:175], v[104:107]
    ds_read_b64_tr_b16 a[168:169], v202 offset:57344
    v_cvt_pk_bf16_f32 v164, v132, v133
    v_mfma_f32_16x16x32_bf16 v[76:79], a[172:175], v[168:171], v[76:79]
    ds_read_b64_tr_b16 a[170:171], v202 offset:61440
    v_fma_f32 v138, v138, s28, -v192
    v_mfma_f32_16x16x32_bf16 v[108:111], a[172:175], v[172:175], v[108:111]
    ds_read_b64_tr_b16 a[172:173], v203 offset:57344
    v_fma_f32 v139, v139, s28, -v192
    v_mfma_f32_16x16x32_bf16 v[80:83], a[176:179], v[168:171], v[80:83]
    ds_read_b64_tr_b16 a[174:175], v203 offset:61440
    v_exp_f32 v134, v134
    v_mfma_f32_16x16x32_bf16 v[112:115], a[176:179], v[172:175], v[112:115]
    ds_read_b64_tr_b16 a[176:177], v204 offset:57344
    v_fma_f32 v140, v140, s28, -v193
    v_mfma_f32_16x16x32_bf16 v[84:87], a[180:183], v[168:171], v[84:87]
    ds_read_b64_tr_b16 a[178:179], v204 offset:61440
    v_exp_f32 v135, v135
    v_mfma_f32_16x16x32_bf16 v[116:119], a[180:183], v[172:175], v[116:119]
    ds_read_b64_tr_b16 a[180:181], v205 offset:57344
    v_cvt_pk_bf16_f32 v165, v134, v135
    v_mfma_f32_16x16x32_bf16 v[88:91], a[184:187], v[168:171], v[88:91]
    ds_read_b64_tr_b16 a[182:183], v205 offset:61440
    v_fma_f32 v141, v141, s28, -v193
    v_mfma_f32_16x16x32_bf16 v[120:123], a[184:187], v[172:175], v[120:123]
    ds_read_b64_tr_b16 a[184:185], v206 offset:57344
    v_exp_f32 v136, v136
    v_mfma_f32_16x16x32_bf16 v[92:95], a[188:191], v[168:171], v[92:95]
    ds_read_b64_tr_b16 a[186:187], v206 offset:61440
    v_fma_f32 v142, v142, s28, -v193
    v_mfma_f32_16x16x32_bf16 v[124:127], a[188:191], v[172:175], v[124:127]
    ds_read_b64_tr_b16 a[188:189], v207 offset:57344
    v_exp_f32 v137, v137
    v_mfma_f32_16x16x32_bf16 v[144:147], a[128:131], a[32:35], 0
    ds_read_b64_tr_b16 a[190:191], v207 offset:61440
    v_cvt_pk_bf16_f32 v162, v136, v137
    v_mfma_f32_16x16x32_bf16 v[144:147], a[132:135], a[36:39], v[144:147]
    s_lshl_b32 s56, s56, 1
    v_exp_f32 v138, v138
    v_mfma_f32_16x16x32_bf16 v[144:147], a[136:139], a[40:43], v[144:147]
    s_max_u32 s56, s56, 1
    v_exp_f32 v139, v139
    v_mfma_f32_16x16x32_bf16 v[144:147], a[140:143], a[44:47], v[144:147]
    s_add_u32 s33, s33, 1
    v_exp_f32 v140, v140
    v_mfma_f32_16x16x32_bf16 v[148:151], a[128:131], a[48:51], 0
    v_exp_f32 v141, v141
    v_mfma_f32_16x16x32_bf16 v[148:151], a[132:135], a[52:55], v[148:151]
    v_cvt_pk_bf16_f32 v163, v138, v139
    v_fma_f32 v143, v143, s28, -v193
    v_mfma_f32_16x16x32_bf16 v[148:151], a[136:139], a[56:59], v[148:151]
    v_exp_f32 v142, v142
    v_mfma_f32_16x16x32_bf16 v[148:151], a[140:143], a[60:63], v[148:151]
    v_exp_f32 v143, v143
    v_mfma_f32_16x16x32_bf16 v[152:155], a[144:147], a[32:35], 0
    v_cvt_pk_bf16_f32 v166, v140, v141
    v_cvt_pk_bf16_f32 v167, v142, v143
    v_mfma_f32_16x16x32_bf16 v[152:155], a[148:151], a[36:39], v[152:155]
    v_fma_f32 v144, v144, s28, -v194
    v_fma_f32 v145, v145, s28, -v194
    v_mfma_f32_16x16x32_bf16 v[152:155], a[152:155], a[40:43], v[152:155]
    v_exp_f32 v144, v144
    v_mfma_f32_16x16x32_bf16 v[152:155], a[156:159], a[44:47], v[152:155]
    v_fma_f32 v146, v146, s28, -v194
    v_fma_f32 v147, v147, s28, -v194
    v_mfma_f32_16x16x32_bf16 v[156:159], a[144:147], a[48:51], 0
    v_exp_f32 v145, v145
    v_mfma_f32_16x16x32_bf16 v[156:159], a[148:151], a[52:55], v[156:159]
    v_exp_f32 v146, v146
    v_mfma_f32_16x16x32_bf16 v[156:159], a[152:155], a[56:59], v[156:159]
    v_fma_f32 v148, v148, s28, -v195
    v_cvt_pk_bf16_f32 v168, v144, v145
    v_mfma_f32_16x16x32_bf16 v[156:159], a[156:159], a[60:63], v[156:159]
    s_waitcnt lgkmcnt(0)
    v_exp_f32 v147, v147
    v_mfma_f32_16x16x32_bf16 v[0:3], a[160:163], v[160:163], v[0:3]
    v_fma_f32 v149, v149, s28, -v195
    v_fma_f32 v150, v150, s28, -v195
    v_mfma_f32_16x16x32_bf16 v[32:35], a[160:163], v[164:167], v[32:35]
    v_exp_f32 v148, v148
    v_mfma_f32_16x16x32_bf16 v[4:7], a[164:167], v[160:163], v[4:7]
    v_exp_f32 v149, v149
    v_mfma_f32_16x16x32_bf16 v[36:39], a[164:167], v[164:167], v[36:39]
    v_cvt_pk_bf16_f32 v169, v146, v147
    v_fma_f32 v151, v151, s28, -v195
    v_mfma_f32_16x16x32_bf16 v[176:179], v[220:223], v[160:163], v[176:179]
    v_exp_f32 v150, v150
    v_mfma_f32_16x16x32_bf16 v[8:11], a[168:171], v[160:163], v[8:11]
    v_fma_f32 v152, v152, s28, -v194
    v_cvt_pk_bf16_f32 v172, v148, v149
    v_mfma_f32_16x16x32_bf16 v[180:183], v[220:223], v[164:167], v[180:183]
    v_exp_f32 v151, v151
    v_mfma_f32_16x16x32_bf16 v[40:43], a[168:171], v[164:167], v[40:43]
    v_fma_f32 v153, v153, s28, -v194
    v_fma_f32 v154, v154, s28, -v194
    v_mfma_f32_16x16x32_bf16 v[12:15], a[172:175], v[160:163], v[12:15]
    v_exp_f32 v152, v152
    v_mfma_f32_16x16x32_bf16 v[44:47], a[172:175], v[164:167], v[44:47]
    v_exp_f32 v153, v153
    v_mfma_f32_16x16x32_bf16 v[16:19], a[176:179], v[160:163], v[16:19]
    v_cvt_pk_bf16_f32 v173, v150, v151
    v_fma_f32 v155, v155, s28, -v194
    v_mfma_f32_16x16x32_bf16 v[48:51], a[176:179], v[164:167], v[48:51]
    v_exp_f32 v154, v154
    v_mfma_f32_16x16x32_bf16 v[20:23], a[180:183], v[160:163], v[20:23]
    v_fma_f32 v156, v156, s28, -v195
    v_cvt_pk_bf16_f32 v170, v152, v153
    v_mfma_f32_16x16x32_bf16 v[52:55], a[180:183], v[164:167], v[52:55]
    v_exp_f32 v155, v155
    v_mfma_f32_16x16x32_bf16 v[24:27], a[184:187], v[160:163], v[24:27]
    v_fma_f32 v157, v157, s28, -v195
    v_fma_f32 v158, v158, s28, -v195
    v_mfma_f32_16x16x32_bf16 v[56:59], a[184:187], v[164:167], v[56:59]
    v_exp_f32 v156, v156
    v_mfma_f32_16x16x32_bf16 v[28:31], a[188:191], v[160:163], v[28:31]
    v_exp_f32 v157, v157
    v_mfma_f32_16x16x32_bf16 v[60:63], a[188:191], v[164:167], v[60:63]
    s_add_u32 s32, s32, s31
    v_rcp_f32 v232, v176
    v_rcp_f32 v234, v180
    v_cvt_pk_bf16_f32 v171, v154, v155
    s_nop 1
    v_mfma_f32_16x16x32_bf16 v[64:67], a[160:163], v[168:171], v[64:67]
    v_pk_mul_f32 v[0:1], v[0:1], v[232:233] op_sel_hi:[1,0]
    v_pk_mul_f32 v[2:3], v[2:3], v[232:233] op_sel_hi:[1,0]
    v_pk_mul_f32 v[4:5], v[4:5], v[232:233] op_sel_hi:[1,0]
    v_pk_mul_f32 v[6:7], v[6:7], v[232:233] op_sel_hi:[1,0]
    v_pk_mul_f32 v[8:9], v[8:9], v[232:233] op_sel_hi:[1,0]
    v_pk_mul_f32 v[10:11], v[10:11], v[232:233] op_sel_hi:[1,0]
    v_pk_mul_f32 v[12:13], v[12:13], v[232:233] op_sel_hi:[1,0]
    v_pk_mul_f32 v[14:15], v[14:15], v[232:233] op_sel_hi:[1,0]
    v_pk_mul_f32 v[16:17], v[16:17], v[232:233] op_sel_hi:[1,0]
    v_pk_mul_f32 v[18:19], v[18:19], v[232:233] op_sel_hi:[1,0]
    v_pk_mul_f32 v[20:21], v[20:21], v[232:233] op_sel_hi:[1,0]
    v_pk_mul_f32 v[22:23], v[22:23], v[232:233] op_sel_hi:[1,0]
    v_pk_mul_f32 v[24:25], v[24:25], v[232:233] op_sel_hi:[1,0]
    v_pk_mul_f32 v[26:27], v[26:27], v[232:233] op_sel_hi:[1,0]
    v_pk_mul_f32 v[28:29], v[28:29], v[232:233] op_sel_hi:[1,0]
    v_pk_mul_f32 v[30:31], v[30:31], v[232:233] op_sel_hi:[1,0]
    v_cvt_pk_bf16_f32 v0, v0, v1
    v_cvt_pk_bf16_f32 v1, v2, v3
    v_cvt_pk_bf16_f32 v4, v4, v5
    v_cvt_pk_bf16_f32 v5, v6, v7
    v_cvt_pk_bf16_f32 v8, v8, v9
    v_cvt_pk_bf16_f32 v9, v10, v11
    v_cvt_pk_bf16_f32 v12, v12, v13
    v_cvt_pk_bf16_f32 v13, v14, v15
    v_cvt_pk_bf16_f32 v16, v16, v17
    v_cvt_pk_bf16_f32 v17, v18, v19
    v_cvt_pk_bf16_f32 v20, v20, v21
    v_cvt_pk_bf16_f32 v21, v22, v23
    v_cvt_pk_bf16_f32 v24, v24, v25
    v_cvt_pk_bf16_f32 v25, v26, v27
    v_cvt_pk_bf16_f32 v28, v28, v29
    v_cvt_pk_bf16_f32 v29, v30, v31
    v_pk_mul_f32 v[32:33], v[32:33], v[234:235] op_sel_hi:[1,0]
    v_pk_mul_f32 v[34:35], v[34:35], v[234:235] op_sel_hi:[1,0]
    v_pk_mul_f32 v[36:37], v[36:37], v[234:235] op_sel_hi:[1,0]
    v_pk_mul_f32 v[38:39], v[38:39], v[234:235] op_sel_hi:[1,0]
    v_pk_mul_f32 v[40:41], v[40:41], v[234:235] op_sel_hi:[1,0]
    v_pk_mul_f32 v[42:43], v[42:43], v[234:235] op_sel_hi:[1,0]
    v_pk_mul_f32 v[44:45], v[44:45], v[234:235] op_sel_hi:[1,0]
    v_pk_mul_f32 v[46:47], v[46:47], v[234:235] op_sel_hi:[1,0]
    v_pk_mul_f32 v[48:49], v[48:49], v[234:235] op_sel_hi:[1,0]
    v_pk_mul_f32 v[50:51], v[50:51], v[234:235] op_sel_hi:[1,0]
    v_pk_mul_f32 v[52:53], v[52:53], v[234:235] op_sel_hi:[1,0]
    v_pk_mul_f32 v[54:55], v[54:55], v[234:235] op_sel_hi:[1,0]
    v_pk_mul_f32 v[56:57], v[56:57], v[234:235] op_sel_hi:[1,0]
    v_pk_mul_f32 v[58:59], v[58:59], v[234:235] op_sel_hi:[1,0]
    v_pk_mul_f32 v[60:61], v[60:61], v[234:235] op_sel_hi:[1,0]
    v_pk_mul_f32 v[62:63], v[62:63], v[234:235] op_sel_hi:[1,0]
    v_cvt_pk_bf16_f32 v32, v32, v33
    v_cvt_pk_bf16_f32 v33, v34, v35
    v_cvt_pk_bf16_f32 v36, v36, v37
    v_cvt_pk_bf16_f32 v37, v38, v39
    v_cvt_pk_bf16_f32 v40, v40, v41
    v_cvt_pk_bf16_f32 v41, v42, v43
    v_cvt_pk_bf16_f32 v44, v44, v45
    v_cvt_pk_bf16_f32 v45, v46, v47
    v_cvt_pk_bf16_f32 v48, v48, v49
    v_cvt_pk_bf16_f32 v49, v50, v51
    v_cvt_pk_bf16_f32 v52, v52, v53
    v_cvt_pk_bf16_f32 v53, v54, v55
    v_cvt_pk_bf16_f32 v56, v56, v57
    v_cvt_pk_bf16_f32 v57, v58, v59
    v_cvt_pk_bf16_f32 v60, v60, v61
    v_cvt_pk_bf16_f32 v61, v62, v63
    v_fma_f32 v159, v159, s28, -v195
    v_exp_f32 v158, v158
    v_exp_f32 v159, v159
    v_cvt_pk_bf16_f32 v174, v156, v157
    v_cvt_pk_bf16_f32 v175, v158, v159
    s_nop 1
    v_mfma_f32_16x16x32_bf16 v[96:99], a[160:163], v[172:175], v[96:99]
    ds_write_b64 v248, v[0:1] offset:0
    v_mfma_f32_16x16x32_bf16 v[68:71], a[164:167], v[168:171], v[68:71]
    ds_write_b64 v249, v[4:5] offset:0
    v_mfma_f32_16x16x32_bf16 v[100:103], a[164:167], v[172:175], v[100:103]
    ds_write_b64 v250, v[8:9] offset:0
    v_mfma_f32_16x16x32_bf16 v[184:187], v[220:223], v[168:171], v[184:187]
    ds_write_b64 v251, v[12:13] offset:0
    v_mfma_f32_16x16x32_bf16 v[72:75], a[168:171], v[168:171], v[72:75]
    ds_write_b64 v248, v[16:17] offset:128
    v_mfma_f32_16x16x32_bf16 v[188:191], v[220:223], v[172:175], v[188:191]
    ds_write_b64 v249, v[20:21] offset:128
    v_mfma_f32_16x16x32_bf16 v[104:107], a[168:171], v[172:175], v[104:107]
    ds_write_b64 v250, v[24:25] offset:128
    v_mfma_f32_16x16x32_bf16 v[76:79], a[172:175], v[168:171], v[76:79]
    ds_write_b64 v251, v[28:29] offset:128
    v_rcp_f32 v232, v184
    v_mfma_f32_16x16x32_bf16 v[108:111], a[172:175], v[172:175], v[108:111]
    ds_write_b64 v248, v[32:33] offset:4096
    v_rcp_f32 v234, v188
    v_mfma_f32_16x16x32_bf16 v[80:83], a[176:179], v[168:171], v[80:83]
    ds_write_b64 v249, v[36:37] offset:4096
    v_mfma_f32_16x16x32_bf16 v[112:115], a[176:179], v[172:175], v[112:115]
    ds_write_b64 v250, v[40:41] offset:4096
    v_mfma_f32_16x16x32_bf16 v[84:87], a[180:183], v[168:171], v[84:87]
    ds_write_b64 v251, v[44:45] offset:4096
    v_mfma_f32_16x16x32_bf16 v[116:119], a[180:183], v[172:175], v[116:119]
    ds_write_b64 v248, v[48:49] offset:4224
    v_mfma_f32_16x16x32_bf16 v[88:91], a[184:187], v[168:171], v[88:91]
    ds_write_b64 v249, v[52:53] offset:4224
    v_mfma_f32_16x16x32_bf16 v[120:123], a[184:187], v[172:175], v[120:123]
    ds_write_b64 v250, v[56:57] offset:4224
    v_mfma_f32_16x16x32_bf16 v[92:95], a[188:191], v[168:171], v[92:95]
    ds_write_b64 v251, v[60:61] offset:4224
    v_mfma_f32_16x16x32_bf16 v[124:127], a[188:191], v[172:175], v[124:127]
    s_waitcnt lgkmcnt(0)
    ds_read_b128 a[192:195], v212 offset:0
    ds_read_b128 a[196:199], v213 offset:1024
    ds_read_b128 a[200:203], v212 offset:2048
    ds_read_b128 a[204:207], v213 offset:3072
    ds_read_b128 a[208:211], v212 offset:4096
    ds_read_b128 a[212:215], v213 offset:5120
    ds_read_b128 a[216:219], v212 offset:6144
    ds_read_b128 a[220:223], v213 offset:7168
    s_waitcnt lgkmcnt(0)
    s_add_u32 s38, s32, 0
    buffer_store_dwordx4 a[192:195], v214, s[20:23], s38 offen sc1
    s_add_u32 s38, s32, 0
    buffer_store_dwordx4 a[196:199], v214, s[20:23], s38 offen offset:1024 sc1
    s_add_u32 s38, s32, 0
    buffer_store_dwordx4 a[200:203], v214, s[20:23], s38 offen offset:2048 sc1
    s_add_u32 s38, s32, 0
    buffer_store_dwordx4 a[204:207], v214, s[20:23], s38 offen offset:3072 sc1
    s_add_u32 s38, s32, 0x1000
    buffer_store_dwordx4 a[208:211], v214, s[20:23], s38 offen sc1
    s_add_u32 s38, s32, 0x1000
    buffer_store_dwordx4 a[212:215], v214, s[20:23], s38 offen offset:1024 sc1
    s_add_u32 s38, s32, 0x1000
    buffer_store_dwordx4 a[216:219], v214, s[20:23], s38 offen offset:2048 sc1
    s_add_u32 s38, s32, 0x1000
    buffer_store_dwordx4 a[220:223], v214, s[20:23], s38 offen offset:3072 sc1
    s_waitcnt lgkmcnt(0)
    v_pk_mul_f32 v[64:65], v[64:65], v[232:233] op_sel_hi:[1,0]
    v_pk_mul_f32 v[66:67], v[66:67], v[232:233] op_sel_hi:[1,0]
    v_pk_mul_f32 v[68:69], v[68:69], v[232:233] op_sel_hi:[1,0]
    v_pk_mul_f32 v[70:71], v[70:71], v[232:233] op_sel_hi:[1,0]
    v_pk_mul_f32 v[72:73], v[72:73], v[232:233] op_sel_hi:[1,0]
    v_pk_mul_f32 v[74:75], v[74:75], v[232:233] op_sel_hi:[1,0]
    v_pk_mul_f32 v[76:77], v[76:77], v[232:233] op_sel_hi:[1,0]
    v_pk_mul_f32 v[78:79], v[78:79], v[232:233] op_sel_hi:[1,0]
    v_pk_mul_f32 v[80:81], v[80:81], v[232:233] op_sel_hi:[1,0]
    v_pk_mul_f32 v[82:83], v[82:83], v[232:233] op_sel_hi:[1,0]
    v_pk_mul_f32 v[84:85], v[84:85], v[232:233] op_sel_hi:[1,0]
    v_pk_mul_f32 v[86:87], v[86:87], v[232:233] op_sel_hi:[1,0]
    v_pk_mul_f32 v[88:89], v[88:89], v[232:233] op_sel_hi:[1,0]
    v_pk_mul_f32 v[90:91], v[90:91], v[232:233] op_sel_hi:[1,0]
    v_pk_mul_f32 v[92:93], v[92:93], v[232:233] op_sel_hi:[1,0]
    v_pk_mul_f32 v[94:95], v[94:95], v[232:233] op_sel_hi:[1,0]
    v_cvt_pk_bf16_f32 v64, v64, v65
    v_cvt_pk_bf16_f32 v65, v66, v67
    v_cvt_pk_bf16_f32 v68, v68, v69
    v_cvt_pk_bf16_f32 v69, v70, v71
    v_cvt_pk_bf16_f32 v72, v72, v73
    v_cvt_pk_bf16_f32 v73, v74, v75
    v_cvt_pk_bf16_f32 v76, v76, v77
    v_cvt_pk_bf16_f32 v77, v78, v79
    v_cvt_pk_bf16_f32 v80, v80, v81
    v_cvt_pk_bf16_f32 v81, v82, v83
    v_cvt_pk_bf16_f32 v84, v84, v85
    v_cvt_pk_bf16_f32 v85, v86, v87
    v_cvt_pk_bf16_f32 v88, v88, v89
    v_cvt_pk_bf16_f32 v89, v90, v91
    v_cvt_pk_bf16_f32 v92, v92, v93
    v_cvt_pk_bf16_f32 v93, v94, v95
    ds_write_b64 v248, v[64:65] offset:0
    ds_write_b64 v249, v[68:69] offset:0
    ds_write_b64 v250, v[72:73] offset:0
    ds_write_b64 v251, v[76:77] offset:0
    ds_write_b64 v248, v[80:81] offset:128
    ds_write_b64 v249, v[84:85] offset:128
    ds_write_b64 v250, v[88:89] offset:128
    ds_write_b64 v251, v[92:93] offset:128
    v_pk_mul_f32 v[96:97], v[96:97], v[234:235] op_sel_hi:[1,0]
    v_pk_mul_f32 v[98:99], v[98:99], v[234:235] op_sel_hi:[1,0]
    v_pk_mul_f32 v[100:101], v[100:101], v[234:235] op_sel_hi:[1,0]
    v_pk_mul_f32 v[102:103], v[102:103], v[234:235] op_sel_hi:[1,0]
    v_pk_mul_f32 v[104:105], v[104:105], v[234:235] op_sel_hi:[1,0]
    v_pk_mul_f32 v[106:107], v[106:107], v[234:235] op_sel_hi:[1,0]
    v_pk_mul_f32 v[108:109], v[108:109], v[234:235] op_sel_hi:[1,0]
    v_pk_mul_f32 v[110:111], v[110:111], v[234:235] op_sel_hi:[1,0]
    v_pk_mul_f32 v[112:113], v[112:113], v[234:235] op_sel_hi:[1,0]
    v_pk_mul_f32 v[114:115], v[114:115], v[234:235] op_sel_hi:[1,0]
    v_pk_mul_f32 v[116:117], v[116:117], v[234:235] op_sel_hi:[1,0]
    v_pk_mul_f32 v[118:119], v[118:119], v[234:235] op_sel_hi:[1,0]
    v_pk_mul_f32 v[120:121], v[120:121], v[234:235] op_sel_hi:[1,0]
    v_pk_mul_f32 v[122:123], v[122:123], v[234:235] op_sel_hi:[1,0]
    v_pk_mul_f32 v[124:125], v[124:125], v[234:235] op_sel_hi:[1,0]
    v_pk_mul_f32 v[126:127], v[126:127], v[234:235] op_sel_hi:[1,0]
    v_cvt_pk_bf16_f32 v96, v96, v97
    v_cvt_pk_bf16_f32 v97, v98, v99
    v_cvt_pk_bf16_f32 v100, v100, v101
    v_cvt_pk_bf16_f32 v101, v102, v103
    v_cvt_pk_bf16_f32 v104, v104, v105
    v_cvt_pk_bf16_f32 v105, v106, v107
    v_cvt_pk_bf16_f32 v108, v108, v109
    v_cvt_pk_bf16_f32 v109, v110, v111
    v_cvt_pk_bf16_f32 v112, v112, v113
    v_cvt_pk_bf16_f32 v113, v114, v115
    v_cvt_pk_bf16_f32 v116, v116, v117
    v_cvt_pk_bf16_f32 v117, v118, v119
    v_cvt_pk_bf16_f32 v120, v120, v121
    v_cvt_pk_bf16_f32 v121, v122, v123
    v_cvt_pk_bf16_f32 v124, v124, v125
    v_cvt_pk_bf16_f32 v125, v126, v127
    ds_write_b64 v248, v[96:97] offset:4096
    ds_write_b64 v249, v[100:101] offset:4096
    ds_write_b64 v250, v[104:105] offset:4096
    ds_write_b64 v251, v[108:109] offset:4096
    ds_write_b64 v248, v[112:113] offset:4224
    ds_write_b64 v249, v[116:117] offset:4224
    ds_write_b64 v250, v[120:121] offset:4224
    ds_write_b64 v251, v[124:125] offset:4224
    s_waitcnt lgkmcnt(0)
    ds_read_b128 a[224:227], v212 offset:0
    ds_read_b128 a[228:231], v213 offset:1024
    ds_read_b128 a[232:235], v212 offset:2048
    ds_read_b128 a[236:239], v213 offset:3072
    ds_read_b128 a[240:243], v212 offset:4096
    ds_read_b128 a[244:247], v213 offset:5120
    ds_read_b128 a[248:251], v212 offset:6144
    ds_read_b128 a[252:255], v213 offset:7168
    s_waitcnt lgkmcnt(0)
    s_add_u32 s38, s32, 0x2000
    buffer_store_dwordx4 a[224:227], v214, s[20:23], s38 offen sc1
    s_add_u32 s38, s32, 0x2000
    buffer_store_dwordx4 a[228:231], v214, s[20:23], s38 offen offset:1024 sc1
    s_add_u32 s38, s32, 0x2000
    buffer_store_dwordx4 a[232:235], v214, s[20:23], s38 offen offset:2048 sc1
    s_add_u32 s38, s32, 0x2000
    buffer_store_dwordx4 a[236:239], v214, s[20:23], s38 offen offset:3072 sc1
    s_add_u32 s38, s32, 0x3000
    buffer_store_dwordx4 a[240:243], v214, s[20:23], s38 offen sc1
    s_add_u32 s38, s32, 0x3000
    buffer_store_dwordx4 a[244:247], v214, s[20:23], s38 offen offset:1024 sc1
    s_add_u32 s38, s32, 0x3000
    buffer_store_dwordx4 a[248:251], v214, s[20:23], s38 offen offset:2048 sc1
    s_add_u32 s38, s32, 0x3000
    buffer_store_dwordx4 a[252:255], v214, s[20:23], s38 offen offset:3072 sc1
    v_cmp_nlt_f32 vcc, v176, v219
    s_nop 0
    s_mov_b64 s[54:55], vcc
    v_cmp_nlt_f32 vcc, v180, v219
    s_nop 0
    s_or_b64 s[54:55], s[54:55], vcc
    v_cmp_nlt_f32 vcc, v184, v219
    s_nop 0
    s_or_b64 s[54:55], s[54:55], vcc
    v_cmp_nlt_f32 vcc, v188, v219
    s_nop 0
    s_or_b64 s[54:55], s[54:55], vcc
    s_cmp_lg_u64 s[54:55], 0
    s_cselect_b32 s54, s56, 0
    s_or_b32 s39, s39, s54
    s_cmp_eq_u32 s39, 0
    s_cbranch_scc1 L_done
L_slow:
    s_waitcnt vmcnt(0)
    s_mov_b32 s8, s44
    s_mov_b32 s9, s45
    s_mov_b32 s10, 0x4000000
    s_mov_b32 s12, s46
    s_mov_b32 s13, s47
    s_mov_b32 s14, 0x4000000
    s_mov_b32 s16, s48
    s_mov_b32 s17, s49
    s_mov_b32 s18, 0x4000000
    v_lshrrev_b32 v236, 4, v214
    v_and_b32 v237, 15, v236
    v_lshrrev_b32 v238, 4, v236
    v_lshlrev_b32 v240, 4, v238
    v_lshl_add_u32 v240, v237, 8, v240
    v_subrev_u32 v241, s34, v210
    v_subrev_u32 v242, s34, v211
    s_sub_u32 s36, s35, 0x10000
    v_add_u32 v200, s36, v200
    v_add_u32 v201, s36, v201
    v_add_u32 v202, s36, v202
    v_add_u32 v203, s36, v203
    v_add_u32 v204, s36, v204
    v_add_u32 v205, s36, v205
    v_add_u32 v206, s36, v206
    v_add_u32 v207, s36, v207
    v_lshlrev_b32 v243, 3, v238
    v_lshl_add_u32 v243, v237, 8, v243
    s_mov_b32 s86, 0
L_su:
    s_lshr_b32 s36, s39, s86
    s_and_b32 s36, s36, 1
    s_cmp_eq_u32 s36, 0
    s_cbranch_scc1 L_sn
    s_lshl_b32 s36, s86, 24
    s_add_u32 s87, s57, s36
    s_add_u32 s88, s58, s36
    s_add_u32 s37, s88, 0
    buffer_load_dwordx4 a[0:3], v240, s[8:11], s37 offen
    buffer_load_dwordx4 a[4:7], v240, s[8:11], s37 offen offset:64
    buffer_load_dwordx4 a[8:11], v240, s[8:11], s37 offen offset:128
    buffer_load_dwordx4 a[12:15], v240, s[8:11], s37 offen offset:192
    s_add_u32 s37, s88, 0x1000
    buffer_load_dwordx4 a[16:19], v240, s[8:11], s37 offen
    buffer_load_dwordx4 a[20:23], v240, s[8:11], s37 offen offset:64
    buffer_load_dwordx4 a[24:27], v240, s[8:11], s37 offen offset:128
    buffer_load_dwordx4 a[28:31], v240, s[8:11], s37 offen offset:192
    s_add_u32 s37, s88, 0x2000
    buffer_load_dwordx4 a[32:35], v240, s[8:11], s37 offen
    buffer_load_dwordx4 a[36:39], v240, s[8:11], s37 offen offset:64
    buffer_load_dwordx4 a[40:43], v240, s[8:11], s37 offen offset:128
    buffer_load_dwordx4 a[44:47], v240, s[8:11], s37 offen offset:192
    s_add_u32 s37, s88, 0x3000
    buffer_load_dwordx4 a[48:51], v240, s[8:11], s37 offen
    buffer_load_dwordx4 a[52:55], v240, s[8:11], s37 offen offset:64
    buffer_load_dwordx4 a[56:59], v240, s[8:11], s37 offen offset:128
    buffer_load_dwordx4 a[60:63], v240, s[8:11], s37 offen offset:192
    v_mov_b32 v0, 0
    v_mov_b32 v1, 0
    v_mov_b32 v2, 0
    v_mov_b32 v3, 0
    v_mov_b32 v4, 0
    v_mov_b32 v5, 0
    v_mov_b32 v6, 0
    v_mov_b32 v7, 0
    v_mov_b32 v8, 0
    v_mov_b32 v9, 0
    v_mov_b32 v10, 0
    v_mov_b32 v11, 0
    v_mov_b32 v12, 0
    v_mov_b32 v13, 0
    v_mov_b32 v14, 0
    v_mov_b32 v15, 0
    v_mov_b32 v16, 0
    v_mov_b32 v17, 0
    v_mov_b32 v18, 0
    v_mov_b32 v19, 0
    v_mov_b32 v20, 0
    v_mov_b32 v21, 0
    v_mov_b32 v22, 0
    v_mov_b32 v23, 0
    v_mov_b32 v24, 0
    v_mov_b32 v25, 0
    v_mov_b32 v26, 0
    v_mov_b32 v27, 0
    v_mov_b32 v28, 0
    v_mov_b32 v29, 0
    v_mov_b32 v30, 0
    v_mov_b32 v31, 0
    v_mov_b32 v32, 0
    v_mov_b32 v33, 0
    v_mov_b32 v34, 0
    v_mov_b32 v35, 0
    v_mov_b32 v36, 0
    v_mov_b32 v37, 0
    v_mov_b32 v38, 0
    v_mov_b32 v39, 0
    v_mov_b32 v40, 0
    v_mov_b32 v41, 0
    v_mov_b32 v42, 0
    v_mov_b32 v43, 0
    v_mov_b32 v44, 0
    v_mov_b32 v45, 0
    v_mov_b32 v46, 0
    v_mov_b32 v47, 0
    v_mov_b32 v48, 0
    v_mov_b32 v49, 0
    v_mov_b32 v50, 0
    v_mov_b32 v51, 0
    v_mov_b32 v52, 0
    v_mov_b32 v53, 0
    v_mov_b32 v54, 0
    v_mov_b32 v55, 0
    v_mov_b32 v56, 0
    v_mov_b32 v57, 0
    v_mov_b32 v58, 0
    v_mov_b32 v59, 0
    v_mov_b32 v60, 0
    v_mov_b32 v61, 0
    v_mov_b32 v62, 0
    v_mov_b32 v63, 0
    v_mov_b32 v64, 0
    v_mov_b32 v65, 0
    v_mov_b32 v66, 0
    v_mov_b32 v67, 0
    v_mov_b32 v68, 0
    v_mov_b32 v69, 0
    v_mov_b32 v70, 0
    v_mov_b32 v71, 0
    v_mov_b32 v72, 0
    v_mov_b32 v73, 0
    v_mov_b32 v74, 0
    v_mov_b32 v75, 0
    v_mov_b32 v76, 0
    v_mov_b32 v77, 0
    v_mov_b32 v78, 0
    v_mov_b32 v79, 0
    v_mov_b32 v80, 0
    v_mov_b32 v81, 0
    v_mov_b32 v82, 0
    v_mov_b32 v83, 0
    v_mov_b32 v84, 0
    v_mov_b32 v85, 0
    v_mov_b32 v86, 0
    v_mov_b32 v87, 0
    v_mov_b32 v88, 0
    v_mov_b32 v89, 0
    v_mov_b32 v90, 0
    v_mov_b32 v91, 0
    v_mov_b32 v92, 0
    v_mov_b32 v93, 0
    v_mov_b32 v94, 0
    v_mov_b32 v95, 0
    v_mov_b32 v96, 0
    v_mov_b32 v97, 0
    v_mov_b32 v98, 0
    v_mov_b32 v99, 0
    v_mov_b32 v100, 0
    v_mov_b32 v101, 0
    v_mov_b32 v102, 0
    v_mov_b32 v103, 0
    v_mov_b32 v104, 0
    v_mov_b32 v105, 0
    v_mov_b32 v106, 0
    v_mov_b32 v107, 0
    v_mov_b32 v108, 0
    v_mov_b32 v109, 0
    v_mov_b32 v110, 0
    v_mov_b32 v111, 0
    v_mov_b32 v112, 0
    v_mov_b32 v113, 0
    v_mov_b32 v114, 0
    v_mov_b32 v115, 0
    v_mov_b32 v116, 0
    v_mov_b32 v117, 0
    v_mov_b32 v118, 0
    v_mov_b32 v119, 0
    v_mov_b32 v120, 0
    v_mov_b32 v121, 0
    v_mov_b32 v122, 0
    v_mov_b32 v123, 0
    v_mov_b32 v124, 0
    v_mov_b32 v125, 0
    v_mov_b32 v126, 0
    v_mov_b32 v127, 0
    v_mov_b32 v176, 0
    v_mov_b32 v177, 0
    v_mov_b32 v178, 0
    v_mov_b32 v179, 0
    v_mov_b32 v180, 0
    v_mov_b32 v181, 0
    v_mov_b32 v182, 0
    v_mov_b32 v183, 0
    v_mov_b32 v184, 0
    v_mov_b32 v185, 0
    v_mov_b32 v186, 0
    v_mov_b32 v187, 0
    v_mov_b32 v188, 0
    v_mov_b32 v189, 0
    v_mov_b32 v190, 0
    v_mov_b32 v191, 0
    v_mov_b32 v224, 0xff800000
    v_mov_b32 v225, 0xff800000
    v_mov_b32 v226, 0xff800000
    v_mov_b32 v227, 0xff800000
    s_mov_b32 s89, 0
L_st:
    s_add_u32 s90, s87, s89
    s_add_u32 s37, s90, 0
    buffer_load_dwordx4 a[128:131], v240, s[12:15], s37 offen
    buffer_load_dwordx4 a[132:135], v240, s[12:15], s37 offen offset:64
    buffer_load_dwordx4 a[136:139], v240, s[12:15], s37 offen offset:128
    buffer_load_dwordx4 a[140:143], v240, s[12:15], s37 offen offset:192
    s_add_u32 s37, s90, 0x1000
    buffer_load_dwordx4 a[144:147], v240, s[12:15], s37 offen
    buffer_load_dwordx4 a[148:151], v240, s[12:15], s37 offen offset:64
    buffer_load_dwordx4 a[152:155], v240, s[12:15], s37 offen offset:128
    buffer_load_dwordx4 a[156:159], v240, s[12:15], s37 offen offset:192
    s_add_u32 s37, s90, 0
    s_add_u32 m0, s35, 0
    s_nop 0
    buffer_load_dwordx4 v241, s[16:19], s37 offen lds
    buffer_load_dwordx4 v242, s[16:19], s37 offen offset:1024 lds
    s_add_u32 s37, s90, 0x800
    s_add_u32 m0, s35, 0x800
    s_nop 0
    buffer_load_dwordx4 v241, s[16:19], s37 offen lds
    buffer_load_dwordx4 v242, s[16:19], s37 offen offset:1024 lds
    s_add_u32 s37, s90, 0x1000
    s_add_u32 m0, s35, 0x1000
    s_nop 0
    buffer_load_dwordx4 v241, s[16:19], s37 offen lds
    buffer_load_dwordx4 v242, s[16:19], s37 offen offset:1024 lds
    s_add_u32 s37, s90, 0x1800
    s_add_u32 m0, s35, 0x1800
    s_nop 0
    buffer_load_dwordx4 v241, s[16:19], s37 offen lds
    buffer_load_dwordx4 v242, s[16:19], s37 offen offset:1024 lds
    s_waitcnt vmcnt(0)
    ds_read_b64_tr_b16 a[160:161], v200 offset:0
    ds_read_b64_tr_b16 a[162:163], v200 offset:4096
    ds_read_b64_tr_b16 a[164:165], v201 offset:0
    ds_read_b64_tr_b16 a[166:167], v201 offset:4096
    ds_read_b64_tr_b16 a[168:169], v202 offset:0
    ds_read_b64_tr_b16 a[170:171], v202 offset:4096
    ds_read_b64_tr_b16 a[172:173], v203 offset:0
    ds_read_b64_tr_b16 a[174:175], v203 offset:4096
    s_waitcnt lgkmcnt(0)
    ds_read_b64_tr_b16 a[176:177], v204 offset:0
    ds_read_b64_tr_b16 a[178:179], v204 offset:4096
    ds_read_b64_tr_b16 a[180:181], v205 offset:0
    ds_read_b64_tr_b16 a[182:183], v205 offset:4096
    ds_read_b64_tr_b16 a[184:185], v206 offset:0
    ds_read_b64_tr_b16 a[186:187], v206 offset:4096
    ds_read_b64_tr_b16 a[188:189], v207 offset:0
    ds_read_b64_tr_b16 a[190:191], v207 offset:4096
    v_mfma_f32_16x16x32_bf16 v[128:131], a[128:131], a[0:3], 0
    v_mfma_f32_16x16x32_bf16 v[128:131], a[132:135], a[4:7], v[128:131]
    v_mfma_f32_16x16x32_bf16 v[128:131], a[136:139], a[8:11], v[128:131]
    v_mfma_f32_16x16x32_bf16 v[128:131], a[140:143], a[12:15], v[128:131]
    v_mfma_f32_16x16x32_bf16 v[132:135], a[128:131], a[16:19], 0
    v_mfma_f32_16x16x32_bf16 v[132:135], a[132:135], a[20:23], v[132:135]
    v_mfma_f32_16x16x32_bf16 v[132:135], a[136:139], a[24:27], v[132:135]
    v_mfma_f32_16x16x32_bf16 v[132:135], a[140:143], a[28:31], v[132:135]
    v_mfma_f32_16x16x32_bf16 v[136:139], a[144:147], a[0:3], 0
    v_mfma_f32_16x16x32_bf16 v[136:139], a[148:151], a[4:7], v[136:139]
    v_mfma_f32_16x16x32_bf16 v[136:139], a[152:155], a[8:11], v[136:139]
    v_mfma_f32_16x16x32_bf16 v[136:139], a[156:159], a[12:15], v[136:139]
    v_mfma_f32_16x16x32_bf16 v[140:143], a[144:147], a[16:19], 0
    v_mfma_f32_16x16x32_bf16 v[140:143], a[148:151], a[20:23], v[140:143]
    v_mfma_f32_16x16x32_bf16 v[140:143], a[152:155], a[24:27], v[140:143]
    v_mfma_f32_16x16x32_bf16 v[140:143], a[156:159], a[28:31], v[140:143]
    v_mfma_f32_16x16x32_bf16 v[144:147], a[128:131], a[32:35], 0
    v_mfma_f32_16x16x32_bf16 v[144:147], a[132:135], a[36:39], v[144:147]
    v_mfma_f32_16x16x32_bf16 v[144:147], a[136:139], a[40:43], v[144:147]
    v_mfma_f32_16x16x32_bf16 v[144:147], a[140:143], a[44:47], v[144:147]
    v_mfma_f32_16x16x32_bf16 v[148:151], a[128:131], a[48:51], 0
    v_mfma_f32_16x16x32_bf16 v[148:151], a[132:135], a[52:55], v[148:151]
    v_mfma_f32_16x16x32_bf16 v[148:151], a[136:139], a[56:59], v[148:151]
    v_mfma_f32_16x16x32_bf16 v[148:151], a[140:143], a[60:63], v[148:151]
    v_mfma_f32_16x16x32_bf16 v[152:155], a[144:147], a[32:35], 0
    v_mfma_f32_16x16x32_bf16 v[152:155], a[148:151], a[36:39], v[152:155]
    v_mfma_f32_16x16x32_bf16 v[152:155], a[152:155], a[40:43], v[152:155]
    v_mfma_f32_16x16x32_bf16 v[152:155], a[156:159], a[44:47], v[152:155]
    v_mfma_f32_16x16x32_bf16 v[156:159], a[144:147], a[48:51], 0
    v_mfma_f32_16x16x32_bf16 v[156:159], a[148:151], a[52:55], v[156:159]
    v_mfma_f32_16x16x32_bf16 v[156:159], a[152:155], a[56:59], v[156:159]
    v_mfma_f32_16x16x32_bf16 v[156:159], a[156:159], a[60:63], v[156:159]
    s_waitcnt lgkmcnt(0)
    v_max3_f32 v228, v128, v129, v130
    v_max3_f32 v228, v228, v131, v136
    v_max3_f32 v228, v228, v137, v138
    v_max_f32 v228, v228, v139
    v_mov_b32 v236, v228
    s_nop 1
    v_permlane16_swap_b32 v228, v236
    v_max_f32 v228, v228, v236
    v_mov_b32 v236, v228
    s_nop 1
    v_permlane32_swap_b32 v228, v236
    v_max_f32 v228, v228, v236
    v_mul_f32 v228, s28, v228
    v_max_f32 v228, v228, v224
    v_sub_f32 v232, v224, v228
    v_exp_f32 v232, v232
    v_mov_b32 v224, v228
    v_fma_f32 v128, v128, s28, -v228
    v_fma_f32 v129, v129, s28, -v228
    v_fma_f32 v130, v130, s28, -v228
    v_fma_f32 v131, v131, s28, -v228
    v_exp_f32 v128, v128
    v_exp_f32 v129, v129
    v_exp_f32 v130, v130
    v_exp_f32 v131, v131
    v_cvt_pk_bf16_f32 v160, v128, v129
    v_cvt_pk_bf16_f32 v161, v130, v131
    v_fma_f32 v136, v136, s28, -v228
    v_fma_f32 v137, v137, s28, -v228
    v_fma_f32 v138, v138, s28, -v228
    v_fma_f32 v139, v139, s28, -v228
    v_exp_f32 v136, v136
    v_exp_f32 v137, v137
    v_exp_f32 v138, v138
    v_exp_f32 v139, v139
    v_cvt_pk_bf16_f32 v162, v136, v137
    v_cvt_pk_bf16_f32 v163, v138, v139
    v_mul_f32 v0, v0, v232
    v_mul_f32 v1, v1, v232
    v_mul_f32 v2, v2, v232
    v_mul_f32 v3, v3, v232
    v_mul_f32 v4, v4, v232
    v_mul_f32 v5, v5, v232
    v_mul_f32 v6, v6, v232
    v_mul_f32 v7, v7, v232
    v_mul_f32 v8, v8, v232
    v_mul_f32 v9, v9, v232
    v_mul_f32 v10, v10, v232
    v_mul_f32 v11, v11, v232
    v_mul_f32 v12, v12, v232
    v_mul_f32 v13, v13, v232
    v_mul_f32 v14, v14, v232
    v_mul_f32 v15, v15, v232
    v_mul_f32 v16, v16, v232
    v_mul_f32 v17, v17, v232
    v_mul_f32 v18, v18, v232
    v_mul_f32 v19, v19, v232
    v_mul_f32 v20, v20, v232
    v_mul_f32 v21, v21, v232
    v_mul_f32 v22, v22, v232
    v_mul_f32 v23, v23, v232
    v_mul_f32 v24, v24, v232
    v_mul_f32 v25, v25, v232
    v_mul_f32 v26, v26, v232
    v_mul_f32 v27, v27, v232
    v_mul_f32 v28, v28, v232
    v_mul_f32 v29, v29, v232
    v_mul_f32 v30, v30, v232
    v_mul_f32 v31, v31, v232
    v_mul_f32 v176, v176, v232
    v_mul_f32 v177, v177, v232
    v_mul_f32 v178, v178, v232
    v_mul_f32 v179, v179, v232
    v_mfma_f32_16x16x32_bf16 v[0:3], a[160:163], v[160:163], v[0:3]
    v_mfma_f32_16x16x32_bf16 v[4:7], a[164:167], v[160:163], v[4:7]
    v_mfma_f32_16x16x32_bf16 v[8:11], a[168:171], v[160:163], v[8:11]
    v_mfma_f32_16x16x32_bf16 v[12:15], a[172:175], v[160:163], v[12:15]
    v_mfma_f32_16x16x32_bf16 v[16:19], a[176:179], v[160:163], v[16:19]
    v_mfma_f32_16x16x32_bf16 v[20:23], a[180:183], v[160:163], v[20:23]
    v_mfma_f32_16x16x32_bf16 v[24:27], a[184:187], v[160:163], v[24:27]
    v_mfma_f32_16x16x32_bf16 v[28:31], a[188:191], v[160:163], v[28:31]
    v_mfma_f32_16x16x32_bf16 v[176:179], v[220:223], v[160:163], v[176:179]
    v_max3_f32 v229, v132, v133, v134
    v_max3_f32 v229, v229, v135, v140
    v_max3_f32 v229, v229, v141, v142
    v_max_f32 v229, v229, v143
    v_mov_b32 v236, v229
    s_nop 1
    v_permlane16_swap_b32 v229, v236
    v_max_f32 v229, v229, v236
    v_mov_b32 v236, v229
    s_nop 1
    v_permlane32_swap_b32 v229, v236
    v_max_f32 v229, v229, v236
    v_mul_f32 v229, s28, v229
    v_max_f32 v229, v229, v225
    v_sub_f32 v233, v225, v229
    v_exp_f32 v233, v233
    v_mov_b32 v225, v229
    v_fma_f32 v132, v132, s28, -v229
    v_fma_f32 v133, v133, s28, -v229
    v_fma_f32 v134, v134, s28, -v229
    v_fma_f32 v135, v135, s28, -v229
    v_exp_f32 v132, v132
    v_exp_f32 v133, v133
    v_exp_f32 v134, v134
    v_exp_f32 v135, v135
    v_cvt_pk_bf16_f32 v164, v132, v133
    v_cvt_pk_bf16_f32 v165, v134, v135
    v_fma_f32 v140, v140, s28, -v229
    v_fma_f32 v141, v141, s28, -v229
    v_fma_f32 v142, v142, s28, -v229
    v_fma_f32 v143, v143, s28, -v229
    v_exp_f32 v140, v140
    v_exp_f32 v141, v141
    v_exp_f32 v142, v142
    v_exp_f32 v143, v143
    v_cvt_pk_bf16_f32 v166, v140, v141
    v_cvt_pk_bf16_f32 v167, v142, v143
    v_mul_f32 v32, v32, v233
    v_mul_f32 v33, v33, v233
    v_mul_f32 v34, v34, v233
    v_mul_f32 v35, v35, v233
    v_mul_f32 v36, v36, v233
    v_mul_f32 v37, v37, v233
    v_mul_f32 v38, v38, v233
    v_mul_f32 v39, v39, v233
    v_mul_f32 v40, v40, v233
    v_mul_f32 v41, v41, v233
    v_mul_f32 v42, v42, v233
    v_mul_f32 v43, v43, v233
    v_mul_f32 v44, v44, v233
    v_mul_f32 v45, v45, v233
    v_mul_f32 v46, v46, v233
    v_mul_f32 v47, v47, v233
    v_mul_f32 v48, v48, v233
    v_mul_f32 v49, v49, v233
    v_mul_f32 v50, v50, v233
    v_mul_f32 v51, v51, v233
    v_mul_f32 v52, v52, v233
    v_mul_f32 v53, v53, v233
    v_mul_f32 v54, v54, v233
    v_mul_f32 v55, v55, v233
    v_mul_f32 v56, v56, v233
    v_mul_f32 v57, v57, v233
    v_mul_f32 v58, v58, v233
    v_mul_f32 v59, v59, v233
    v_mul_f32 v60, v60, v233
    v_mul_f32 v61, v61, v233
    v_mul_f32 v62, v62, v233
    v_mul_f32 v63, v63, v233
    v_mul_f32 v180, v180, v233
    v_mul_f32 v181, v181, v233
    v_mul_f32 v182, v182, v233
    v_mul_f32 v183, v183, v233
    v_mfma_f32_16x16x32_bf16 v[32:35], a[160:163], v[164:167], v[32:35]
    v_mfma_f32_16x16x32_bf16 v[36:39], a[164:167], v[164:167], v[36:39]
    v_mfma_f32_16x16x32_bf16 v[40:43], a[168:171], v[164:167], v[40:43]
    v_mfma_f32_16x16x32_bf16 v[44:47], a[172:175], v[164:167], v[44:47]
    v_mfma_f32_16x16x32_bf16 v[48:51], a[176:179], v[164:167], v[48:51]
    v_mfma_f32_16x16x32_bf16 v[52:55], a[180:183], v[164:167], v[52:55]
    v_mfma_f32_16x16x32_bf16 v[56:59], a[184:187], v[164:167], v[56:59]
    v_mfma_f32_16x16x32_bf16 v[60:63], a[188:191], v[164:167], v[60:63]
    v_mfma_f32_16x16x32_bf16 v[180:183], v[220:223], v[164:167], v[180:183]
    v_max3_f32 v230, v144, v145, v146
    v_max3_f32 v230, v230, v147, v152
    v_max3_f32 v230, v230, v153, v154
    v_max_f32 v230, v230, v155
    v_mov_b32 v236, v230
    s_nop 1
    v_permlane16_swap_b32 v230, v236
    v_max_f32 v230, v230, v236
    v_mov_b32 v236, v230
    s_nop 1
    v_permlane32_swap_b32 v230, v236
    v_max_f32 v230, v230, v236
    v_mul_f32 v230, s28, v230
    v_max_f32 v230, v230, v226
    v_sub_f32 v234, v226, v230
    v_exp_f32 v234, v234
    v_mov_b32 v226, v230
    v_fma_f32 v144, v144, s28, -v230
    v_fma_f32 v145, v145, s28, -v230
    v_fma_f32 v146, v146, s28, -v230
    v_fma_f32 v147, v147, s28, -v230
    v_exp_f32 v144, v144
    v_exp_f32 v145, v145
    v_exp_f32 v146, v146
    v_exp_f32 v147, v147
    v_cvt_pk_bf16_f32 v168, v144, v145
    v_cvt_pk_bf16_f32 v169, v146, v147
    v_fma_f32 v152, v152, s28, -v230
    v_fma_f32 v153, v153, s28, -v230
    v_fma_f32 v154, v154, s28, -v230
    v_fma_f32 v155, v155, s28, -v230
    v_exp_f32 v152, v152
    v_exp_f32 v153, v153
    v_exp_f32 v154, v154
    v_exp_f32 v155, v155
    v_cvt_pk_bf16_f32 v170, v152, v153
    v_cvt_pk_bf16_f32 v171, v154, v155
    v_mul_f32 v64, v64, v234
    v_mul_f32 v65, v65, v234
    v_mul_f32 v66, v66, v234
    v_mul_f32 v67, v67, v234
    v_mul_f32 v68, v68, v234
    v_mul_f32 v69, v69, v234
    v_mul_f32 v70, v70, v234
    v_mul_f32 v71, v71, v234
    v_mul_f32 v72, v72, v234
    v_mul_f32 v73, v73, v234
    v_mul_f32 v74, v74, v234
    v_mul_f32 v75, v75, v234
    v_mul_f32 v76, v76, v234
    v_mul_f32 v77, v77, v234
    v_mul_f32 v78, v78, v234
    v_mul_f32 v79, v79, v234
    v_mul_f32 v80, v80, v234
    v_mul_f32 v81, v81, v234
    v_mul_f32 v82, v82, v234
    v_mul_f32 v83, v83, v234
    v_mul_f32 v84, v84, v234
    v_mul_f32 v85, v85, v234
    v_mul_f32 v86, v86, v234
    v_mul_f32 v87, v87, v234
    v_mul_f32 v88, v88, v234
    v_mul_f32 v89, v89, v234
    v_mul_f32 v90, v90, v234
    v_mul_f32 v91, v91, v234
    v_mul_f32 v92, v92, v234
    v_mul_f32 v93, v93, v234
    v_mul_f32 v94, v94, v234
    v_mul_f32 v95, v95, v234
    v_mul_f32 v184, v184, v234
    v_mul_f32 v185, v185, v234
    v_mul_f32 v186, v186, v234
    v_mul_f32 v187, v187, v234
    v_mfma_f32_16x16x32_bf16 v[64:67], a[160:163], v[168:171], v[64:67]
    v_mfma_f32_16x16x32_bf16 v[68:71], a[164:167], v[168:171], v[68:71]
    v_mfma_f32_16x16x32_bf16 v[72:75], a[168:171], v[168:171], v[72:75]
    v_mfma_f32_16x16x32_bf16 v[76:79], a[172:175], v[168:171], v[76:79]
    v_mfma_f32_16x16x32_bf16 v[80:83], a[176:179], v[168:171], v[80:83]
    v_mfma_f32_16x16x32_bf16 v[84:87], a[180:183], v[168:171], v[84:87]
    v_mfma_f32_16x16x32_bf16 v[88:91], a[184:187], v[168:171], v[88:91]
    v_mfma_f32_16x16x32_bf16 v[92:95], a[188:191], v[168:171], v[92:95]
    v_mfma_f32_16x16x32_bf16 v[184:187], v[220:223], v[168:171], v[184:187]
    v_max3_f32 v231, v148, v149, v150
    v_max3_f32 v231, v231, v151, v156
    v_max3_f32 v231, v231, v157, v158
    v_max_f32 v231, v231, v159
    v_mov_b32 v236, v231
    s_nop 1
    v_permlane16_swap_b32 v231, v236
    v_max_f32 v231, v231, v236
    v_mov_b32 v236, v231
    s_nop 1
    v_permlane32_swap_b32 v231, v236
    v_max_f32 v231, v231, v236
    v_mul_f32 v231, s28, v231
    v_max_f32 v231, v231, v227
    v_sub_f32 v235, v227, v231
    v_exp_f32 v235, v235
    v_mov_b32 v227, v231
    v_fma_f32 v148, v148, s28, -v231
    v_fma_f32 v149, v149, s28, -v231
    v_fma_f32 v150, v150, s28, -v231
    v_fma_f32 v151, v151, s28, -v231
    v_exp_f32 v148, v148
    v_exp_f32 v149, v149
    v_exp_f32 v150, v150
    v_exp_f32 v151, v151
    v_cvt_pk_bf16_f32 v172, v148, v149
    v_cvt_pk_bf16_f32 v173, v150, v151
    v_fma_f32 v156, v156, s28, -v231
    v_fma_f32 v157, v157, s28, -v231
    v_fma_f32 v158, v158, s28, -v231
    v_fma_f32 v159, v159, s28, -v231
    v_exp_f32 v156, v156
    v_exp_f32 v157, v157
    v_exp_f32 v158, v158
    v_exp_f32 v159, v159
    v_cvt_pk_bf16_f32 v174, v156, v157
    v_cvt_pk_bf16_f32 v175, v158, v159
    v_mul_f32 v96, v96, v235
    v_mul_f32 v97, v97, v235
    v_mul_f32 v98, v98, v235
    v_mul_f32 v99, v99, v235
    v_mul_f32 v100, v100, v235
    v_mul_f32 v101, v101, v235
    v_mul_f32 v102, v102, v235
    v_mul_f32 v103, v103, v235
    v_mul_f32 v104, v104, v235
    v_mul_f32 v105, v105, v235
    v_mul_f32 v106, v106, v235
    v_mul_f32 v107, v107, v235
    v_mul_f32 v108, v108, v235
    v_mul_f32 v109, v109, v235
    v_mul_f32 v110, v110, v235
    v_mul_f32 v111, v111, v235
    v_mul_f32 v112, v112, v235
    v_mul_f32 v113, v113, v235
    v_mul_f32 v114, v114, v235
    v_mul_f32 v115, v115, v235
    v_mul_f32 v116, v116, v235
    v_mul_f32 v117, v117, v235
    v_mul_f32 v118, v118, v235
    v_mul_f32 v119, v119, v235
    v_mul_f32 v120, v120, v235
    v_mul_f32 v121, v121, v235
    v_mul_f32 v122, v122, v235
    v_mul_f32 v123, v123, v235
    v_mul_f32 v124, v124, v235
    v_mul_f32 v125, v125, v235
    v_mul_f32 v126, v126, v235
    v_mul_f32 v127, v127, v235
    v_mul_f32 v188, v188, v235
    v_mul_f32 v189, v189, v235
    v_mul_f32 v190, v190, v235
    v_mul_f32 v191, v191, v235
    v_mfma_f32_16x16x32_bf16 v[96:99], a[160:163], v[172:175], v[96:99]
    v_mfma_f32_16x16x32_bf16 v[100:103], a[164:167], v[172:175], v[100:103]
    v_mfma_f32_16x16x32_bf16 v[104:107], a[168:171], v[172:175], v[104:107]
    v_mfma_f32_16x16x32_bf16 v[108:111], a[172:175], v[172:175], v[108:111]
    v_mfma_f32_16x16x32_bf16 v[112:115], a[176:179], v[172:175], v[112:115]
    v_mfma_f32_16x16x32_bf16 v[116:119], a[180:183], v[172:175], v[116:119]
    v_mfma_f32_16x16x32_bf16 v[120:123], a[184:187], v[172:175], v[120:123]
    v_mfma_f32_16x16x32_bf16 v[124:127], a[188:191], v[172:175], v[124:127]
    v_mfma_f32_16x16x32_bf16 v[188:191], v[220:223], v[172:175], v[188:191]
    s_nop 11
    s_add_u32 s89, s89, 0x2000
    s_cmp_lt_u32 s89, 0x20000
    s_cbranch_scc1 L_st
    v_rcp_f32 v232, v176
    s_add_u32 s37, s88, 0
    v_mul_f32 v0, v0, v232
    v_mul_f32 v1, v1, v232
    v_mul_f32 v2, v2, v232
    v_mul_f32 v3, v3, v232
    v_cvt_pk_bf16_f32 v0, v0, v1
    v_cvt_pk_bf16_f32 v1, v2, v3
    buffer_store_dwordx2 v[0:1], v243, s[20:23], s37 offen
    v_mul_f32 v4, v4, v232
    v_mul_f32 v5, v5, v232
    v_mul_f32 v6, v6, v232
    v_mul_f32 v7, v7, v232
    v_cvt_pk_bf16_f32 v4, v4, v5
    v_cvt_pk_bf16_f32 v5, v6, v7
    buffer_store_dwordx2 v[4:5], v243, s[20:23], s37 offen offset:32
    v_mul_f32 v8, v8, v232
    v_mul_f32 v9, v9, v232
    v_mul_f32 v10, v10, v232
    v_mul_f32 v11, v11, v232
    v_cvt_pk_bf16_f32 v8, v8, v9
    v_cvt_pk_bf16_f32 v9, v10, v11
    buffer_store_dwordx2 v[8:9], v243, s[20:23], s37 offen offset:64
    v_mul_f32 v12, v12, v232
    v_mul_f32 v13, v13, v232
    v_mul_f32 v14, v14, v232
    v_mul_f32 v15, v15, v232
    v_cvt_pk_bf16_f32 v12, v12, v13
    v_cvt_pk_bf16_f32 v13, v14, v15
    buffer_store_dwordx2 v[12:13], v243, s[20:23], s37 offen offset:96
    v_mul_f32 v16, v16, v232
    v_mul_f32 v17, v17, v232
    v_mul_f32 v18, v18, v232
    v_mul_f32 v19, v19, v232
    v_cvt_pk_bf16_f32 v16, v16, v17
    v_cvt_pk_bf16_f32 v17, v18, v19
    buffer_store_dwordx2 v[16:17], v243, s[20:23], s37 offen offset:128
    v_mul_f32 v20, v20, v232
    v_mul_f32 v21, v21, v232
    v_mul_f32 v22, v22, v232
    v_mul_f32 v23, v23, v232
    v_cvt_pk_bf16_f32 v20, v20, v21
    v_cvt_pk_bf16_f32 v21, v22, v23
    buffer_store_dwordx2 v[20:21], v243, s[20:23], s37 offen offset:160
    v_mul_f32 v24, v24, v232
    v_mul_f32 v25, v25, v232
    v_mul_f32 v26, v26, v232
    v_mul_f32 v27, v27, v232
    v_cvt_pk_bf16_f32 v24, v24, v25
    v_cvt_pk_bf16_f32 v25, v26, v27
    buffer_store_dwordx2 v[24:25], v243, s[20:23], s37 offen offset:192
    v_mul_f32 v28, v28, v232
    v_mul_f32 v29, v29, v232
    v_mul_f32 v30, v30, v232
    v_mul_f32 v31, v31, v232
    v_cvt_pk_bf16_f32 v28, v28, v29
    v_cvt_pk_bf16_f32 v29, v30, v31
    buffer_store_dwordx2 v[28:29], v243, s[20:23], s37 offen offset:224
    v_rcp_f32 v233, v180
    s_add_u32 s37, s88, 0x1000
    v_mul_f32 v32, v32, v233
    v_mul_f32 v33, v33, v233
    v_mul_f32 v34, v34, v233
    v_mul_f32 v35, v35, v233
    v_cvt_pk_bf16_f32 v32, v32, v33
    v_cvt_pk_bf16_f32 v33, v34, v35
    buffer_store_dwordx2 v[32:33], v243, s[20:23], s37 offen
    v_mul_f32 v36, v36, v233
    v_mul_f32 v37, v37, v233
    v_mul_f32 v38, v38, v233
    v_mul_f32 v39, v39, v233
    v_cvt_pk_bf16_f32 v36, v36, v37
    v_cvt_pk_bf16_f32 v37, v38, v39
    buffer_store_dwordx2 v[36:37], v243, s[20:23], s37 offen offset:32
    v_mul_f32 v40, v40, v233
    v_mul_f32 v41, v41, v233
    v_mul_f32 v42, v42, v233
    v_mul_f32 v43, v43, v233
    v_cvt_pk_bf16_f32 v40, v40, v41
    v_cvt_pk_bf16_f32 v41, v42, v43
    buffer_store_dwordx2 v[40:41], v243, s[20:23], s37 offen offset:64
    v_mul_f32 v44, v44, v233
    v_mul_f32 v45, v45, v233
    v_mul_f32 v46, v46, v233
    v_mul_f32 v47, v47, v233
    v_cvt_pk_bf16_f32 v44, v44, v45
    v_cvt_pk_bf16_f32 v45, v46, v47
    buffer_store_dwordx2 v[44:45], v243, s[20:23], s37 offen offset:96
    v_mul_f32 v48, v48, v233
    v_mul_f32 v49, v49, v233
    v_mul_f32 v50, v50, v233
    v_mul_f32 v51, v51, v233
    v_cvt_pk_bf16_f32 v48, v48, v49
    v_cvt_pk_bf16_f32 v49, v50, v51
    buffer_store_dwordx2 v[48:49], v243, s[20:23], s37 offen offset:128
    v_mul_f32 v52, v52, v233
    v_mul_f32 v53, v53, v233
    v_mul_f32 v54, v54, v233
    v_mul_f32 v55, v55, v233
    v_cvt_pk_bf16_f32 v52, v52, v53
    v_cvt_pk_bf16_f32 v53, v54, v55
    buffer_store_dwordx2 v[52:53], v243, s[20:23], s37 offen offset:160
    v_mul_f32 v56, v56, v233
    v_mul_f32 v57, v57, v233
    v_mul_f32 v58, v58, v233
    v_mul_f32 v59, v59, v233
    v_cvt_pk_bf16_f32 v56, v56, v57
    v_cvt_pk_bf16_f32 v57, v58, v59
    buffer_store_dwordx2 v[56:57], v243, s[20:23], s37 offen offset:192
    v_mul_f32 v60, v60, v233
    v_mul_f32 v61, v61, v233
    v_mul_f32 v62, v62, v233
    v_mul_f32 v63, v63, v233
    v_cvt_pk_bf16_f32 v60, v60, v61
    v_cvt_pk_bf16_f32 v61, v62, v63
    buffer_store_dwordx2 v[60:61], v243, s[20:23], s37 offen offset:224
    v_rcp_f32 v234, v184
    s_add_u32 s37, s88, 0x2000
    v_mul_f32 v64, v64, v234
    v_mul_f32 v65, v65, v234
    v_mul_f32 v66, v66, v234
    v_mul_f32 v67, v67, v234
    v_cvt_pk_bf16_f32 v64, v64, v65
    v_cvt_pk_bf16_f32 v65, v66, v67
    buffer_store_dwordx2 v[64:65], v243, s[20:23], s37 offen
    v_mul_f32 v68, v68, v234
    v_mul_f32 v69, v69, v234
    v_mul_f32 v70, v70, v234
    v_mul_f32 v71, v71, v234
    v_cvt_pk_bf16_f32 v68, v68, v69
    v_cvt_pk_bf16_f32 v69, v70, v71
    buffer_store_dwordx2 v[68:69], v243, s[20:23], s37 offen offset:32
    v_mul_f32 v72, v72, v234
    v_mul_f32 v73, v73, v234
    v_mul_f32 v74, v74, v234
    v_mul_f32 v75, v75, v234
    v_cvt_pk_bf16_f32 v72, v72, v73
    v_cvt_pk_bf16_f32 v73, v74, v75
    buffer_store_dwordx2 v[72:73], v243, s[20:23], s37 offen offset:64
    v_mul_f32 v76, v76, v234
    v_mul_f32 v77, v77, v234
    v_mul_f32 v78, v78, v234
    v_mul_f32 v79, v79, v234
    v_cvt_pk_bf16_f32 v76, v76, v77
    v_cvt_pk_bf16_f32 v77, v78, v79
    buffer_store_dwordx2 v[76:77], v243, s[20:23], s37 offen offset:96
    v_mul_f32 v80, v80, v234
    v_mul_f32 v81, v81, v234
    v_mul_f32 v82, v82, v234
    v_mul_f32 v83, v83, v234
    v_cvt_pk_bf16_f32 v80, v80, v81
    v_cvt_pk_bf16_f32 v81, v82, v83
    buffer_store_dwordx2 v[80:81], v243, s[20:23], s37 offen offset:128
    v_mul_f32 v84, v84, v234
    v_mul_f32 v85, v85, v234
    v_mul_f32 v86, v86, v234
    v_mul_f32 v87, v87, v234
    v_cvt_pk_bf16_f32 v84, v84, v85
    v_cvt_pk_bf16_f32 v85, v86, v87
    buffer_store_dwordx2 v[84:85], v243, s[20:23], s37 offen offset:160
    v_mul_f32 v88, v88, v234
    v_mul_f32 v89, v89, v234
    v_mul_f32 v90, v90, v234
    v_mul_f32 v91, v91, v234
    v_cvt_pk_bf16_f32 v88, v88, v89
    v_cvt_pk_bf16_f32 v89, v90, v91
    buffer_store_dwordx2 v[88:89], v243, s[20:23], s37 offen offset:192
    v_mul_f32 v92, v92, v234
    v_mul_f32 v93, v93, v234
    v_mul_f32 v94, v94, v234
    v_mul_f32 v95, v95, v234
    v_cvt_pk_bf16_f32 v92, v92, v93
    v_cvt_pk_bf16_f32 v93, v94, v95
    buffer_store_dwordx2 v[92:93], v243, s[20:23], s37 offen offset:224
    v_rcp_f32 v235, v188
    s_add_u32 s37, s88, 0x3000
    v_mul_f32 v96, v96, v235
    v_mul_f32 v97, v97, v235
    v_mul_f32 v98, v98, v235
    v_mul_f32 v99, v99, v235
    v_cvt_pk_bf16_f32 v96, v96, v97
    v_cvt_pk_bf16_f32 v97, v98, v99
    buffer_store_dwordx2 v[96:97], v243, s[20:23], s37 offen
    v_mul_f32 v100, v100, v235
    v_mul_f32 v101, v101, v235
    v_mul_f32 v102, v102, v235
    v_mul_f32 v103, v103, v235
    v_cvt_pk_bf16_f32 v100, v100, v101
    v_cvt_pk_bf16_f32 v101, v102, v103
    buffer_store_dwordx2 v[100:101], v243, s[20:23], s37 offen offset:32
    v_mul_f32 v104, v104, v235
    v_mul_f32 v105, v105, v235
    v_mul_f32 v106, v106, v235
    v_mul_f32 v107, v107, v235
    v_cvt_pk_bf16_f32 v104, v104, v105
    v_cvt_pk_bf16_f32 v105, v106, v107
    buffer_store_dwordx2 v[104:105], v243, s[20:23], s37 offen offset:64
    v_mul_f32 v108, v108, v235
    v_mul_f32 v109, v109, v235
    v_mul_f32 v110, v110, v235
    v_mul_f32 v111, v111, v235
    v_cvt_pk_bf16_f32 v108, v108, v109
    v_cvt_pk_bf16_f32 v109, v110, v111
    buffer_store_dwordx2 v[108:109], v243, s[20:23], s37 offen offset:96
    v_mul_f32 v112, v112, v235
    v_mul_f32 v113, v113, v235
    v_mul_f32 v114, v114, v235
    v_mul_f32 v115, v115, v235
    v_cvt_pk_bf16_f32 v112, v112, v113
    v_cvt_pk_bf16_f32 v113, v114, v115
    buffer_store_dwordx2 v[112:113], v243, s[20:23], s37 offen offset:128
    v_mul_f32 v116, v116, v235
    v_mul_f32 v117, v117, v235
    v_mul_f32 v118, v118, v235
    v_mul_f32 v119, v119, v235
    v_cvt_pk_bf16_f32 v116, v116, v117
    v_cvt_pk_bf16_f32 v117, v118, v119
    buffer_store_dwordx2 v[116:117], v243, s[20:23], s37 offen offset:160
    v_mul_f32 v120, v120, v235
    v_mul_f32 v121, v121, v235
    v_mul_f32 v122, v122, v235
    v_mul_f32 v123, v123, v235
    v_cvt_pk_bf16_f32 v120, v120, v121
    v_cvt_pk_bf16_f32 v121, v122, v123
    buffer_store_dwordx2 v[120:121], v243, s[20:23], s37 offen offset:192
    v_mul_f32 v124, v124, v235
    v_mul_f32 v125, v125, v235
    v_mul_f32 v126, v126, v235
    v_mul_f32 v127, v127, v235
    v_cvt_pk_bf16_f32 v124, v124, v125
    v_cvt_pk_bf16_f32 v125, v126, v127
    buffer_store_dwordx2 v[124:125], v243, s[20:23], s37 offen offset:224
    s_waitcnt vmcnt(0)
L_sn:
    s_add_u32 s86, s86, 1
    s_cmp_lt_u32 s86, 4
    s_cbranch_scc1 L_su
L_done:
L_end:
    s_endpgm
.section .rodata,"a"
.p2align 6
.amdhsa_kernel standalone__mha_softmax__near_ridge_kernel
  .amdhsa_next_free_vgpr 512
  .amdhsa_next_free_sgpr 96
  .amdhsa_accum_offset 256
  .amdhsa_group_segment_fixed_size 0
  .amdhsa_kernarg_size 48
  .amdhsa_user_sgpr_count 2
  .amdhsa_user_sgpr_kernarg_segment_ptr 1
  .amdhsa_system_sgpr_workgroup_id_x 1
.end_amdhsa_kernel
```
